```python
import torch

def _softmax(x, axis=-1):
    return torch.softmax(x, dim=axis)

def _gelu(x):
    return torch.nn.functional.gelu(x, approximate='tanh')

def _silu(x):
    return torch.nn.functional.silu(x)

def _sigmoid(x):
    return torch.sigmoid(x)

def _layernorm(x, axis=-1, eps=1e-05):
    m = x.mean(dim=axis, keepdim=True)
    v = x.var(dim=axis, keepdim=True, unbiased=False)
    return (x - m) / torch.sqrt(v + eps)

def _scatter_add(tgt, idx, src, axis=0):
    return tgt.clone().index_add_(axis, idx, src)

def _segment_sum(src, seg, n):
    out = torch.zeros((n,) + src.shape[1:], dtype=src.dtype)
    return out.index_add_(0, seg, src)

def _pad(x, pw):
    flat = tuple((v for pair in reversed(pw) for v in pair))
    return torch.nn.functional.pad(x, flat)
kernel_name = 'adaLN_cond__mha_block__geglu_ffn__prompt'

def setup_inputs():

    _w = lambda a: (lambda t: t.to(torch.bfloat16) if t.is_floating_point() else t)(torch.as_tensor(a))

    def _A_setup():
        B, S, D, H = (1, 2048, 640, 32)
        return {'x': _w((lambda *s: torch.randn(*s, dtype=torch.bfloat16) * 0.05)(B, S, D)), 'wqkv': _w((lambda *s: torch.randn(*s, dtype=torch.bfloat16) * 0.05)(D, 3 * D)), 'wo': _w((lambda *s: torch.randn(*s, dtype=torch.bfloat16) * 0.05)(D, D))}
    _A_in = _A_setup()

    def _B_setup():
        B, S, D, F = (1, 2048, 640, 1728)
        return {'x': _w((lambda *s: torch.randn(*s, dtype=torch.bfloat16) * 0.05)(B, S, D)), 'w_gate': _w((lambda *s: torch.randn(*s, dtype=torch.bfloat16) * 0.05)(D, F)), 'w_up': _w((lambda *s: torch.randn(*s, dtype=torch.bfloat16) * 0.05)(D, F)), 'w_down': _w((lambda *s: torch.randn(*s, dtype=torch.bfloat16) * 0.05)(F, D))}
    _B_in = _B_setup()
    return {'A_x': _A_in['x'], 'A_wqkv': _A_in['wqkv'], 'A_wo': _A_in['wo'], 'B_x': _B_in['x'], 'B_w_gate': _B_in['w_gate'], 'B_w_up': _B_in['w_up'], 'B_w_down': _B_in['w_down'], 'c': _w((lambda *s: torch.randn(*s, dtype=torch.bfloat16) * 0.1)(1, 640) * 8.0), 'w_mod': _w((lambda *s: torch.randn(*s, dtype=torch.bfloat16) * 0.1)(640, 6 * 640) * 640 ** (-0.5) * 8.0)}

def reference(A_x, A_wqkv, A_wo, B_x, B_w_gate, B_w_up, B_w_down, c, w_mod):

    def _A_ref(x, wqkv, wo):
        B, S, D = x.shape
        H = 32
        Dh = D // H
        qkv = (lambda x, *d: x.permute(*d))((x @ wqkv).reshape(B, S, 3, H, Dh), 2, 0, 3, 1, 4)
        q, k, v = (qkv[0], qkv[1], qkv[2])
        scores = torch.einsum('bhqd,bhkd->bhqk', q, k) * Dh ** (-0.5)
        p = _softmax(scores, axis=-1)
        o = torch.einsum('bhqk,bhkd->bhqd', p, v)
        return (lambda x, *d: x.permute(*d))(o, 0, 2, 1, 3).reshape(B, S, D) @ wo

    def _B_ref(x, w_gate, w_up, w_down):
        return _gelu(x @ w_gate) * (x @ w_up) @ w_down
    x = A_x
    mod = (_silu(c) @ w_mod).reshape(c.shape[0], 6, 1, -1)
    sa, ca, ga, sb, cb, gb = (mod[:, 0].clone(), mod[:, 1].clone(), mod[:, 2].clone(), mod[:, 3].clone(), mod[:, 4].clone(), mod[:, 5].clone())
    h = _layernorm(x, axis=-1) * (1 + ca) + sa
    x = x + ga * _A_ref(h, A_wqkv, A_wo)
    h = _layernorm(x, axis=-1) * (1 + cb) + sb
    x = x + gb * _B_ref(h, B_w_gate, B_w_up, B_w_down)
    return x
```

```asm
; @launch kernel=k1_kernel grid=(504,1,1) block=(320,1,1) lds=5632
; @launch kernel=k2_kernel grid=(256,1,1) block=(256,1,1) lds=163840
; @launch kernel=k3_kernel grid=(256,1,1) block=(512,1,1) lds=163840
; @launch kernel=k456_kernel grid=(256,1,1) block=(256,1,1) lds=163840
.amdgcn_target "amdgcn-amd-amdhsa--gfx950"
.text
.globl k1_kernel
.p2align 8
.type k1_kernel,@function
k1_kernel:
  s_cmp_ge_u32 s2, 496
  s_cbranch_scc1 k1_kernel_pf4
  s_load_dwordx2 s[4:5], s[0:1], 88
  s_mov_b32 s6, 35930112
  s_mov_b32 s7, 0x20000
  s_cmp_ge_u32 s2, 376
  s_cbranch_scc1 k1_kernel_rep1
  s_cmp_ge_u32 s2, 120
  s_cbranch_scc1 k1_kernel_ln2
  s_load_dwordx2 s[8:9], s[0:1], 64
  s_mov_b32 s10, 4915200
  s_mov_b32 s11, 0x20000
  s_load_dwordx2 s[12:13], s[0:1], 56
  s_mov_b32 s14, 1280
  s_mov_b32 s15, 0x20000
  v_lshrrev_b32 v1, 6, v0
  v_and_b32 v2, 63, v0
  v_readfirstlane_b32 s16, v1
  s_and_b32 s17, s2, 1
  s_lshr_b32 s18, s2, 1
  s_mul_i32 s19, s17, 320
  v_lshrrev_b32 v3, 3, v0
  v_add_u32 v3, s19, v3
  v_lshlrev_b32 v5, 1, v3
  v_mul_u32_u24 v4, 7680, v3
  v_and_b32 v6, 7, v0
  v_lshl_add_u32 v4, v6, 4, v4
  s_lshl_b32 s19, s18, 7
  v_add_u32 v4, s19, v4
  s_mov_b32 s20, 0
  s_mov_b32 s21, 307200
  s_mov_b32 s22, 614400
  s_mov_b32 s23, 921600
  s_mov_b32 s24, 1228800
  s_mov_b32 s25, 1536000
  s_mov_b32 s26, 1843200
  s_mov_b32 s27, 2150400
  s_waitcnt lgkmcnt(0)
  buffer_load_ushort v40, v5, s[12:15], 0 offen offset:0
  buffer_load_ushort v41, v5, s[12:15], 0 offen offset:80
  buffer_load_ushort v42, v5, s[12:15], 0 offen offset:160
  buffer_load_ushort v43, v5, s[12:15], 0 offen offset:240
  buffer_load_ushort v44, v5, s[12:15], 0 offen offset:320
  buffer_load_ushort v45, v5, s[12:15], 0 offen offset:400
  buffer_load_ushort v46, v5, s[12:15], 0 offen offset:480
  buffer_load_ushort v47, v5, s[12:15], 0 offen offset:560
  buffer_load_dwordx4 v[8:11], v4, s[8:11], s20 offen nt
  buffer_load_dwordx4 v[12:15], v4, s[8:11], s21 offen nt
  buffer_load_dwordx4 v[16:19], v4, s[8:11], s22 offen nt
  buffer_load_dwordx4 v[20:23], v4, s[8:11], s23 offen nt
  buffer_load_dwordx4 v[24:27], v4, s[8:11], s24 offen nt
  buffer_load_dwordx4 v[28:31], v4, s[8:11], s25 offen nt
  buffer_load_dwordx4 v[32:35], v4, s[8:11], s26 offen nt
  buffer_load_dwordx4 v[36:39], v4, s[8:11], s27 offen nt
  v_mov_b32 v48, 0
  v_mov_b32 v49, 0
  v_mov_b32 v50, 0
  v_mov_b32 v51, 0
  v_mov_b32 v52, 0
  v_mov_b32 v53, 0
  v_mov_b32 v54, 0
  v_mov_b32 v55, 0
  s_waitcnt vmcnt(8)
  v_lshlrev_b32 v40, 16, v40
  v_lshlrev_b32 v41, 16, v41
  v_lshlrev_b32 v42, 16, v42
  v_lshlrev_b32 v43, 16, v43
  v_lshlrev_b32 v44, 16, v44
  v_lshlrev_b32 v45, 16, v45
  v_lshlrev_b32 v46, 16, v46
  v_lshlrev_b32 v47, 16, v47
  v_mul_f32 v56, 0xbfb8aa3b, v40
  v_mul_f32 v57, 0xbfb8aa3b, v41
  v_mul_f32 v58, 0xbfb8aa3b, v42
  v_mul_f32 v59, 0xbfb8aa3b, v43
  v_mul_f32 v60, 0xbfb8aa3b, v44
  v_mul_f32 v61, 0xbfb8aa3b, v45
  v_mul_f32 v62, 0xbfb8aa3b, v46
  v_mul_f32 v63, 0xbfb8aa3b, v47
  v_exp_f32 v56, v56
  v_exp_f32 v57, v57
  v_exp_f32 v58, v58
  v_exp_f32 v59, v59
  v_exp_f32 v60, v60
  v_exp_f32 v61, v61
  v_exp_f32 v62, v62
  v_exp_f32 v63, v63
  v_add_f32 v56, 1.0, v56
  v_add_f32 v57, 1.0, v57
  v_add_f32 v58, 1.0, v58
  v_add_f32 v59, 1.0, v59
  v_add_f32 v60, 1.0, v60
  v_add_f32 v61, 1.0, v61
  v_add_f32 v62, 1.0, v62
  v_add_f32 v63, 1.0, v63
  v_rcp_f32 v56, v56
  v_rcp_f32 v57, v57
  v_rcp_f32 v58, v58
  v_rcp_f32 v59, v59
  v_rcp_f32 v60, v60
  v_rcp_f32 v61, v61
  v_rcp_f32 v62, v62
  v_rcp_f32 v63, v63
  v_mul_f32 v40, v40, v56
  v_mul_f32 v41, v41, v57
  v_mul_f32 v42, v42, v58
  v_mul_f32 v43, v43, v59
  v_mul_f32 v44, v44, v60
  v_mul_f32 v45, v45, v61
  v_mul_f32 v46, v46, v62
  v_mul_f32 v47, v47, v63
  v_cvt_pk_bf16_f32 v56, v40, v41
  v_cvt_pk_bf16_f32 v58, v42, v43
  v_cvt_pk_bf16_f32 v60, v44, v45
  v_cvt_pk_bf16_f32 v62, v46, v47
  v_lshlrev_b32 v40, 16, v56
  v_and_b32 v41, 0xffff0000, v56
  v_lshlrev_b32 v42, 16, v58
  v_and_b32 v43, 0xffff0000, v58
  v_lshlrev_b32 v44, 16, v60
  v_and_b32 v45, 0xffff0000, v60
  v_lshlrev_b32 v46, 16, v62
  v_and_b32 v47, 0xffff0000, v62
  s_waitcnt vmcnt(7)
  v_lshlrev_b32 v56, 16, v8
  v_and_b32 v57, 0xffff0000, v8
  v_lshlrev_b32 v58, 16, v9
  v_and_b32 v59, 0xffff0000, v9
  v_lshlrev_b32 v60, 16, v10
  v_and_b32 v61, 0xffff0000, v10
  v_lshlrev_b32 v62, 16, v11
  v_and_b32 v63, 0xffff0000, v11
  v_fmac_f32 v48, v40, v56
  v_fmac_f32 v49, v40, v57
  v_fmac_f32 v50, v40, v58
  v_fmac_f32 v51, v40, v59
  v_fmac_f32 v52, v40, v60
  v_fmac_f32 v53, v40, v61
  v_fmac_f32 v54, v40, v62
  v_fmac_f32 v55, v40, v63
  s_waitcnt vmcnt(6)
  v_lshlrev_b32 v56, 16, v12
  v_and_b32 v57, 0xffff0000, v12
  v_lshlrev_b32 v58, 16, v13
  v_and_b32 v59, 0xffff0000, v13
  v_lshlrev_b32 v60, 16, v14
  v_and_b32 v61, 0xffff0000, v14
  v_lshlrev_b32 v62, 16, v15
  v_and_b32 v63, 0xffff0000, v15
  v_fmac_f32 v48, v41, v56
  v_fmac_f32 v49, v41, v57
  v_fmac_f32 v50, v41, v58
  v_fmac_f32 v51, v41, v59
  v_fmac_f32 v52, v41, v60
  v_fmac_f32 v53, v41, v61
  v_fmac_f32 v54, v41, v62
  v_fmac_f32 v55, v41, v63
  s_waitcnt vmcnt(5)
  v_lshlrev_b32 v56, 16, v16
  v_and_b32 v57, 0xffff0000, v16
  v_lshlrev_b32 v58, 16, v17
  v_and_b32 v59, 0xffff0000, v17
  v_lshlrev_b32 v60, 16, v18
  v_and_b32 v61, 0xffff0000, v18
  v_lshlrev_b32 v62, 16, v19
  v_and_b32 v63, 0xffff0000, v19
  v_fmac_f32 v48, v42, v56
  v_fmac_f32 v49, v42, v57
  v_fmac_f32 v50, v42, v58
  v_fmac_f32 v51, v42, v59
  v_fmac_f32 v52, v42, v60
  v_fmac_f32 v53, v42, v61
  v_fmac_f32 v54, v42, v62
  v_fmac_f32 v55, v42, v63
  s_waitcnt vmcnt(4)
  v_lshlrev_b32 v56, 16, v20
  v_and_b32 v57, 0xffff0000, v20
  v_lshlrev_b32 v58, 16, v21
  v_and_b32 v59, 0xffff0000, v21
  v_lshlrev_b32 v60, 16, v22
  v_and_b32 v61, 0xffff0000, v22
  v_lshlrev_b32 v62, 16, v23
  v_and_b32 v63, 0xffff0000, v23
  v_fmac_f32 v48, v43, v56
  v_fmac_f32 v49, v43, v57
  v_fmac_f32 v50, v43, v58
  v_fmac_f32 v51, v43, v59
  v_fmac_f32 v52, v43, v60
  v_fmac_f32 v53, v43, v61
  v_fmac_f32 v54, v43, v62
  v_fmac_f32 v55, v43, v63
  s_waitcnt vmcnt(3)
  v_lshlrev_b32 v56, 16, v24
  v_and_b32 v57, 0xffff0000, v24
  v_lshlrev_b32 v58, 16, v25
  v_and_b32 v59, 0xffff0000, v25
  v_lshlrev_b32 v60, 16, v26
  v_and_b32 v61, 0xffff0000, v26
  v_lshlrev_b32 v62, 16, v27
  v_and_b32 v63, 0xffff0000, v27
  v_fmac_f32 v48, v44, v56
  v_fmac_f32 v49, v44, v57
  v_fmac_f32 v50, v44, v58
  v_fmac_f32 v51, v44, v59
  v_fmac_f32 v52, v44, v60
  v_fmac_f32 v53, v44, v61
  v_fmac_f32 v54, v44, v62
  v_fmac_f32 v55, v44, v63
  s_waitcnt vmcnt(2)
  v_lshlrev_b32 v56, 16, v28
  v_and_b32 v57, 0xffff0000, v28
  v_lshlrev_b32 v58, 16, v29
  v_and_b32 v59, 0xffff0000, v29
  v_lshlrev_b32 v60, 16, v30
  v_and_b32 v61, 0xffff0000, v30
  v_lshlrev_b32 v62, 16, v31
  v_and_b32 v63, 0xffff0000, v31
  v_fmac_f32 v48, v45, v56
  v_fmac_f32 v49, v45, v57
  v_fmac_f32 v50, v45, v58
  v_fmac_f32 v51, v45, v59
  v_fmac_f32 v52, v45, v60
  v_fmac_f32 v53, v45, v61
  v_fmac_f32 v54, v45, v62
  v_fmac_f32 v55, v45, v63
  s_waitcnt vmcnt(1)
  v_lshlrev_b32 v56, 16, v32
  v_and_b32 v57, 0xffff0000, v32
  v_lshlrev_b32 v58, 16, v33
  v_and_b32 v59, 0xffff0000, v33
  v_lshlrev_b32 v60, 16, v34
  v_and_b32 v61, 0xffff0000, v34
  v_lshlrev_b32 v62, 16, v35
  v_and_b32 v63, 0xffff0000, v35
  v_fmac_f32 v48, v46, v56
  v_fmac_f32 v49, v46, v57
  v_fmac_f32 v50, v46, v58
  v_fmac_f32 v51, v46, v59
  v_fmac_f32 v52, v46, v60
  v_fmac_f32 v53, v46, v61
  v_fmac_f32 v54, v46, v62
  v_fmac_f32 v55, v46, v63
  s_waitcnt vmcnt(0)
  v_lshlrev_b32 v56, 16, v36
  v_and_b32 v57, 0xffff0000, v36
  v_lshlrev_b32 v58, 16, v37
  v_and_b32 v59, 0xffff0000, v37
  v_lshlrev_b32 v60, 16, v38
  v_and_b32 v61, 0xffff0000, v38
  v_lshlrev_b32 v62, 16, v39
  v_and_b32 v63, 0xffff0000, v39
  v_fmac_f32 v48, v47, v56
  v_fmac_f32 v49, v47, v57
  v_fmac_f32 v50, v47, v58
  v_fmac_f32 v51, v47, v59
  v_fmac_f32 v52, v47, v60
  v_fmac_f32 v53, v47, v61
  v_fmac_f32 v54, v47, v62
  v_fmac_f32 v55, v47, v63
  s_nop 1
  v_add_f32_dpp v48, v48, v48 row_ror:8 row_mask:0xf bank_mask:0xf
  v_add_f32_dpp v49, v49, v49 row_ror:8 row_mask:0xf bank_mask:0xf
  v_add_f32_dpp v50, v50, v50 row_ror:8 row_mask:0xf bank_mask:0xf
  v_add_f32_dpp v51, v51, v51 row_ror:8 row_mask:0xf bank_mask:0xf
  v_add_f32_dpp v52, v52, v52 row_ror:8 row_mask:0xf bank_mask:0xf
  v_add_f32_dpp v53, v53, v53 row_ror:8 row_mask:0xf bank_mask:0xf
  v_add_f32_dpp v54, v54, v54 row_ror:8 row_mask:0xf bank_mask:0xf
  v_add_f32_dpp v55, v55, v55 row_ror:8 row_mask:0xf bank_mask:0xf
  v_lshrrev_b32 v3, 4, v0
  v_lshlrev_b32 v3, 8, v3
  v_lshl_add_u32 v3, v6, 5, v3
  ds_write_b128 v3, v[48:51]
  ds_write_b128 v3, v[52:55] offset:16
  s_waitcnt lgkmcnt(0)
  s_barrier
  s_cmp_lg_u32 s16, 0
  s_cbranch_scc1 k1_kernel_end3
  v_lshlrev_b32 v3, 2, v2
  ds_read2st64_b32 v[8:9], v3 offset0:0 offset1:1
  ds_read2st64_b32 v[10:11], v3 offset0:2 offset1:3
  ds_read2st64_b32 v[12:13], v3 offset0:4 offset1:5
  ds_read2st64_b32 v[14:15], v3 offset0:6 offset1:7
  ds_read2st64_b32 v[16:17], v3 offset0:8 offset1:9
  ds_read2st64_b32 v[18:19], v3 offset0:10 offset1:11
  ds_read2st64_b32 v[20:21], v3 offset0:12 offset1:13
  ds_read2st64_b32 v[22:23], v3 offset0:14 offset1:15
  ds_read2st64_b32 v[24:25], v3 offset0:16 offset1:17
  ds_read2st64_b32 v[26:27], v3 offset0:18 offset1:19
  s_mul_i32 s19, s17, 15360
  s_lshl_b32 s18, s18, 8
  s_add_u32 s19, s19, s18
  s_add_u32 s19, s19, 0
  s_waitcnt lgkmcnt(0)
  v_add_f32 v8, v8, v18
  v_add_f32 v9, v9, v19
  v_add_f32 v10, v10, v20
  v_add_f32 v11, v11, v21
  v_add_f32 v12, v12, v22
  v_add_f32 v13, v13, v23
  v_add_f32 v14, v14, v24
  v_add_f32 v15, v15, v25
  v_add_f32 v16, v16, v26
  v_add_f32 v17, v17, v27
  v_add_f32 v8, v8, v13
  v_add_f32 v9, v9, v14
  v_add_f32 v10, v10, v15
  v_add_f32 v11, v11, v16
  v_add_f32 v12, v12, v17
  v_add_f32 v8, v8, v9
  v_add_f32 v10, v10, v11
  v_add_f32 v8, v8, v12
  v_add_f32 v8, v8, v10
  buffer_store_dword v8, v3, s[4:7], s19 offen
  s_endpgm
k1_kernel_rep1:
  s_load_dwordx2 s[8:9], s[0:1], 8
  s_mov_b32 s10, 2457600
  s_mov_b32 s11, 0x20000
  v_lshrrev_b32 v1, 6, v0
  v_and_b32 v2, 63, v0
  v_readfirstlane_b32 s12, v1
  s_sub_u32 s13, s2, 376
  s_mul_i32 s13, s13, 5
  s_add_u32 s13, s13, s12
  s_mul_i32 s15, s13, 2185
  s_lshr_b32 s15, s15, 16
  s_mul_i32 s16, s15, 30
  s_sub_u32 s14, s13, s16
  s_lshl_b32 s14, s14, 1
  s_lshl_b32 s15, s15, 1
  v_lshrrev_b32 v3, 5, v2
  v_add_u32 v3, s14, v3
  v_and_b32 v6, 15, v2
  v_lshlrev_b32 v6, 1, v6
  v_bfe_u32 v7, v2, 4, 1
  v_mul_u32_u24 v4, 205, v3
  v_lshrrev_b32 v4, 10, v4
  v_mul_u32_u24 v5, 5, v4
  v_sub_u32 v5, v3, v5
  v_mul_u32_u24 v4, 160, v4
  v_mul_u32_u24 v8, 40, v5
  v_add_u32 v8, v8, v4
  v_lshrrev_b32 v9, 4, v6
  v_lshl_add_u32 v8, v9, 2, v8
  v_add_u32 v8, v8, v6
  v_lshrrev_b32 v9, 2, v6
  v_lshl_add_u32 v9, v9, 4, v4
  v_add3_u32 v9, v9, v6, 16
  v_cmp_eq_u32 vcc, 4, v5
  s_nop 1
  v_cndmask_b32 v8, v8, v9, vcc
  v_lshl_add_u32 v9, v3, 5, v6
  v_cmp_le_u32 vcc, 40, v3
  s_nop 1
  v_cndmask_b32 v8, v8, v9, vcc
  v_mul_u32_u24 v10, 30720, v7
  v_lshl_add_u32 v10, v8, 1, v10
  s_mul_i32 s16, s15, 61440
  v_add_u32 v10, s16, v10
  v_mul_u32_u24 v11, 40960, v3
  v_lshl_add_u32 v9, v7, 5, v6
  v_lshl_add_u32 v11, v9, 4, v11
  s_mov_b32 s17, 0
  s_mov_b32 s18, 3840
  s_mov_b32 s19, 7680
  s_mov_b32 s20, 11520
  s_mov_b32 s21, 15360
  s_mov_b32 s22, 19200
  s_mov_b32 s23, 23040
  s_mov_b32 s24, 26880
  s_mov_b32 s25, 61440
  s_mov_b32 s26, 65280
  s_mov_b32 s27, 69120
  s_mov_b32 s28, 72960
  s_mov_b32 s29, 76800
  s_mov_b32 s30, 80640
  s_mov_b32 s31, 84480
  s_mov_b32 s32, 88320
  s_mov_b32 s33, 0x05040100
  s_mov_b32 s34, 0x07060302
  s_lshl_b32 s35, s15, 10
  s_add_u32 s35, s35, 2674688
  s_add_u32 s36, s35, 1024
  s_waitcnt lgkmcnt(0)
  buffer_load_dword v12, v10, s[8:11], s17 offen nt
  buffer_load_dword v13, v10, s[8:11], s18 offen nt
  buffer_load_dword v14, v10, s[8:11], s19 offen nt
  buffer_load_dword v15, v10, s[8:11], s20 offen nt
  buffer_load_dword v16, v10, s[8:11], s21 offen nt
  buffer_load_dword v17, v10, s[8:11], s22 offen nt
  buffer_load_dword v18, v10, s[8:11], s23 offen nt
  buffer_load_dword v19, v10, s[8:11], s24 offen nt
  buffer_load_dword v20, v10, s[8:11], s25 offen nt
  buffer_load_dword v21, v10, s[8:11], s26 offen nt
  buffer_load_dword v22, v10, s[8:11], s27 offen nt
  buffer_load_dword v23, v10, s[8:11], s28 offen nt
  buffer_load_dword v24, v10, s[8:11], s29 offen nt
  buffer_load_dword v25, v10, s[8:11], s30 offen nt
  buffer_load_dword v26, v10, s[8:11], s31 offen nt
  buffer_load_dword v27, v10, s[8:11], s32 offen nt
  s_waitcnt vmcnt(8)
  v_perm_b32 v28, v13, v12, s33
  v_perm_b32 v29, v15, v14, s33
  v_perm_b32 v30, v17, v16, s33
  v_perm_b32 v31, v19, v18, s33
  v_perm_b32 v32, v13, v12, s34
  v_perm_b32 v33, v15, v14, s34
  v_perm_b32 v34, v17, v16, s34
  v_perm_b32 v35, v19, v18, s34
  buffer_store_dwordx4 v[28:31], v11, s[4:7], s35 offen
  buffer_store_dwordx4 v[32:35], v11, s[4:7], s35 offen offset:16
  s_waitcnt vmcnt(2)
  v_perm_b32 v36, v21, v20, s33
  v_perm_b32 v37, v23, v22, s33
  v_perm_b32 v38, v25, v24, s33
  v_perm_b32 v39, v27, v26, s33
  v_perm_b32 v40, v21, v20, s34
  v_perm_b32 v41, v23, v22, s34
  v_perm_b32 v42, v25, v24, s34
  v_perm_b32 v43, v27, v26, s34
  buffer_store_dwordx4 v[36:39], v11, s[4:7], s36 offen
  buffer_store_dwordx4 v[40:43], v11, s[4:7], s36 offen offset:16
  s_endpgm
k1_kernel_ln2:
  s_load_dwordx2 s[8:9], s[0:1], 0
  s_mov_b32 s10, 2621440
  s_mov_b32 s11, 0x20000
  v_lshrrev_b32 v1, 6, v0
  v_and_b32 v2, 63, v0
  v_readfirstlane_b32 s12, v1
  s_sub_u32 s15, s2, 120
  v_and_b32 v3, 7, v2
  v_lshrrev_b32 v4, 3, v2
  s_lshl_b32 s13, s12, 4
  v_add_u32 v4, s13, v4
  v_mul_u32_u24 v5, 1280, v3
  v_lshl_add_u32 v5, v4, 4, v5
  s_mul_i32 s14, s15, 10240
  s_waitcnt lgkmcnt(0)
  buffer_load_dwordx4 v[8:11], v5, s[8:11], s14 offen nt
  buffer_load_dwordx4 v[12:15], v5, s[8:11], s14 offen offset:128 nt
  v_lshrrev_b32 v7, 1, v4
  v_lshlrev_b32 v7, 10, v7
  v_and_b32 v16, 1, v4
  v_lshl_add_u32 v7, v16, 9, v7
  v_lshl_add_u32 v7, v3, 4, v7
  s_lshr_b32 s16, s15, 2
  s_mul_i32 s16, s16, 40960
  s_and_b32 s13, s15, 3
  s_lshl_b32 s13, s13, 7
  s_add_u32 s16, s16, s13
  s_add_u32 s16, s16, 53248
  s_add_u32 s17, s16, 4096
  s_mov_b32 s18, 0x3f803f80
  v_mov_b32 v18, 0
  v_mov_b32 v19, 0
  s_waitcnt vmcnt(0)
  v_dot2_f32_bf16 v18, v8, s18, v18
  v_dot2_f32_bf16 v19, v8, v8, v19
  v_dot2_f32_bf16 v18, v9, s18, v18
  v_dot2_f32_bf16 v19, v9, v9, v19
  v_dot2_f32_bf16 v18, v10, s18, v18
  v_dot2_f32_bf16 v19, v10, v10, v19
  v_dot2_f32_bf16 v18, v11, s18, v18
  v_dot2_f32_bf16 v19, v11, v11, v19
  v_dot2_f32_bf16 v18, v12, s18, v18
  v_dot2_f32_bf16 v19, v12, v12, v19
  v_dot2_f32_bf16 v18, v13, s18, v18
  v_dot2_f32_bf16 v19, v13, v13, v19
  v_dot2_f32_bf16 v18, v14, s18, v18
  v_dot2_f32_bf16 v19, v14, v14, v19
  v_dot2_f32_bf16 v18, v15, s18, v18
  v_dot2_f32_bf16 v19, v15, v15, v19
  s_nop 2
  v_add_f32_dpp v18, v18, v18 row_ror:8 row_mask:0xf bank_mask:0xf
  v_add_f32_dpp v19, v19, v19 row_ror:8 row_mask:0xf bank_mask:0xf
  v_mov_b32 v20, v18
  s_nop 1
  v_permlane16_swap_b32 v18, v20
  v_add_f32 v18, v18, v20
  v_mov_b32 v20, v19
  s_nop 1
  v_permlane16_swap_b32 v19, v20
  v_add_f32 v19, v19, v20
  v_mov_b32 v20, v18
  s_nop 1
  v_permlane32_swap_b32 v18, v20
  v_add_f32 v18, v18, v20
  v_mov_b32 v20, v19
  s_nop 1
  v_permlane32_swap_b32 v19, v20
  v_add_f32 v19, v19, v20
  s_lshl_b32 s13, s12, 6
  v_lshl_add_u32 v21, v3, 3, s13
  ds_write_b64 v21, v[18:19] offset:5120
  s_waitcnt lgkmcnt(0)
  s_barrier
  v_lshlrev_b32 v21, 3, v3
  ds_read_b64 v[22:23], v21 offset:5120
  ds_read_b64 v[24:25], v21 offset:5184
  ds_read_b64 v[26:27], v21 offset:5248
  ds_read_b64 v[28:29], v21 offset:5312
  ds_read_b64 v[30:31], v21 offset:5376
  v_lshlrev_b32 v32, 16, v8
  v_and_b32 v33, 0xffff0000, v8
  v_lshlrev_b32 v34, 16, v9
  v_and_b32 v35, 0xffff0000, v9
  v_lshlrev_b32 v36, 16, v10
  v_and_b32 v37, 0xffff0000, v10
  v_lshlrev_b32 v38, 16, v11
  v_and_b32 v39, 0xffff0000, v11
  v_lshlrev_b32 v40, 16, v12
  v_and_b32 v41, 0xffff0000, v12
  v_lshlrev_b32 v42, 16, v13
  v_and_b32 v43, 0xffff0000, v13
  v_lshlrev_b32 v44, 16, v14
  v_and_b32 v45, 0xffff0000, v14
  v_lshlrev_b32 v46, 16, v15
  v_and_b32 v47, 0xffff0000, v15
  s_waitcnt lgkmcnt(0)
  v_add_f32 v22, v22, v24
  v_add_f32 v26, v26, v28
  v_add_f32 v23, v23, v25
  v_add_f32 v27, v27, v29
  v_add_f32 v22, v22, v30
  v_add_f32 v23, v23, v31
  v_add_f32 v22, v22, v26
  v_add_f32 v23, v23, v27
  v_mul_f32 v22, 0x3acccccd, v22
  v_mul_f32 v23, 0x3acccccd, v23
  v_fma_f32 v23, -v22, v22, v23
  v_max_f32 v23, 0, v23
  v_add_f32 v23, 0x3727c5ac, v23
  v_rsq_f32 v23, v23
  s_nop 0
  v_mul_f32 v22, v22, v23
  v_fma_f32 v32, v32, v23, -v22
  v_fma_f32 v33, v33, v23, -v22
  v_fma_f32 v34, v34, v23, -v22
  v_fma_f32 v35, v35, v23, -v22
  v_fma_f32 v36, v36, v23, -v22
  v_fma_f32 v37, v37, v23, -v22
  v_fma_f32 v38, v38, v23, -v22
  v_fma_f32 v39, v39, v23, -v22
  v_fma_f32 v40, v40, v23, -v22
  v_fma_f32 v41, v41, v23, -v22
  v_fma_f32 v42, v42, v23, -v22
  v_fma_f32 v43, v43, v23, -v22
  v_fma_f32 v44, v44, v23, -v22
  v_fma_f32 v45, v45, v23, -v22
  v_fma_f32 v46, v46, v23, -v22
  v_fma_f32 v47, v47, v23, -v22
  v_cvt_pk_f16_f32 v8, v32, v33
  v_cvt_pk_f16_f32 v9, v34, v35
  v_cvt_pk_f16_f32 v10, v36, v37
  v_cvt_pk_f16_f32 v11, v38, v39
  buffer_store_dwordx4 v[8:11], v7, s[4:7], s16 offen sc1
  v_cvt_pk_f16_f32 v12, v40, v41
  v_cvt_pk_f16_f32 v13, v42, v43
  v_cvt_pk_f16_f32 v14, v44, v45
  v_cvt_pk_f16_f32 v15, v46, v47
  buffer_store_dwordx4 v[12:15], v7, s[4:7], s17 offen sc1
  s_endpgm
k1_kernel_pf4:
  s_cmp_ge_u32 s2, 504
  s_cbranch_scc1 k1_kernel_end3
  s_getpc_b64 s[4:5]
k1_kernel_pc5:
  s_add_u32 s4, s4, k2_kernel - k1_kernel_pc5
  s_addc_u32 s5, s5, 0
  v_lshlrev_b32 v1, 7, v0
  v_min_u32 v2, code_end - k2_kernel - 4, v1
  global_load_dword v3, v2, s[4:5]
  v_add_u32 v1, 40960, v1
  v_min_u32 v2, code_end - k2_kernel - 4, v1
  global_load_dword v4, v2, s[4:5]
  v_add_u32 v1, 40960, v1
k1_kernel_end3:
  s_endpgm
.globl k2_kernel
.p2align 8
.type k2_kernel,@function
k2_kernel:
  s_cmp_ge_u32 s2, 256
  s_cbranch_scc1 k2_kernel_end1
  s_load_dwordx2 s[4:5], s[0:1], 88
  s_mov_b32 s6, 35930112
  s_mov_b32 s7, 0x20000
  v_lshrrev_b32 v1, 6, v0
  v_and_b32 v2, 63, v0
  v_readfirstlane_b32 s8, v1
  s_bfe_u32 s9, s2, 0x20001
  s_lshl_b32 s9, s9, 2
  s_bfe_u32 s11, s2, 0x20003
  s_add_u32 s9, s9, s11
  s_and_b32 s10, s2, 1
  s_lshl_b32 s10, s10, 3
  s_lshr_b32 s11, s2, 5
  s_add_u32 s10, s10, s11
  s_cmp_ge_u32 s10, 15
  s_cbranch_scc1 k2_kernel_mod3
  s_mov_b32 s13, 0
  s_lshl_b32 s11, s10, 2
  s_add_u32 s11, s11, s8
  s_mul_i32 s11, s11, 40960
  s_add_u32 s11, s11, 2674688
  s_lshl_b32 s12, s9, 2
  s_add_u32 s12, s12, s8
  s_mul_i32 s12, s12, 40960
  s_add_u32 s12, s12, 53248
  v_lshlrev_b32 v4, 4, v2
  v_add_u32 v7, s11, v4
  v_add_u32 v8, s12, v4
  s_mul_i32 s14, s8, 36864
  v_lshlrev_b32 v9, 4, v0
  s_mov_b32 s15, 0
  s_mov_b32 s16, 15360
  s_waitcnt lgkmcnt(0)
  buffer_load_dwordx4 v[12:15], v9, s[4:7], s15 offen
  buffer_load_dwordx4 v[16:19], v9, s[4:7], s16 offen
  v_add_u32 v5, 4096, v4
  s_cmp_lg_u32 s8, 0
  s_cbranch_scc1 k2_kernel_w04
  buffer_load_dwordx4 v[20:23], v5, s[4:7], s15 offen
  buffer_load_dwordx4 v[24:27], v5, s[4:7], s16 offen
k2_kernel_w04:
  s_add_u32 m0, s14, 0
  s_mov_b32 s13, 0
  buffer_load_dwordx4 v7, s[4:7], s13 offen offset:0 lds
  buffer_load_dwordx4 v[92:95], v8, s[4:7], s13 offen offset:0
  buffer_load_dwordx4 v7, s[4:7], s13 offen offset:1024 lds
  buffer_load_dwordx4 v[96:99], v8, s[4:7], s13 offen offset:1024
  buffer_load_dwordx4 v7, s[4:7], s13 offen offset:2048 lds
  buffer_load_dwordx4 v[100:103], v8, s[4:7], s13 offen offset:2048
  buffer_load_dwordx4 v7, s[4:7], s13 offen offset:3072 lds
  buffer_load_dwordx4 v[104:107], v8, s[4:7], s13 offen offset:3072
  s_cmp_ge_u32 s10, 5
  s_cselect_b32 s17, 1.0, 0x3ea52b5c
  v_cmp_le_u32 vcc, 160, v0
  v_mov_b32 v148, 1.0
  v_add_u32 v9, 147456, v9
  v_cndmask_b32 v148, 0, v148, vcc
  v_add_u32 v149, 151552, v4
  s_waitcnt vmcnt(8)
  v_add_f32 v12, v12, v16
  v_add_f32 v13, v13, v17
  v_add_f32 v14, v14, v18
  v_add_f32 v15, v15, v19
  v_cvt_pk_bf16_f32 v16, v12, v13
  v_cvt_pk_bf16_f32 v17, v14, v15
  v_lshlrev_b32 v12, 16, v16
  v_and_b32 v13, 0xffff0000, v16
  v_lshlrev_b32 v14, 16, v17
  v_and_b32 v15, 0xffff0000, v17
  v_add_f32 v12, v148, v12
  v_add_f32 v13, v148, v13
  v_add_f32 v14, v148, v14
  v_add_f32 v15, v148, v15
  v_cvt_pk_bf16_f32 v16, v12, v13
  v_cvt_pk_bf16_f32 v17, v14, v15
  v_lshlrev_b32 v12, 16, v16
  v_and_b32 v13, 0xffff0000, v16
  v_lshlrev_b32 v14, 16, v17
  v_and_b32 v15, 0xffff0000, v17
  v_mul_f32 v12, s17, v12
  v_mul_f32 v13, s17, v13
  v_mul_f32 v14, s17, v14
  v_mul_f32 v15, s17, v15
  ds_write_b128 v9, v[12:15]
  s_cmp_lg_u32 s8, 0
  s_cbranch_scc1 k2_kernel_w15
  v_add_f32 v20, v20, v24
  v_add_f32 v21, v21, v25
  v_add_f32 v22, v22, v26
  v_add_f32 v23, v23, v27
  v_cvt_pk_bf16_f32 v24, v20, v21
  v_cvt_pk_bf16_f32 v25, v22, v23
  v_lshlrev_b32 v20, 16, v24
  v_and_b32 v21, 0xffff0000, v24
  v_lshlrev_b32 v22, 16, v25
  v_and_b32 v23, 0xffff0000, v25
  v_add_f32 v20, 1.0, v20
  v_add_f32 v21, 1.0, v21
  v_add_f32 v22, 1.0, v22
  v_add_f32 v23, 1.0, v23
  v_cvt_pk_bf16_f32 v24, v20, v21
  v_cvt_pk_bf16_f32 v25, v22, v23
  v_lshlrev_b32 v20, 16, v24
  v_and_b32 v21, 0xffff0000, v24
  v_lshlrev_b32 v22, 16, v25
  v_and_b32 v23, 0xffff0000, v25
  v_mul_f32 v20, s17, v20
  v_mul_f32 v21, s17, v21
  v_mul_f32 v22, s17, v22
  v_mul_f32 v23, s17, v23
  ds_write_b128 v149, v[20:23]
k2_kernel_w15:
  v_add_u32 v5, 0x10000, v4
  v_add_u32 v6, 0x20000, v4
  v_lshrrev_b32 v188, 5, v2
  v_lshlrev_b32 v188, 5, v188
  v_add_u32 v188, 147456, v188
  s_waitcnt vmcnt(4) lgkmcnt(0)
  s_barrier
  ds_read_b128 v[156:159], v188 offset:2560
  ds_read_b128 v[172:175], v188 offset:0
  ds_read_b128 v[160:163], v188 offset:2576
  ds_read_b128 v[176:179], v188 offset:16
  ds_read_b128 v[164:167], v188 offset:2624
  ds_read_b128 v[180:183], v188 offset:64
  ds_read_b128 v[168:171], v188 offset:2640
  ds_read_b128 v[184:187], v188 offset:80
  ds_read_b128 v[76:79], v4 offset:0
  ds_read_b128 v[80:83], v4 offset:36864
  ds_read_b128 v[84:87], v5 offset:8192
  ds_read_b128 v[88:91], v5 offset:45056
  s_add_u32 m0, s14, 4096
  s_mov_b32 s13, 4096
  buffer_load_dwordx4 v7, s[4:7], s13 offen offset:0 lds
  buffer_load_dwordx4 v[108:111], v8, s[4:7], s13 offen offset:0
  buffer_load_dwordx4 v7, s[4:7], s13 offen offset:1024 lds
  buffer_load_dwordx4 v[112:115], v8, s[4:7], s13 offen offset:1024
  s_waitcnt lgkmcnt(4)
  v_fma_mix_f32 v148, v92, v156, v172 op_sel:[0,0,0] op_sel_hi:[1,0,0]
  v_fma_mix_f32 v149, v92, v157, v173 op_sel:[1,0,0] op_sel_hi:[1,0,0]
  v_fma_mix_f32 v150, v93, v158, v174 op_sel:[0,0,0] op_sel_hi:[1,0,0]
  v_fma_mix_f32 v151, v93, v159, v175 op_sel:[1,0,0] op_sel_hi:[1,0,0]
  v_fma_mix_f32 v152, v94, v160, v176 op_sel:[0,0,0] op_sel_hi:[1,0,0]
  v_fma_mix_f32 v153, v94, v161, v177 op_sel:[1,0,0] op_sel_hi:[1,0,0]
  v_fma_mix_f32 v154, v95, v162, v178 op_sel:[0,0,0] op_sel_hi:[1,0,0]
  v_fma_mix_f32 v155, v95, v163, v179 op_sel:[1,0,0] op_sel_hi:[1,0,0]
  v_cvt_pk_bf16_f32 v140, v148, v149
  v_cvt_pk_bf16_f32 v141, v150, v151
  v_cvt_pk_bf16_f32 v142, v152, v153
  v_cvt_pk_bf16_f32 v143, v154, v155
  ds_read_b128 v[156:159], v188 offset:2688
  ds_read_b128 v[172:175], v188 offset:128
  ds_read_b128 v[160:163], v188 offset:2704
  ds_read_b128 v[176:179], v188 offset:144
  s_cmp_ge_u32 s10, 10
  s_cbranch_scc1 k2_kernel_vpath2
  s_waitcnt lgkmcnt(7)
  v_mfma_f32_32x32x16_bf16 v[12:27], v[76:79], v[140:143], 0
  ds_read_b128 v[76:79], v4 offset:1024
  v_fma_mix_f32 v148, v96, v164, v180 op_sel:[0,0,0] op_sel_hi:[1,0,0]
  v_fma_mix_f32 v149, v96, v165, v181 op_sel:[1,0,0] op_sel_hi:[1,0,0]
  v_fma_mix_f32 v150, v97, v166, v182 op_sel:[0,0,0] op_sel_hi:[1,0,0]
  v_fma_mix_f32 v151, v97, v167, v183 op_sel:[1,0,0] op_sel_hi:[1,0,0]
  s_waitcnt lgkmcnt(7)
  v_mfma_f32_32x32x16_bf16 v[28:43], v[80:83], v[140:143], 0
  ds_read_b128 v[80:83], v4 offset:37888
  v_fma_mix_f32 v152, v98, v168, v184 op_sel:[0,0,0] op_sel_hi:[1,0,0]
  v_fma_mix_f32 v153, v98, v169, v185 op_sel:[1,0,0] op_sel_hi:[1,0,0]
  v_fma_mix_f32 v154, v99, v170, v186 op_sel:[0,0,0] op_sel_hi:[1,0,0]
  v_fma_mix_f32 v155, v99, v171, v187 op_sel:[1,0,0] op_sel_hi:[1,0,0]
  buffer_load_dwordx4 v7, s[4:7], s13 offen offset:2048 lds
  buffer_load_dwordx4 v[116:119], v8, s[4:7], s13 offen offset:2048
  s_waitcnt lgkmcnt(7)
  v_mfma_f32_32x32x16_bf16 v[44:59], v[84:87], v[140:143], 0
  ds_read_b128 v[84:87], v5 offset:9216
  v_cvt_pk_bf16_f32 v144, v148, v149
  v_cvt_pk_bf16_f32 v145, v150, v151
  v_cvt_pk_bf16_f32 v146, v152, v153
  v_cvt_pk_bf16_f32 v147, v154, v155
  ds_read_b128 v[164:167], v188 offset:2752
  ds_read_b128 v[180:183], v188 offset:192
  s_waitcnt lgkmcnt(9)
  v_mfma_f32_32x32x16_bf16 v[60:75], v[88:91], v[140:143], 0
  ds_read_b128 v[88:91], v5 offset:46080
  ds_read_b128 v[168:171], v188 offset:2768
  ds_read_b128 v[184:187], v188 offset:208
  buffer_load_dwordx4 v7, s[4:7], s13 offen offset:3072 lds
  buffer_load_dwordx4 v[120:123], v8, s[4:7], s13 offen offset:3072
  s_add_u32 m0, s14, 8192
  s_mov_b32 s13, 8192
  buffer_load_dwordx4 v7, s[4:7], s13 offen offset:0 lds
  buffer_load_dwordx4 v[124:127], v8, s[4:7], s13 offen offset:0
  buffer_load_dwordx4 v7, s[4:7], s13 offen offset:1024 lds
  buffer_load_dwordx4 v[128:131], v8, s[4:7], s13 offen offset:1024
  s_waitcnt vmcnt(12)
  s_barrier
  s_waitcnt lgkmcnt(7)
  v_mfma_f32_32x32x16_bf16 v[12:27], v[76:79], v[144:147], v[12:27]
  ds_read_b128 v[76:79], v4 offset:2048
  v_fma_mix_f32 v148, v100, v156, v172 op_sel:[0,0,0] op_sel_hi:[1,0,0]
  v_fma_mix_f32 v149, v100, v157, v173 op_sel:[1,0,0] op_sel_hi:[1,0,0]
  v_fma_mix_f32 v150, v101, v158, v174 op_sel:[0,0,0] op_sel_hi:[1,0,0]
  v_fma_mix_f32 v151, v101, v159, v175 op_sel:[1,0,0] op_sel_hi:[1,0,0]
  s_waitcnt lgkmcnt(7)
  v_mfma_f32_32x32x16_bf16 v[28:43], v[80:83], v[144:147], v[28:43]
  ds_read_b128 v[80:83], v4 offset:38912
  v_fma_mix_f32 v152, v102, v160, v176 op_sel:[0,0,0] op_sel_hi:[1,0,0]
  v_fma_mix_f32 v153, v102, v161, v177 op_sel:[1,0,0] op_sel_hi:[1,0,0]
  v_fma_mix_f32 v154, v103, v162, v178 op_sel:[0,0,0] op_sel_hi:[1,0,0]
  v_fma_mix_f32 v155, v103, v163, v179 op_sel:[1,0,0] op_sel_hi:[1,0,0]
  s_waitcnt lgkmcnt(7)
  v_mfma_f32_32x32x16_bf16 v[44:59], v[84:87], v[144:147], v[44:59]
  ds_read_b128 v[84:87], v5 offset:10240
  v_cvt_pk_bf16_f32 v140, v148, v149
  v_cvt_pk_bf16_f32 v141, v150, v151
  v_cvt_pk_bf16_f32 v142, v152, v153
  v_cvt_pk_bf16_f32 v143, v154, v155
  ds_read_b128 v[156:159], v188 offset:2816
  ds_read_b128 v[172:175], v188 offset:256
  s_waitcnt lgkmcnt(7)
  v_mfma_f32_32x32x16_bf16 v[60:75], v[88:91], v[144:147], v[60:75]
  ds_read_b128 v[88:91], v5 offset:47104
  ds_read_b128 v[160:163], v188 offset:2832
  ds_read_b128 v[176:179], v188 offset:272
  s_waitcnt lgkmcnt(7)
  v_mfma_f32_32x32x16_bf16 v[12:27], v[76:79], v[140:143], v[12:27]
  ds_read_b128 v[76:79], v4 offset:3072
  v_fma_mix_f32 v148, v104, v164, v180 op_sel:[0,0,0] op_sel_hi:[1,0,0]
  v_fma_mix_f32 v149, v104, v165, v181 op_sel:[1,0,0] op_sel_hi:[1,0,0]
  v_fma_mix_f32 v150, v105, v166, v182 op_sel:[0,0,0] op_sel_hi:[1,0,0]
  v_fma_mix_f32 v151, v105, v167, v183 op_sel:[1,0,0] op_sel_hi:[1,0,0]
  s_waitcnt lgkmcnt(7)
  v_mfma_f32_32x32x16_bf16 v[28:43], v[80:83], v[140:143], v[28:43]
  ds_read_b128 v[80:83], v4 offset:39936
  v_fma_mix_f32 v152, v106, v168, v184 op_sel:[0,0,0] op_sel_hi:[1,0,0]
  v_fma_mix_f32 v153, v106, v169, v185 op_sel:[1,0,0] op_sel_hi:[1,0,0]
  v_fma_mix_f32 v154, v107, v170, v186 op_sel:[0,0,0] op_sel_hi:[1,0,0]
  v_fma_mix_f32 v155, v107, v171, v187 op_sel:[1,0,0] op_sel_hi:[1,0,0]
  buffer_load_dwordx4 v7, s[4:7], s13 offen offset:2048 lds
  buffer_load_dwordx4 v[132:135], v8, s[4:7], s13 offen offset:2048
  s_waitcnt lgkmcnt(7)
  v_mfma_f32_32x32x16_bf16 v[44:59], v[84:87], v[140:143], v[44:59]
  ds_read_b128 v[84:87], v5 offset:11264
  v_cvt_pk_bf16_f32 v144, v148, v149
  v_cvt_pk_bf16_f32 v145, v150, v151
  v_cvt_pk_bf16_f32 v146, v152, v153
  v_cvt_pk_bf16_f32 v147, v154, v155
  ds_read_b128 v[164:167], v188 offset:2880
  ds_read_b128 v[180:183], v188 offset:320
  s_waitcnt lgkmcnt(7)
  v_mfma_f32_32x32x16_bf16 v[60:75], v[88:91], v[140:143], v[60:75]
  ds_read_b128 v[88:91], v5 offset:48128
  ds_read_b128 v[168:171], v188 offset:2896
  ds_read_b128 v[184:187], v188 offset:336
  buffer_load_dwordx4 v7, s[4:7], s13 offen offset:3072 lds
  buffer_load_dwordx4 v[136:139], v8, s[4:7], s13 offen offset:3072
  s_add_u32 m0, s14, 12288
  s_mov_b32 s13, 12288
  buffer_load_dwordx4 v7, s[4:7], s13 offen offset:0 lds
  buffer_load_dwordx4 v[92:95], v8, s[4:7], s13 offen offset:0
  buffer_load_dwordx4 v7, s[4:7], s13 offen offset:1024 lds
  buffer_load_dwordx4 v[96:99], v8, s[4:7], s13 offen offset:1024
  s_waitcnt vmcnt(12)
  s_barrier
  s_waitcnt lgkmcnt(7)
  v_mfma_f32_32x32x16_bf16 v[12:27], v[76:79], v[144:147], v[12:27]
  ds_read_b128 v[76:79], v4 offset:4096
  v_fma_mix_f32 v148, v108, v156, v172 op_sel:[0,0,0] op_sel_hi:[1,0,0]
  v_fma_mix_f32 v149, v108, v157, v173 op_sel:[1,0,0] op_sel_hi:[1,0,0]
  v_fma_mix_f32 v150, v109, v158, v174 op_sel:[0,0,0] op_sel_hi:[1,0,0]
  v_fma_mix_f32 v151, v109, v159, v175 op_sel:[1,0,0] op_sel_hi:[1,0,0]
  s_waitcnt lgkmcnt(7)
  v_mfma_f32_32x32x16_bf16 v[28:43], v[80:83], v[144:147], v[28:43]
  ds_read_b128 v[80:83], v4 offset:40960
  v_fma_mix_f32 v152, v110, v160, v176 op_sel:[0,0,0] op_sel_hi:[1,0,0]
  v_fma_mix_f32 v153, v110, v161, v177 op_sel:[1,0,0] op_sel_hi:[1,0,0]
  v_fma_mix_f32 v154, v111, v162, v178 op_sel:[0,0,0] op_sel_hi:[1,0,0]
  v_fma_mix_f32 v155, v111, v163, v179 op_sel:[1,0,0] op_sel_hi:[1,0,0]
  s_waitcnt lgkmcnt(7)
  v_mfma_f32_32x32x16_bf16 v[44:59], v[84:87], v[144:147], v[44:59]
  ds_read_b128 v[84:87], v5 offset:12288
  v_cvt_pk_bf16_f32 v140, v148, v149
  v_cvt_pk_bf16_f32 v141, v150, v151
  v_cvt_pk_bf16_f32 v142, v152, v153
  v_cvt_pk_bf16_f32 v143, v154, v155
  ds_read_b128 v[156:159], v188 offset:2944
  ds_read_b128 v[172:175], v188 offset:384
  s_waitcnt lgkmcnt(7)
  v_mfma_f32_32x32x16_bf16 v[60:75], v[88:91], v[144:147], v[60:75]
  ds_read_b128 v[88:91], v5 offset:49152
  ds_read_b128 v[160:163], v188 offset:2960
  ds_read_b128 v[176:179], v188 offset:400
  s_waitcnt lgkmcnt(7)
  v_mfma_f32_32x32x16_bf16 v[12:27], v[76:79], v[140:143], v[12:27]
  ds_read_b128 v[76:79], v4 offset:5120
  v_fma_mix_f32 v148, v112, v164, v180 op_sel:[0,0,0] op_sel_hi:[1,0,0]
  v_fma_mix_f32 v149, v112, v165, v181 op_sel:[1,0,0] op_sel_hi:[1,0,0]
  v_fma_mix_f32 v150, v113, v166, v182 op_sel:[0,0,0] op_sel_hi:[1,0,0]
  v_fma_mix_f32 v151, v113, v167, v183 op_sel:[1,0,0] op_sel_hi:[1,0,0]
  s_waitcnt lgkmcnt(7)
  v_mfma_f32_32x32x16_bf16 v[28:43], v[80:83], v[140:143], v[28:43]
  ds_read_b128 v[80:83], v4 offset:41984
  v_fma_mix_f32 v152, v114, v168, v184 op_sel:[0,0,0] op_sel_hi:[1,0,0]
  v_fma_mix_f32 v153, v114, v169, v185 op_sel:[1,0,0] op_sel_hi:[1,0,0]
  v_fma_mix_f32 v154, v115, v170, v186 op_sel:[0,0,0] op_sel_hi:[1,0,0]
  v_fma_mix_f32 v155, v115, v171, v187 op_sel:[1,0,0] op_sel_hi:[1,0,0]
  buffer_load_dwordx4 v7, s[4:7], s13 offen offset:2048 lds
  s_waitcnt lgkmcnt(7)
  v_mfma_f32_32x32x16_bf16 v[44:59], v[84:87], v[140:143], v[44:59]
  ds_read_b128 v[84:87], v5 offset:13312
  v_cvt_pk_bf16_f32 v144, v148, v149
  v_cvt_pk_bf16_f32 v145, v150, v151
  v_cvt_pk_bf16_f32 v146, v152, v153
  v_cvt_pk_bf16_f32 v147, v154, v155
  ds_read_b128 v[164:167], v188 offset:3008
  ds_read_b128 v[180:183], v188 offset:448
  s_waitcnt lgkmcnt(7)
  v_mfma_f32_32x32x16_bf16 v[60:75], v[88:91], v[140:143], v[60:75]
  ds_read_b128 v[88:91], v5 offset:50176
  ds_read_b128 v[168:171], v188 offset:3024
  ds_read_b128 v[184:187], v188 offset:464
  buffer_load_dwordx4 v[100:103], v8, s[4:7], s13 offen offset:2048
  s_waitcnt lgkmcnt(7)
  v_mfma_f32_32x32x16_bf16 v[12:27], v[76:79], v[144:147], v[12:27]
  ds_read_b128 v[76:79], v4 offset:6144
  v_fma_mix_f32 v148, v116, v156, v172 op_sel:[0,0,0] op_sel_hi:[1,0,0]
  v_fma_mix_f32 v149, v116, v157, v173 op_sel:[1,0,0] op_sel_hi:[1,0,0]
  v_fma_mix_f32 v150, v117, v158, v174 op_sel:[0,0,0] op_sel_hi:[1,0,0]
  v_fma_mix_f32 v151, v117, v159, v175 op_sel:[1,0,0] op_sel_hi:[1,0,0]
  s_waitcnt lgkmcnt(7)
  v_mfma_f32_32x32x16_bf16 v[28:43], v[80:83], v[144:147], v[28:43]
  ds_read_b128 v[80:83], v4 offset:43008
  v_fma_mix_f32 v152, v118, v160, v176 op_sel:[0,0,0] op_sel_hi:[1,0,0]
  v_fma_mix_f32 v153, v118, v161, v177 op_sel:[1,0,0] op_sel_hi:[1,0,0]
  v_fma_mix_f32 v154, v119, v162, v178 op_sel:[0,0,0] op_sel_hi:[1,0,0]
  v_fma_mix_f32 v155, v119, v163, v179 op_sel:[1,0,0] op_sel_hi:[1,0,0]
  buffer_load_dwordx4 v7, s[4:7], s13 offen offset:3072 lds
  s_waitcnt lgkmcnt(7)
  v_mfma_f32_32x32x16_bf16 v[44:59], v[84:87], v[144:147], v[44:59]
  ds_read_b128 v[84:87], v5 offset:14336
  v_cvt_pk_bf16_f32 v140, v148, v149
  v_cvt_pk_bf16_f32 v141, v150, v151
  v_cvt_pk_bf16_f32 v142, v152, v153
  v_cvt_pk_bf16_f32 v143, v154, v155
  ds_read_b128 v[156:159], v188 offset:3072
  ds_read_b128 v[172:175], v188 offset:512
  s_waitcnt lgkmcnt(7)
  v_mfma_f32_32x32x16_bf16 v[60:75], v[88:91], v[144:147], v[60:75]
  ds_read_b128 v[88:91], v5 offset:51200
  ds_read_b128 v[160:163], v188 offset:3088
  ds_read_b128 v[176:179], v188 offset:528
  buffer_load_dwordx4 v[104:107], v8, s[4:7], s13 offen offset:3072
  s_waitcnt lgkmcnt(7)
  v_mfma_f32_32x32x16_bf16 v[12:27], v[76:79], v[140:143], v[12:27]
  ds_read_b128 v[76:79], v4 offset:7168
  v_fma_mix_f32 v148, v120, v164, v180 op_sel:[0,0,0] op_sel_hi:[1,0,0]
  v_fma_mix_f32 v149, v120, v165, v181 op_sel:[1,0,0] op_sel_hi:[1,0,0]
  v_fma_mix_f32 v150, v121, v166, v182 op_sel:[0,0,0] op_sel_hi:[1,0,0]
  v_fma_mix_f32 v151, v121, v167, v183 op_sel:[1,0,0] op_sel_hi:[1,0,0]
  s_waitcnt lgkmcnt(7)
  v_mfma_f32_32x32x16_bf16 v[28:43], v[80:83], v[140:143], v[28:43]
  ds_read_b128 v[80:83], v4 offset:44032
  v_fma_mix_f32 v152, v122, v168, v184 op_sel:[0,0,0] op_sel_hi:[1,0,0]
  v_fma_mix_f32 v153, v122, v169, v185 op_sel:[1,0,0] op_sel_hi:[1,0,0]
  v_fma_mix_f32 v154, v123, v170, v186 op_sel:[0,0,0] op_sel_hi:[1,0,0]
  v_fma_mix_f32 v155, v123, v171, v187 op_sel:[1,0,0] op_sel_hi:[1,0,0]
  s_add_u32 m0, s14, 16384
  s_mov_b32 s13, 16384
  s_waitcnt lgkmcnt(7)
  v_mfma_f32_32x32x16_bf16 v[44:59], v[84:87], v[140:143], v[44:59]
  ds_read_b128 v[84:87], v5 offset:15360
  v_cvt_pk_bf16_f32 v144, v148, v149
  v_cvt_pk_bf16_f32 v145, v150, v151
  v_cvt_pk_bf16_f32 v146, v152, v153
  v_cvt_pk_bf16_f32 v147, v154, v155
  ds_read_b128 v[164:167], v188 offset:3136
  ds_read_b128 v[180:183], v188 offset:576
  s_waitcnt lgkmcnt(7)
  v_mfma_f32_32x32x16_bf16 v[60:75], v[88:91], v[140:143], v[60:75]
  ds_read_b128 v[88:91], v5 offset:52224
  ds_read_b128 v[168:171], v188 offset:3152
  ds_read_b128 v[184:187], v188 offset:592
  buffer_load_dwordx4 v7, s[4:7], s13 offen offset:0 lds
  buffer_load_dwordx4 v[108:111], v8, s[4:7], s13 offen offset:0
  buffer_load_dwordx4 v7, s[4:7], s13 offen offset:1024 lds
  buffer_load_dwordx4 v[112:115], v8, s[4:7], s13 offen offset:1024
  s_waitcnt vmcnt(12)
  s_barrier
  s_waitcnt lgkmcnt(7)
  v_mfma_f32_32x32x16_bf16 v[12:27], v[76:79], v[144:147], v[12:27]
  ds_read_b128 v[76:79], v4 offset:8192
  v_fma_mix_f32 v148, v124, v156, v172 op_sel:[0,0,0] op_sel_hi:[1,0,0]
  v_fma_mix_f32 v149, v124, v157, v173 op_sel:[1,0,0] op_sel_hi:[1,0,0]
  v_fma_mix_f32 v150, v125, v158, v174 op_sel:[0,0,0] op_sel_hi:[1,0,0]
  v_fma_mix_f32 v151, v125, v159, v175 op_sel:[1,0,0] op_sel_hi:[1,0,0]
  s_waitcnt lgkmcnt(7)
  v_mfma_f32_32x32x16_bf16 v[28:43], v[80:83], v[144:147], v[28:43]
  ds_read_b128 v[80:83], v4 offset:45056
  v_fma_mix_f32 v152, v126, v160, v176 op_sel:[0,0,0] op_sel_hi:[1,0,0]
  v_fma_mix_f32 v153, v126, v161, v177 op_sel:[1,0,0] op_sel_hi:[1,0,0]
  v_fma_mix_f32 v154, v127, v162, v178 op_sel:[0,0,0] op_sel_hi:[1,0,0]
  v_fma_mix_f32 v155, v127, v163, v179 op_sel:[1,0,0] op_sel_hi:[1,0,0]
  s_waitcnt lgkmcnt(7)
  v_mfma_f32_32x32x16_bf16 v[44:59], v[84:87], v[144:147], v[44:59]
  ds_read_b128 v[84:87], v5 offset:16384
  v_cvt_pk_bf16_f32 v140, v148, v149
  v_cvt_pk_bf16_f32 v141, v150, v151
  v_cvt_pk_bf16_f32 v142, v152, v153
  v_cvt_pk_bf16_f32 v143, v154, v155
  ds_read_b128 v[156:159], v188 offset:3200
  ds_read_b128 v[172:175], v188 offset:640
  s_waitcnt lgkmcnt(7)
  v_mfma_f32_32x32x16_bf16 v[60:75], v[88:91], v[144:147], v[60:75]
  ds_read_b128 v[88:91], v5 offset:53248
  ds_read_b128 v[160:163], v188 offset:3216
  ds_read_b128 v[176:179], v188 offset:656
  s_waitcnt lgkmcnt(7)
  v_mfma_f32_32x32x16_bf16 v[12:27], v[76:79], v[140:143], v[12:27]
  ds_read_b128 v[76:79], v4 offset:9216
  v_fma_mix_f32 v148, v128, v164, v180 op_sel:[0,0,0] op_sel_hi:[1,0,0]
  v_fma_mix_f32 v149, v128, v165, v181 op_sel:[1,0,0] op_sel_hi:[1,0,0]
  v_fma_mix_f32 v150, v129, v166, v182 op_sel:[0,0,0] op_sel_hi:[1,0,0]
  v_fma_mix_f32 v151, v129, v167, v183 op_sel:[1,0,0] op_sel_hi:[1,0,0]
  s_waitcnt lgkmcnt(7)
  v_mfma_f32_32x32x16_bf16 v[28:43], v[80:83], v[140:143], v[28:43]
  ds_read_b128 v[80:83], v4 offset:46080
  v_fma_mix_f32 v152, v130, v168, v184 op_sel:[0,0,0] op_sel_hi:[1,0,0]
  v_fma_mix_f32 v153, v130, v169, v185 op_sel:[1,0,0] op_sel_hi:[1,0,0]
  v_fma_mix_f32 v154, v131, v170, v186 op_sel:[0,0,0] op_sel_hi:[1,0,0]
  v_fma_mix_f32 v155, v131, v171, v187 op_sel:[1,0,0] op_sel_hi:[1,0,0]
  buffer_load_dwordx4 v7, s[4:7], s13 offen offset:2048 lds
  s_waitcnt lgkmcnt(7)
  v_mfma_f32_32x32x16_bf16 v[44:59], v[84:87], v[140:143], v[44:59]
  ds_read_b128 v[84:87], v5 offset:17408
  v_cvt_pk_bf16_f32 v144, v148, v149
  v_cvt_pk_bf16_f32 v145, v150, v151
  v_cvt_pk_bf16_f32 v146, v152, v153
  v_cvt_pk_bf16_f32 v147, v154, v155
  ds_read_b128 v[164:167], v188 offset:3264
  ds_read_b128 v[180:183], v188 offset:704
  s_waitcnt lgkmcnt(7)
  v_mfma_f32_32x32x16_bf16 v[60:75], v[88:91], v[140:143], v[60:75]
  ds_read_b128 v[88:91], v5 offset:54272
  ds_read_b128 v[168:171], v188 offset:3280
  ds_read_b128 v[184:187], v188 offset:720
  buffer_load_dwordx4 v[116:119], v8, s[4:7], s13 offen offset:2048
  s_waitcnt lgkmcnt(7)
  v_mfma_f32_32x32x16_bf16 v[12:27], v[76:79], v[144:147], v[12:27]
  ds_read_b128 v[76:79], v4 offset:10240
  v_fma_mix_f32 v148, v132, v156, v172 op_sel:[0,0,0] op_sel_hi:[1,0,0]
  v_fma_mix_f32 v149, v132, v157, v173 op_sel:[1,0,0] op_sel_hi:[1,0,0]
  v_fma_mix_f32 v150, v133, v158, v174 op_sel:[0,0,0] op_sel_hi:[1,0,0]
  v_fma_mix_f32 v151, v133, v159, v175 op_sel:[1,0,0] op_sel_hi:[1,0,0]
  s_waitcnt lgkmcnt(7)
  v_mfma_f32_32x32x16_bf16 v[28:43], v[80:83], v[144:147], v[28:43]
  ds_read_b128 v[80:83], v4 offset:47104
  v_fma_mix_f32 v152, v134, v160, v176 op_sel:[0,0,0] op_sel_hi:[1,0,0]
  v_fma_mix_f32 v153, v134, v161, v177 op_sel:[1,0,0] op_sel_hi:[1,0,0]
  v_fma_mix_f32 v154, v135, v162, v178 op_sel:[0,0,0] op_sel_hi:[1,0,0]
  v_fma_mix_f32 v155, v135, v163, v179 op_sel:[1,0,0] op_sel_hi:[1,0,0]
  buffer_load_dwordx4 v7, s[4:7], s13 offen offset:3072 lds
  s_waitcnt lgkmcnt(7)
  v_mfma_f32_32x32x16_bf16 v[44:59], v[84:87], v[144:147], v[44:59]
  ds_read_b128 v[84:87], v5 offset:18432
  v_cvt_pk_bf16_f32 v140, v148, v149
  v_cvt_pk_bf16_f32 v141, v150, v151
  v_cvt_pk_bf16_f32 v142, v152, v153
  v_cvt_pk_bf16_f32 v143, v154, v155
  ds_read_b128 v[156:159], v188 offset:3328
  ds_read_b128 v[172:175], v188 offset:768
  s_waitcnt lgkmcnt(7)
  v_mfma_f32_32x32x16_bf16 v[60:75], v[88:91], v[144:147], v[60:75]
  ds_read_b128 v[88:91], v5 offset:55296
  ds_read_b128 v[160:163], v188 offset:3344
  ds_read_b128 v[176:179], v188 offset:784
  buffer_load_dwordx4 v[120:123], v8, s[4:7], s13 offen offset:3072
  s_waitcnt lgkmcnt(7)
  v_mfma_f32_32x32x16_bf16 v[12:27], v[76:79], v[140:143], v[12:27]
  ds_read_b128 v[76:79], v4 offset:11264
  v_fma_mix_f32 v148, v136, v164, v180 op_sel:[0,0,0] op_sel_hi:[1,0,0]
  v_fma_mix_f32 v149, v136, v165, v181 op_sel:[1,0,0] op_sel_hi:[1,0,0]
  v_fma_mix_f32 v150, v137, v166, v182 op_sel:[0,0,0] op_sel_hi:[1,0,0]
  v_fma_mix_f32 v151, v137, v167, v183 op_sel:[1,0,0] op_sel_hi:[1,0,0]
  s_waitcnt lgkmcnt(7)
  v_mfma_f32_32x32x16_bf16 v[28:43], v[80:83], v[140:143], v[28:43]
  ds_read_b128 v[80:83], v4 offset:48128
  v_fma_mix_f32 v152, v138, v168, v184 op_sel:[0,0,0] op_sel_hi:[1,0,0]
  v_fma_mix_f32 v153, v138, v169, v185 op_sel:[1,0,0] op_sel_hi:[1,0,0]
  v_fma_mix_f32 v154, v139, v170, v186 op_sel:[0,0,0] op_sel_hi:[1,0,0]
  v_fma_mix_f32 v155, v139, v171, v187 op_sel:[1,0,0] op_sel_hi:[1,0,0]
  s_add_u32 m0, s14, 20480
  s_mov_b32 s13, 20480
  s_waitcnt lgkmcnt(7)
  v_mfma_f32_32x32x16_bf16 v[44:59], v[84:87], v[140:143], v[44:59]
  ds_read_b128 v[84:87], v5 offset:19456
  v_cvt_pk_bf16_f32 v144, v148, v149
  v_cvt_pk_bf16_f32 v145, v150, v151
  v_cvt_pk_bf16_f32 v146, v152, v153
  v_cvt_pk_bf16_f32 v147, v154, v155
  ds_read_b128 v[164:167], v188 offset:3392
  ds_read_b128 v[180:183], v188 offset:832
  s_waitcnt lgkmcnt(7)
  v_mfma_f32_32x32x16_bf16 v[60:75], v[88:91], v[140:143], v[60:75]
  ds_read_b128 v[88:91], v5 offset:56320
  ds_read_b128 v[168:171], v188 offset:3408
  ds_read_b128 v[184:187], v188 offset:848
  buffer_load_dwordx4 v7, s[4:7], s13 offen offset:0 lds
  buffer_load_dwordx4 v[124:127], v8, s[4:7], s13 offen offset:0
  buffer_load_dwordx4 v7, s[4:7], s13 offen offset:1024 lds
  buffer_load_dwordx4 v[128:131], v8, s[4:7], s13 offen offset:1024
  s_waitcnt vmcnt(12)
  s_barrier
  s_waitcnt lgkmcnt(7)
  v_mfma_f32_32x32x16_bf16 v[12:27], v[76:79], v[144:147], v[12:27]
  ds_read_b128 v[76:79], v4 offset:12288
  v_fma_mix_f32 v148, v92, v156, v172 op_sel:[0,0,0] op_sel_hi:[1,0,0]
  v_fma_mix_f32 v149, v92, v157, v173 op_sel:[1,0,0] op_sel_hi:[1,0,0]
  v_fma_mix_f32 v150, v93, v158, v174 op_sel:[0,0,0] op_sel_hi:[1,0,0]
  v_fma_mix_f32 v151, v93, v159, v175 op_sel:[1,0,0] op_sel_hi:[1,0,0]
  s_waitcnt lgkmcnt(7)
  v_mfma_f32_32x32x16_bf16 v[28:43], v[80:83], v[144:147], v[28:43]
  ds_read_b128 v[80:83], v4 offset:49152
  v_fma_mix_f32 v152, v94, v160, v176 op_sel:[0,0,0] op_sel_hi:[1,0,0]
  v_fma_mix_f32 v153, v94, v161, v177 op_sel:[1,0,0] op_sel_hi:[1,0,0]
  v_fma_mix_f32 v154, v95, v162, v178 op_sel:[0,0,0] op_sel_hi:[1,0,0]
  v_fma_mix_f32 v155, v95, v163, v179 op_sel:[1,0,0] op_sel_hi:[1,0,0]
  s_waitcnt lgkmcnt(7)
  v_mfma_f32_32x32x16_bf16 v[44:59], v[84:87], v[144:147], v[44:59]
  ds_read_b128 v[84:87], v5 offset:20480
  v_cvt_pk_bf16_f32 v140, v148, v149
  v_cvt_pk_bf16_f32 v141, v150, v151
  v_cvt_pk_bf16_f32 v142, v152, v153
  v_cvt_pk_bf16_f32 v143, v154, v155
  ds_read_b128 v[156:159], v188 offset:3456
  ds_read_b128 v[172:175], v188 offset:896
  s_waitcnt lgkmcnt(7)
  v_mfma_f32_32x32x16_bf16 v[60:75], v[88:91], v[144:147], v[60:75]
  ds_read_b128 v[88:91], v5 offset:57344
  ds_read_b128 v[160:163], v188 offset:3472
  ds_read_b128 v[176:179], v188 offset:912
  s_waitcnt lgkmcnt(7)
  v_mfma_f32_32x32x16_bf16 v[12:27], v[76:79], v[140:143], v[12:27]
  ds_read_b128 v[76:79], v4 offset:13312
  v_fma_mix_f32 v148, v96, v164, v180 op_sel:[0,0,0] op_sel_hi:[1,0,0]
  v_fma_mix_f32 v149, v96, v165, v181 op_sel:[1,0,0] op_sel_hi:[1,0,0]
  v_fma_mix_f32 v150, v97, v166, v182 op_sel:[0,0,0] op_sel_hi:[1,0,0]
  v_fma_mix_f32 v151, v97, v167, v183 op_sel:[1,0,0] op_sel_hi:[1,0,0]
  s_waitcnt lgkmcnt(7)
  v_mfma_f32_32x32x16_bf16 v[28:43], v[80:83], v[140:143], v[28:43]
  ds_read_b128 v[80:83], v4 offset:50176
  v_fma_mix_f32 v152, v98, v168, v184 op_sel:[0,0,0] op_sel_hi:[1,0,0]
  v_fma_mix_f32 v153, v98, v169, v185 op_sel:[1,0,0] op_sel_hi:[1,0,0]
  v_fma_mix_f32 v154, v99, v170, v186 op_sel:[0,0,0] op_sel_hi:[1,0,0]
  v_fma_mix_f32 v155, v99, v171, v187 op_sel:[1,0,0] op_sel_hi:[1,0,0]
  buffer_load_dwordx4 v7, s[4:7], s13 offen offset:2048 lds
  s_waitcnt lgkmcnt(7)
  v_mfma_f32_32x32x16_bf16 v[44:59], v[84:87], v[140:143], v[44:59]
  ds_read_b128 v[84:87], v5 offset:21504
  v_cvt_pk_bf16_f32 v144, v148, v149
  v_cvt_pk_bf16_f32 v145, v150, v151
  v_cvt_pk_bf16_f32 v146, v152, v153
  v_cvt_pk_bf16_f32 v147, v154, v155
  ds_read_b128 v[164:167], v188 offset:3520
  ds_read_b128 v[180:183], v188 offset:960
  s_waitcnt lgkmcnt(7)
  v_mfma_f32_32x32x16_bf16 v[60:75], v[88:91], v[140:143], v[60:75]
  ds_read_b128 v[88:91], v5 offset:58368
  ds_read_b128 v[168:171], v188 offset:3536
  ds_read_b128 v[184:187], v188 offset:976
  buffer_load_dwordx4 v[132:135], v8, s[4:7], s13 offen offset:2048
  s_waitcnt lgkmcnt(7)
  v_mfma_f32_32x32x16_bf16 v[12:27], v[76:79], v[144:147], v[12:27]
  ds_read_b128 v[76:79], v4 offset:14336
  v_fma_mix_f32 v148, v100, v156, v172 op_sel:[0,0,0] op_sel_hi:[1,0,0]
  v_fma_mix_f32 v149, v100, v157, v173 op_sel:[1,0,0] op_sel_hi:[1,0,0]
  v_fma_mix_f32 v150, v101, v158, v174 op_sel:[0,0,0] op_sel_hi:[1,0,0]
  v_fma_mix_f32 v151, v101, v159, v175 op_sel:[1,0,0] op_sel_hi:[1,0,0]
  s_waitcnt lgkmcnt(7)
  v_mfma_f32_32x32x16_bf16 v[28:43], v[80:83], v[144:147], v[28:43]
  ds_read_b128 v[80:83], v4 offset:51200
  v_fma_mix_f32 v152, v102, v160, v176 op_sel:[0,0,0] op_sel_hi:[1,0,0]
  v_fma_mix_f32 v153, v102, v161, v177 op_sel:[1,0,0] op_sel_hi:[1,0,0]
  v_fma_mix_f32 v154, v103, v162, v178 op_sel:[0,0,0] op_sel_hi:[1,0,0]
  v_fma_mix_f32 v155, v103, v163, v179 op_sel:[1,0,0] op_sel_hi:[1,0,0]
  buffer_load_dwordx4 v7, s[4:7], s13 offen offset:3072 lds
  s_waitcnt lgkmcnt(7)
  v_mfma_f32_32x32x16_bf16 v[44:59], v[84:87], v[144:147], v[44:59]
  ds_read_b128 v[84:87], v5 offset:22528
  v_cvt_pk_bf16_f32 v140, v148, v149
  v_cvt_pk_bf16_f32 v141, v150, v151
  v_cvt_pk_bf16_f32 v142, v152, v153
  v_cvt_pk_bf16_f32 v143, v154, v155
  ds_read_b128 v[156:159], v188 offset:3584
  ds_read_b128 v[172:175], v188 offset:1024
  s_waitcnt lgkmcnt(7)
  v_mfma_f32_32x32x16_bf16 v[60:75], v[88:91], v[144:147], v[60:75]
  ds_read_b128 v[88:91], v5 offset:59392
  ds_read_b128 v[160:163], v188 offset:3600
  ds_read_b128 v[176:179], v188 offset:1040
  buffer_load_dwordx4 v[136:139], v8, s[4:7], s13 offen offset:3072
  s_waitcnt lgkmcnt(7)
  v_mfma_f32_32x32x16_bf16 v[12:27], v[76:79], v[140:143], v[12:27]
  ds_read_b128 v[76:79], v4 offset:15360
  v_fma_mix_f32 v148, v104, v164, v180 op_sel:[0,0,0] op_sel_hi:[1,0,0]
  v_fma_mix_f32 v149, v104, v165, v181 op_sel:[1,0,0] op_sel_hi:[1,0,0]
  v_fma_mix_f32 v150, v105, v166, v182 op_sel:[0,0,0] op_sel_hi:[1,0,0]
  v_fma_mix_f32 v151, v105, v167, v183 op_sel:[1,0,0] op_sel_hi:[1,0,0]
  s_waitcnt lgkmcnt(7)
  v_mfma_f32_32x32x16_bf16 v[28:43], v[80:83], v[140:143], v[28:43]
  ds_read_b128 v[80:83], v4 offset:52224
  v_fma_mix_f32 v152, v106, v168, v184 op_sel:[0,0,0] op_sel_hi:[1,0,0]
  v_fma_mix_f32 v153, v106, v169, v185 op_sel:[1,0,0] op_sel_hi:[1,0,0]
  v_fma_mix_f32 v154, v107, v170, v186 op_sel:[0,0,0] op_sel_hi:[1,0,0]
  v_fma_mix_f32 v155, v107, v171, v187 op_sel:[1,0,0] op_sel_hi:[1,0,0]
  s_add_u32 m0, s14, 24576
  s_mov_b32 s13, 24576
  s_waitcnt lgkmcnt(7)
  v_mfma_f32_32x32x16_bf16 v[44:59], v[84:87], v[140:143], v[44:59]
  ds_read_b128 v[84:87], v5 offset:23552
  v_cvt_pk_bf16_f32 v144, v148, v149
  v_cvt_pk_bf16_f32 v145, v150, v151
  v_cvt_pk_bf16_f32 v146, v152, v153
  v_cvt_pk_bf16_f32 v147, v154, v155
  ds_read_b128 v[164:167], v188 offset:3648
  ds_read_b128 v[180:183], v188 offset:1088
  s_waitcnt lgkmcnt(7)
  v_mfma_f32_32x32x16_bf16 v[60:75], v[88:91], v[140:143], v[60:75]
  ds_read_b128 v[88:91], v5 offset:60416
  ds_read_b128 v[168:171], v188 offset:3664
  ds_read_b128 v[184:187], v188 offset:1104
  buffer_load_dwordx4 v7, s[4:7], s13 offen offset:0 lds
  buffer_load_dwordx4 v[92:95], v8, s[4:7], s13 offen offset:0
  buffer_load_dwordx4 v7, s[4:7], s13 offen offset:1024 lds
  buffer_load_dwordx4 v[96:99], v8, s[4:7], s13 offen offset:1024
  s_waitcnt vmcnt(12)
  s_barrier
  s_waitcnt lgkmcnt(7)
  v_mfma_f32_32x32x16_bf16 v[12:27], v[76:79], v[144:147], v[12:27]
  ds_read_b128 v[76:79], v4 offset:16384
  v_fma_mix_f32 v148, v108, v156, v172 op_sel:[0,0,0] op_sel_hi:[1,0,0]
  v_fma_mix_f32 v149, v108, v157, v173 op_sel:[1,0,0] op_sel_hi:[1,0,0]
  v_fma_mix_f32 v150, v109, v158, v174 op_sel:[0,0,0] op_sel_hi:[1,0,0]
  v_fma_mix_f32 v151, v109, v159, v175 op_sel:[1,0,0] op_sel_hi:[1,0,0]
  s_waitcnt lgkmcnt(7)
  v_mfma_f32_32x32x16_bf16 v[28:43], v[80:83], v[144:147], v[28:43]
  ds_read_b128 v[80:83], v4 offset:53248
  v_fma_mix_f32 v152, v110, v160, v176 op_sel:[0,0,0] op_sel_hi:[1,0,0]
  v_fma_mix_f32 v153, v110, v161, v177 op_sel:[1,0,0] op_sel_hi:[1,0,0]
  v_fma_mix_f32 v154, v111, v162, v178 op_sel:[0,0,0] op_sel_hi:[1,0,0]
  v_fma_mix_f32 v155, v111, v163, v179 op_sel:[1,0,0] op_sel_hi:[1,0,0]
  s_waitcnt lgkmcnt(7)
  v_mfma_f32_32x32x16_bf16 v[44:59], v[84:87], v[144:147], v[44:59]
  ds_read_b128 v[84:87], v5 offset:24576
  v_cvt_pk_bf16_f32 v140, v148, v149
  v_cvt_pk_bf16_f32 v141, v150, v151
  v_cvt_pk_bf16_f32 v142, v152, v153
  v_cvt_pk_bf16_f32 v143, v154, v155
  ds_read_b128 v[156:159], v188 offset:3712
  ds_read_b128 v[172:175], v188 offset:1152
  s_waitcnt lgkmcnt(7)
  v_mfma_f32_32x32x16_bf16 v[60:75], v[88:91], v[144:147], v[60:75]
  ds_read_b128 v[88:91], v5 offset:61440
  ds_read_b128 v[160:163], v188 offset:3728
  ds_read_b128 v[176:179], v188 offset:1168
  s_waitcnt lgkmcnt(7)
  v_mfma_f32_32x32x16_bf16 v[12:27], v[76:79], v[140:143], v[12:27]
  ds_read_b128 v[76:79], v4 offset:17408
  v_fma_mix_f32 v148, v112, v164, v180 op_sel:[0,0,0] op_sel_hi:[1,0,0]
  v_fma_mix_f32 v149, v112, v165, v181 op_sel:[1,0,0] op_sel_hi:[1,0,0]
  v_fma_mix_f32 v150, v113, v166, v182 op_sel:[0,0,0] op_sel_hi:[1,0,0]
  v_fma_mix_f32 v151, v113, v167, v183 op_sel:[1,0,0] op_sel_hi:[1,0,0]
  s_waitcnt lgkmcnt(7)
  v_mfma_f32_32x32x16_bf16 v[28:43], v[80:83], v[140:143], v[28:43]
  ds_read_b128 v[80:83], v4 offset:54272
  v_fma_mix_f32 v152, v114, v168, v184 op_sel:[0,0,0] op_sel_hi:[1,0,0]
  v_fma_mix_f32 v153, v114, v169, v185 op_sel:[1,0,0] op_sel_hi:[1,0,0]
  v_fma_mix_f32 v154, v115, v170, v186 op_sel:[0,0,0] op_sel_hi:[1,0,0]
  v_fma_mix_f32 v155, v115, v171, v187 op_sel:[1,0,0] op_sel_hi:[1,0,0]
  buffer_load_dwordx4 v7, s[4:7], s13 offen offset:2048 lds
  s_waitcnt lgkmcnt(7)
  v_mfma_f32_32x32x16_bf16 v[44:59], v[84:87], v[140:143], v[44:59]
  ds_read_b128 v[84:87], v5 offset:25600
  v_cvt_pk_bf16_f32 v144, v148, v149
  v_cvt_pk_bf16_f32 v145, v150, v151
  v_cvt_pk_bf16_f32 v146, v152, v153
  v_cvt_pk_bf16_f32 v147, v154, v155
  ds_read_b128 v[164:167], v188 offset:3776
  ds_read_b128 v[180:183], v188 offset:1216
  s_waitcnt lgkmcnt(7)
  v_mfma_f32_32x32x16_bf16 v[60:75], v[88:91], v[140:143], v[60:75]
  ds_read_b128 v[88:91], v5 offset:62464
  ds_read_b128 v[168:171], v188 offset:3792
  ds_read_b128 v[184:187], v188 offset:1232
  buffer_load_dwordx4 v[100:103], v8, s[4:7], s13 offen offset:2048
  s_waitcnt lgkmcnt(7)
  v_mfma_f32_32x32x16_bf16 v[12:27], v[76:79], v[144:147], v[12:27]
  ds_read_b128 v[76:79], v4 offset:18432
  v_fma_mix_f32 v148, v116, v156, v172 op_sel:[0,0,0] op_sel_hi:[1,0,0]
  v_fma_mix_f32 v149, v116, v157, v173 op_sel:[1,0,0] op_sel_hi:[1,0,0]
  v_fma_mix_f32 v150, v117, v158, v174 op_sel:[0,0,0] op_sel_hi:[1,0,0]
  v_fma_mix_f32 v151, v117, v159, v175 op_sel:[1,0,0] op_sel_hi:[1,0,0]
  s_waitcnt lgkmcnt(7)
  v_mfma_f32_32x32x16_bf16 v[28:43], v[80:83], v[144:147], v[28:43]
  ds_read_b128 v[80:83], v4 offset:55296
  v_fma_mix_f32 v152, v118, v160, v176 op_sel:[0,0,0] op_sel_hi:[1,0,0]
  v_fma_mix_f32 v153, v118, v161, v177 op_sel:[1,0,0] op_sel_hi:[1,0,0]
  v_fma_mix_f32 v154, v119, v162, v178 op_sel:[0,0,0] op_sel_hi:[1,0,0]
  v_fma_mix_f32 v155, v119, v163, v179 op_sel:[1,0,0] op_sel_hi:[1,0,0]
  buffer_load_dwordx4 v7, s[4:7], s13 offen offset:3072 lds
  s_waitcnt lgkmcnt(7)
  v_mfma_f32_32x32x16_bf16 v[44:59], v[84:87], v[144:147], v[44:59]
  ds_read_b128 v[84:87], v5 offset:26624
  v_cvt_pk_bf16_f32 v140, v148, v149
  v_cvt_pk_bf16_f32 v141, v150, v151
  v_cvt_pk_bf16_f32 v142, v152, v153
  v_cvt_pk_bf16_f32 v143, v154, v155
  ds_read_b128 v[156:159], v188 offset:3840
  ds_read_b128 v[172:175], v188 offset:1280
  s_waitcnt lgkmcnt(7)
  v_mfma_f32_32x32x16_bf16 v[60:75], v[88:91], v[144:147], v[60:75]
  ds_read_b128 v[88:91], v5 offset:63488
  ds_read_b128 v[160:163], v188 offset:3856
  ds_read_b128 v[176:179], v188 offset:1296
  buffer_load_dwordx4 v[104:107], v8, s[4:7], s13 offen offset:3072
  s_waitcnt lgkmcnt(7)
  v_mfma_f32_32x32x16_bf16 v[12:27], v[76:79], v[140:143], v[12:27]
  ds_read_b128 v[76:79], v4 offset:19456
  v_fma_mix_f32 v148, v120, v164, v180 op_sel:[0,0,0] op_sel_hi:[1,0,0]
  v_fma_mix_f32 v149, v120, v165, v181 op_sel:[1,0,0] op_sel_hi:[1,0,0]
  v_fma_mix_f32 v150, v121, v166, v182 op_sel:[0,0,0] op_sel_hi:[1,0,0]
  v_fma_mix_f32 v151, v121, v167, v183 op_sel:[1,0,0] op_sel_hi:[1,0,0]
  s_waitcnt lgkmcnt(7)
  v_mfma_f32_32x32x16_bf16 v[28:43], v[80:83], v[140:143], v[28:43]
  ds_read_b128 v[80:83], v4 offset:56320
  v_fma_mix_f32 v152, v122, v168, v184 op_sel:[0,0,0] op_sel_hi:[1,0,0]
  v_fma_mix_f32 v153, v122, v169, v185 op_sel:[1,0,0] op_sel_hi:[1,0,0]
  v_fma_mix_f32 v154, v123, v170, v186 op_sel:[0,0,0] op_sel_hi:[1,0,0]
  v_fma_mix_f32 v155, v123, v171, v187 op_sel:[1,0,0] op_sel_hi:[1,0,0]
  s_add_u32 m0, s14, 28672
  s_mov_b32 s13, 28672
  s_waitcnt lgkmcnt(7)
  v_mfma_f32_32x32x16_bf16 v[44:59], v[84:87], v[140:143], v[44:59]
  ds_read_b128 v[84:87], v5 offset:27648
  v_cvt_pk_bf16_f32 v144, v148, v149
  v_cvt_pk_bf16_f32 v145, v150, v151
  v_cvt_pk_bf16_f32 v146, v152, v153
  v_cvt_pk_bf16_f32 v147, v154, v155
  ds_read_b128 v[164:167], v188 offset:3904
  ds_read_b128 v[180:183], v188 offset:1344
  s_waitcnt lgkmcnt(7)
  v_mfma_f32_32x32x16_bf16 v[60:75], v[88:91], v[140:143], v[60:75]
  ds_read_b128 v[88:91], v5 offset:64512
  ds_read_b128 v[168:171], v188 offset:3920
  ds_read_b128 v[184:187], v188 offset:1360
  buffer_load_dwordx4 v7, s[4:7], s13 offen offset:0 lds
  buffer_load_dwordx4 v[108:111], v8, s[4:7], s13 offen offset:0
  buffer_load_dwordx4 v7, s[4:7], s13 offen offset:1024 lds
  buffer_load_dwordx4 v[112:115], v8, s[4:7], s13 offen offset:1024
  s_waitcnt vmcnt(12)
  s_barrier
  s_waitcnt lgkmcnt(7)
  v_mfma_f32_32x32x16_bf16 v[12:27], v[76:79], v[144:147], v[12:27]
  ds_read_b128 v[76:79], v4 offset:20480
  v_fma_mix_f32 v148, v124, v156, v172 op_sel:[0,0,0] op_sel_hi:[1,0,0]
  v_fma_mix_f32 v149, v124, v157, v173 op_sel:[1,0,0] op_sel_hi:[1,0,0]
  v_fma_mix_f32 v150, v125, v158, v174 op_sel:[0,0,0] op_sel_hi:[1,0,0]
  v_fma_mix_f32 v151, v125, v159, v175 op_sel:[1,0,0] op_sel_hi:[1,0,0]
  s_waitcnt lgkmcnt(7)
  v_mfma_f32_32x32x16_bf16 v[28:43], v[80:83], v[144:147], v[28:43]
  ds_read_b128 v[80:83], v4 offset:57344
  v_fma_mix_f32 v152, v126, v160, v176 op_sel:[0,0,0] op_sel_hi:[1,0,0]
  v_fma_mix_f32 v153, v126, v161, v177 op_sel:[1,0,0] op_sel_hi:[1,0,0]
  v_fma_mix_f32 v154, v127, v162, v178 op_sel:[0,0,0] op_sel_hi:[1,0,0]
  v_fma_mix_f32 v155, v127, v163, v179 op_sel:[1,0,0] op_sel_hi:[1,0,0]
  s_waitcnt lgkmcnt(7)
  v_mfma_f32_32x32x16_bf16 v[44:59], v[84:87], v[144:147], v[44:59]
  ds_read_b128 v[84:87], v5 offset:28672
  v_cvt_pk_bf16_f32 v140, v148, v149
  v_cvt_pk_bf16_f32 v141, v150, v151
  v_cvt_pk_bf16_f32 v142, v152, v153
  v_cvt_pk_bf16_f32 v143, v154, v155
  ds_read_b128 v[156:159], v188 offset:3968
  ds_read_b128 v[172:175], v188 offset:1408
  s_waitcnt lgkmcnt(7)
  v_mfma_f32_32x32x16_bf16 v[60:75], v[88:91], v[144:147], v[60:75]
  ds_read_b128 v[88:91], v6 offset:0
  ds_read_b128 v[160:163], v188 offset:3984
  ds_read_b128 v[176:179], v188 offset:1424
  s_waitcnt lgkmcnt(7)
  v_mfma_f32_32x32x16_bf16 v[12:27], v[76:79], v[140:143], v[12:27]
  ds_read_b128 v[76:79], v4 offset:21504
  v_fma_mix_f32 v148, v128, v164, v180 op_sel:[0,0,0] op_sel_hi:[1,0,0]
  v_fma_mix_f32 v149, v128, v165, v181 op_sel:[1,0,0] op_sel_hi:[1,0,0]
  v_fma_mix_f32 v150, v129, v166, v182 op_sel:[0,0,0] op_sel_hi:[1,0,0]
  v_fma_mix_f32 v151, v129, v167, v183 op_sel:[1,0,0] op_sel_hi:[1,0,0]
  s_waitcnt lgkmcnt(7)
  v_mfma_f32_32x32x16_bf16 v[28:43], v[80:83], v[140:143], v[28:43]
  ds_read_b128 v[80:83], v4 offset:58368
  v_fma_mix_f32 v152, v130, v168, v184 op_sel:[0,0,0] op_sel_hi:[1,0,0]
  v_fma_mix_f32 v153, v130, v169, v185 op_sel:[1,0,0] op_sel_hi:[1,0,0]
  v_fma_mix_f32 v154, v131, v170, v186 op_sel:[0,0,0] op_sel_hi:[1,0,0]
  v_fma_mix_f32 v155, v131, v171, v187 op_sel:[1,0,0] op_sel_hi:[1,0,0]
  buffer_load_dwordx4 v7, s[4:7], s13 offen offset:2048 lds
  s_waitcnt lgkmcnt(7)
  v_mfma_f32_32x32x16_bf16 v[44:59], v[84:87], v[140:143], v[44:59]
  ds_read_b128 v[84:87], v5 offset:29696
  v_cvt_pk_bf16_f32 v144, v148, v149
  v_cvt_pk_bf16_f32 v145, v150, v151
  v_cvt_pk_bf16_f32 v146, v152, v153
  v_cvt_pk_bf16_f32 v147, v154, v155
  ds_read_b128 v[164:167], v188 offset:4032
  ds_read_b128 v[180:183], v188 offset:1472
  s_waitcnt lgkmcnt(7)
  v_mfma_f32_32x32x16_bf16 v[60:75], v[88:91], v[140:143], v[60:75]
  ds_read_b128 v[88:91], v6 offset:1024
  ds_read_b128 v[168:171], v188 offset:4048
  ds_read_b128 v[184:187], v188 offset:1488
  buffer_load_dwordx4 v[116:119], v8, s[4:7], s13 offen offset:2048
  s_waitcnt lgkmcnt(7)
  v_mfma_f32_32x32x16_bf16 v[12:27], v[76:79], v[144:147], v[12:27]
  ds_read_b128 v[76:79], v4 offset:22528
  v_fma_mix_f32 v148, v132, v156, v172 op_sel:[0,0,0] op_sel_hi:[1,0,0]
  v_fma_mix_f32 v149, v132, v157, v173 op_sel:[1,0,0] op_sel_hi:[1,0,0]
  v_fma_mix_f32 v150, v133, v158, v174 op_sel:[0,0,0] op_sel_hi:[1,0,0]
  v_fma_mix_f32 v151, v133, v159, v175 op_sel:[1,0,0] op_sel_hi:[1,0,0]
  s_waitcnt lgkmcnt(7)
  v_mfma_f32_32x32x16_bf16 v[28:43], v[80:83], v[144:147], v[28:43]
  ds_read_b128 v[80:83], v4 offset:59392
  v_fma_mix_f32 v152, v134, v160, v176 op_sel:[0,0,0] op_sel_hi:[1,0,0]
  v_fma_mix_f32 v153, v134, v161, v177 op_sel:[1,0,0] op_sel_hi:[1,0,0]
  v_fma_mix_f32 v154, v135, v162, v178 op_sel:[0,0,0] op_sel_hi:[1,0,0]
  v_fma_mix_f32 v155, v135, v163, v179 op_sel:[1,0,0] op_sel_hi:[1,0,0]
  buffer_load_dwordx4 v7, s[4:7], s13 offen offset:3072 lds
  s_waitcnt lgkmcnt(7)
  v_mfma_f32_32x32x16_bf16 v[44:59], v[84:87], v[144:147], v[44:59]
  ds_read_b128 v[84:87], v5 offset:30720
  v_cvt_pk_bf16_f32 v140, v148, v149
  v_cvt_pk_bf16_f32 v141, v150, v151
  v_cvt_pk_bf16_f32 v142, v152, v153
  v_cvt_pk_bf16_f32 v143, v154, v155
  ds_read_b128 v[156:159], v188 offset:4096
  ds_read_b128 v[172:175], v188 offset:1536
  s_waitcnt lgkmcnt(7)
  v_mfma_f32_32x32x16_bf16 v[60:75], v[88:91], v[144:147], v[60:75]
  ds_read_b128 v[88:91], v6 offset:2048
  ds_read_b128 v[160:163], v188 offset:4112
  ds_read_b128 v[176:179], v188 offset:1552
  buffer_load_dwordx4 v[120:123], v8, s[4:7], s13 offen offset:3072
  s_waitcnt lgkmcnt(7)
  v_mfma_f32_32x32x16_bf16 v[12:27], v[76:79], v[140:143], v[12:27]
  ds_read_b128 v[76:79], v4 offset:23552
  v_fma_mix_f32 v148, v136, v164, v180 op_sel:[0,0,0] op_sel_hi:[1,0,0]
  v_fma_mix_f32 v149, v136, v165, v181 op_sel:[1,0,0] op_sel_hi:[1,0,0]
  v_fma_mix_f32 v150, v137, v166, v182 op_sel:[0,0,0] op_sel_hi:[1,0,0]
  v_fma_mix_f32 v151, v137, v167, v183 op_sel:[1,0,0] op_sel_hi:[1,0,0]
  s_waitcnt lgkmcnt(7)
  v_mfma_f32_32x32x16_bf16 v[28:43], v[80:83], v[140:143], v[28:43]
  ds_read_b128 v[80:83], v4 offset:60416
  v_fma_mix_f32 v152, v138, v168, v184 op_sel:[0,0,0] op_sel_hi:[1,0,0]
  v_fma_mix_f32 v153, v138, v169, v185 op_sel:[1,0,0] op_sel_hi:[1,0,0]
  v_fma_mix_f32 v154, v139, v170, v186 op_sel:[0,0,0] op_sel_hi:[1,0,0]
  v_fma_mix_f32 v155, v139, v171, v187 op_sel:[1,0,0] op_sel_hi:[1,0,0]
  s_add_u32 m0, s14, 32768
  s_mov_b32 s13, 32768
  s_waitcnt lgkmcnt(7)
  v_mfma_f32_32x32x16_bf16 v[44:59], v[84:87], v[140:143], v[44:59]
  ds_read_b128 v[84:87], v5 offset:31744
  v_cvt_pk_bf16_f32 v144, v148, v149
  v_cvt_pk_bf16_f32 v145, v150, v151
  v_cvt_pk_bf16_f32 v146, v152, v153
  v_cvt_pk_bf16_f32 v147, v154, v155
  ds_read_b128 v[164:167], v188 offset:4160
  ds_read_b128 v[180:183], v188 offset:1600
  s_waitcnt lgkmcnt(7)
  v_mfma_f32_32x32x16_bf16 v[60:75], v[88:91], v[140:143], v[60:75]
  ds_read_b128 v[88:91], v6 offset:3072
  ds_read_b128 v[168:171], v188 offset:4176
  ds_read_b128 v[184:187], v188 offset:1616
  buffer_load_dwordx4 v7, s[4:7], s13 offen offset:0 lds
  buffer_load_dwordx4 v[124:127], v8, s[4:7], s13 offen offset:0
  buffer_load_dwordx4 v7, s[4:7], s13 offen offset:1024 lds
  buffer_load_dwordx4 v[128:131], v8, s[4:7], s13 offen offset:1024
  s_waitcnt vmcnt(12)
  s_barrier
  s_waitcnt lgkmcnt(7)
  v_mfma_f32_32x32x16_bf16 v[12:27], v[76:79], v[144:147], v[12:27]
  ds_read_b128 v[76:79], v4 offset:24576
  v_fma_mix_f32 v148, v92, v156, v172 op_sel:[0,0,0] op_sel_hi:[1,0,0]
  v_fma_mix_f32 v149, v92, v157, v173 op_sel:[1,0,0] op_sel_hi:[1,0,0]
  v_fma_mix_f32 v150, v93, v158, v174 op_sel:[0,0,0] op_sel_hi:[1,0,0]
  v_fma_mix_f32 v151, v93, v159, v175 op_sel:[1,0,0] op_sel_hi:[1,0,0]
  s_waitcnt lgkmcnt(7)
  v_mfma_f32_32x32x16_bf16 v[28:43], v[80:83], v[144:147], v[28:43]
  ds_read_b128 v[80:83], v4 offset:61440
  v_fma_mix_f32 v152, v94, v160, v176 op_sel:[0,0,0] op_sel_hi:[1,0,0]
  v_fma_mix_f32 v153, v94, v161, v177 op_sel:[1,0,0] op_sel_hi:[1,0,0]
  v_fma_mix_f32 v154, v95, v162, v178 op_sel:[0,0,0] op_sel_hi:[1,0,0]
  v_fma_mix_f32 v155, v95, v163, v179 op_sel:[1,0,0] op_sel_hi:[1,0,0]
  s_waitcnt lgkmcnt(7)
  v_mfma_f32_32x32x16_bf16 v[44:59], v[84:87], v[144:147], v[44:59]
  ds_read_b128 v[84:87], v5 offset:32768
  v_cvt_pk_bf16_f32 v140, v148, v149
  v_cvt_pk_bf16_f32 v141, v150, v151
  v_cvt_pk_bf16_f32 v142, v152, v153
  v_cvt_pk_bf16_f32 v143, v154, v155
  ds_read_b128 v[156:159], v188 offset:4224
  ds_read_b128 v[172:175], v188 offset:1664
  s_waitcnt lgkmcnt(7)
  v_mfma_f32_32x32x16_bf16 v[60:75], v[88:91], v[144:147], v[60:75]
  ds_read_b128 v[88:91], v6 offset:4096
  ds_read_b128 v[160:163], v188 offset:4240
  ds_read_b128 v[176:179], v188 offset:1680
  s_waitcnt lgkmcnt(7)
  v_mfma_f32_32x32x16_bf16 v[12:27], v[76:79], v[140:143], v[12:27]
  ds_read_b128 v[76:79], v4 offset:25600
  v_fma_mix_f32 v148, v96, v164, v180 op_sel:[0,0,0] op_sel_hi:[1,0,0]
  v_fma_mix_f32 v149, v96, v165, v181 op_sel:[1,0,0] op_sel_hi:[1,0,0]
  v_fma_mix_f32 v150, v97, v166, v182 op_sel:[0,0,0] op_sel_hi:[1,0,0]
  v_fma_mix_f32 v151, v97, v167, v183 op_sel:[1,0,0] op_sel_hi:[1,0,0]
  s_waitcnt lgkmcnt(7)
  v_mfma_f32_32x32x16_bf16 v[28:43], v[80:83], v[140:143], v[28:43]
  ds_read_b128 v[80:83], v4 offset:62464
  v_fma_mix_f32 v152, v98, v168, v184 op_sel:[0,0,0] op_sel_hi:[1,0,0]
  v_fma_mix_f32 v153, v98, v169, v185 op_sel:[1,0,0] op_sel_hi:[1,0,0]
  v_fma_mix_f32 v154, v99, v170, v186 op_sel:[0,0,0] op_sel_hi:[1,0,0]
  v_fma_mix_f32 v155, v99, v171, v187 op_sel:[1,0,0] op_sel_hi:[1,0,0]
  buffer_load_dwordx4 v7, s[4:7], s13 offen offset:2048 lds
  s_waitcnt lgkmcnt(7)
  v_mfma_f32_32x32x16_bf16 v[44:59], v[84:87], v[140:143], v[44:59]
  ds_read_b128 v[84:87], v5 offset:33792
  v_cvt_pk_bf16_f32 v144, v148, v149
  v_cvt_pk_bf16_f32 v145, v150, v151
  v_cvt_pk_bf16_f32 v146, v152, v153
  v_cvt_pk_bf16_f32 v147, v154, v155
  ds_read_b128 v[164:167], v188 offset:4288
  ds_read_b128 v[180:183], v188 offset:1728
  s_waitcnt lgkmcnt(7)
  v_mfma_f32_32x32x16_bf16 v[60:75], v[88:91], v[140:143], v[60:75]
  ds_read_b128 v[88:91], v6 offset:5120
  ds_read_b128 v[168:171], v188 offset:4304
  ds_read_b128 v[184:187], v188 offset:1744
  buffer_load_dwordx4 v[132:135], v8, s[4:7], s13 offen offset:2048
  s_waitcnt lgkmcnt(7)
  v_mfma_f32_32x32x16_bf16 v[12:27], v[76:79], v[144:147], v[12:27]
  ds_read_b128 v[76:79], v4 offset:26624
  v_fma_mix_f32 v148, v100, v156, v172 op_sel:[0,0,0] op_sel_hi:[1,0,0]
  v_fma_mix_f32 v149, v100, v157, v173 op_sel:[1,0,0] op_sel_hi:[1,0,0]
  v_fma_mix_f32 v150, v101, v158, v174 op_sel:[0,0,0] op_sel_hi:[1,0,0]
  v_fma_mix_f32 v151, v101, v159, v175 op_sel:[1,0,0] op_sel_hi:[1,0,0]
  s_waitcnt lgkmcnt(7)
  v_mfma_f32_32x32x16_bf16 v[28:43], v[80:83], v[144:147], v[28:43]
  ds_read_b128 v[80:83], v4 offset:63488
  v_fma_mix_f32 v152, v102, v160, v176 op_sel:[0,0,0] op_sel_hi:[1,0,0]
  v_fma_mix_f32 v153, v102, v161, v177 op_sel:[1,0,0] op_sel_hi:[1,0,0]
  v_fma_mix_f32 v154, v103, v162, v178 op_sel:[0,0,0] op_sel_hi:[1,0,0]
  v_fma_mix_f32 v155, v103, v163, v179 op_sel:[1,0,0] op_sel_hi:[1,0,0]
  buffer_load_dwordx4 v7, s[4:7], s13 offen offset:3072 lds
  s_waitcnt lgkmcnt(7)
  v_mfma_f32_32x32x16_bf16 v[44:59], v[84:87], v[144:147], v[44:59]
  ds_read_b128 v[84:87], v5 offset:34816
  v_cvt_pk_bf16_f32 v140, v148, v149
  v_cvt_pk_bf16_f32 v141, v150, v151
  v_cvt_pk_bf16_f32 v142, v152, v153
  v_cvt_pk_bf16_f32 v143, v154, v155
  ds_read_b128 v[156:159], v188 offset:4352
  ds_read_b128 v[172:175], v188 offset:1792
  s_waitcnt lgkmcnt(7)
  v_mfma_f32_32x32x16_bf16 v[60:75], v[88:91], v[144:147], v[60:75]
  ds_read_b128 v[88:91], v6 offset:6144
  ds_read_b128 v[160:163], v188 offset:4368
  ds_read_b128 v[176:179], v188 offset:1808
  buffer_load_dwordx4 v[136:139], v8, s[4:7], s13 offen offset:3072
  s_waitcnt lgkmcnt(7)
  v_mfma_f32_32x32x16_bf16 v[12:27], v[76:79], v[140:143], v[12:27]
  ds_read_b128 v[76:79], v4 offset:27648
  v_fma_mix_f32 v148, v104, v164, v180 op_sel:[0,0,0] op_sel_hi:[1,0,0]
  v_fma_mix_f32 v149, v104, v165, v181 op_sel:[1,0,0] op_sel_hi:[1,0,0]
  v_fma_mix_f32 v150, v105, v166, v182 op_sel:[0,0,0] op_sel_hi:[1,0,0]
  v_fma_mix_f32 v151, v105, v167, v183 op_sel:[1,0,0] op_sel_hi:[1,0,0]
  s_waitcnt lgkmcnt(7)
  v_mfma_f32_32x32x16_bf16 v[28:43], v[80:83], v[140:143], v[28:43]
  ds_read_b128 v[80:83], v4 offset:64512
  v_fma_mix_f32 v152, v106, v168, v184 op_sel:[0,0,0] op_sel_hi:[1,0,0]
  v_fma_mix_f32 v153, v106, v169, v185 op_sel:[1,0,0] op_sel_hi:[1,0,0]
  v_fma_mix_f32 v154, v107, v170, v186 op_sel:[0,0,0] op_sel_hi:[1,0,0]
  v_fma_mix_f32 v155, v107, v171, v187 op_sel:[1,0,0] op_sel_hi:[1,0,0]
  s_add_u32 m0, s14, 0
  s_mov_b32 s13, 36864
  s_waitcnt lgkmcnt(7)
  v_mfma_f32_32x32x16_bf16 v[44:59], v[84:87], v[140:143], v[44:59]
  ds_read_b128 v[84:87], v5 offset:35840
  v_cvt_pk_bf16_f32 v144, v148, v149
  v_cvt_pk_bf16_f32 v145, v150, v151
  v_cvt_pk_bf16_f32 v146, v152, v153
  v_cvt_pk_bf16_f32 v147, v154, v155
  ds_read_b128 v[164:167], v188 offset:4416
  ds_read_b128 v[180:183], v188 offset:1856
  s_waitcnt lgkmcnt(7)
  v_mfma_f32_32x32x16_bf16 v[60:75], v[88:91], v[140:143], v[60:75]
  ds_read_b128 v[88:91], v6 offset:7168
  ds_read_b128 v[168:171], v188 offset:4432
  ds_read_b128 v[184:187], v188 offset:1872
  buffer_load_dwordx4 v7, s[4:7], s13 offen offset:0 lds
  buffer_load_dwordx4 v[92:95], v8, s[4:7], s13 offen offset:0
  buffer_load_dwordx4 v7, s[4:7], s13 offen offset:1024 lds
  buffer_load_dwordx4 v[96:99], v8, s[4:7], s13 offen offset:1024
  s_waitcnt vmcnt(12)
  s_barrier
  s_waitcnt lgkmcnt(7)
  v_mfma_f32_32x32x16_bf16 v[12:27], v[76:79], v[144:147], v[12:27]
  ds_read_b128 v[76:79], v4 offset:28672
  v_fma_mix_f32 v148, v108, v156, v172 op_sel:[0,0,0] op_sel_hi:[1,0,0]
  v_fma_mix_f32 v149, v108, v157, v173 op_sel:[1,0,0] op_sel_hi:[1,0,0]
  v_fma_mix_f32 v150, v109, v158, v174 op_sel:[0,0,0] op_sel_hi:[1,0,0]
  v_fma_mix_f32 v151, v109, v159, v175 op_sel:[1,0,0] op_sel_hi:[1,0,0]
  s_waitcnt lgkmcnt(7)
  v_mfma_f32_32x32x16_bf16 v[28:43], v[80:83], v[144:147], v[28:43]
  ds_read_b128 v[80:83], v5 offset:0
  v_fma_mix_f32 v152, v110, v160, v176 op_sel:[0,0,0] op_sel_hi:[1,0,0]
  v_fma_mix_f32 v153, v110, v161, v177 op_sel:[1,0,0] op_sel_hi:[1,0,0]
  v_fma_mix_f32 v154, v111, v162, v178 op_sel:[0,0,0] op_sel_hi:[1,0,0]
  v_fma_mix_f32 v155, v111, v163, v179 op_sel:[1,0,0] op_sel_hi:[1,0,0]
  s_waitcnt lgkmcnt(7)
  v_mfma_f32_32x32x16_bf16 v[44:59], v[84:87], v[144:147], v[44:59]
  ds_read_b128 v[84:87], v5 offset:36864
  v_cvt_pk_bf16_f32 v140, v148, v149
  v_cvt_pk_bf16_f32 v141, v150, v151
  v_cvt_pk_bf16_f32 v142, v152, v153
  v_cvt_pk_bf16_f32 v143, v154, v155
  ds_read_b128 v[156:159], v188 offset:4480
  ds_read_b128 v[172:175], v188 offset:1920
  s_waitcnt lgkmcnt(7)
  v_mfma_f32_32x32x16_bf16 v[60:75], v[88:91], v[144:147], v[60:75]
  ds_read_b128 v[88:91], v6 offset:8192
  ds_read_b128 v[160:163], v188 offset:4496
  ds_read_b128 v[176:179], v188 offset:1936
  s_waitcnt lgkmcnt(7)
  v_mfma_f32_32x32x16_bf16 v[12:27], v[76:79], v[140:143], v[12:27]
  ds_read_b128 v[76:79], v4 offset:29696
  v_fma_mix_f32 v148, v112, v164, v180 op_sel:[0,0,0] op_sel_hi:[1,0,0]
  v_fma_mix_f32 v149, v112, v165, v181 op_sel:[1,0,0] op_sel_hi:[1,0,0]
  v_fma_mix_f32 v150, v113, v166, v182 op_sel:[0,0,0] op_sel_hi:[1,0,0]
  v_fma_mix_f32 v151, v113, v167, v183 op_sel:[1,0,0] op_sel_hi:[1,0,0]
  s_waitcnt lgkmcnt(7)
  v_mfma_f32_32x32x16_bf16 v[28:43], v[80:83], v[140:143], v[28:43]
  ds_read_b128 v[80:83], v5 offset:1024
  v_fma_mix_f32 v152, v114, v168, v184 op_sel:[0,0,0] op_sel_hi:[1,0,0]
  v_fma_mix_f32 v153, v114, v169, v185 op_sel:[1,0,0] op_sel_hi:[1,0,0]
  v_fma_mix_f32 v154, v115, v170, v186 op_sel:[0,0,0] op_sel_hi:[1,0,0]
  v_fma_mix_f32 v155, v115, v171, v187 op_sel:[1,0,0] op_sel_hi:[1,0,0]
  buffer_load_dwordx4 v7, s[4:7], s13 offen offset:2048 lds
  s_waitcnt lgkmcnt(7)
  v_mfma_f32_32x32x16_bf16 v[44:59], v[84:87], v[140:143], v[44:59]
  ds_read_b128 v[84:87], v5 offset:37888
  v_cvt_pk_bf16_f32 v144, v148, v149
  v_cvt_pk_bf16_f32 v145, v150, v151
  v_cvt_pk_bf16_f32 v146, v152, v153
  v_cvt_pk_bf16_f32 v147, v154, v155
  ds_read_b128 v[164:167], v188 offset:4544
  ds_read_b128 v[180:183], v188 offset:1984
  s_waitcnt lgkmcnt(7)
  v_mfma_f32_32x32x16_bf16 v[60:75], v[88:91], v[140:143], v[60:75]
  ds_read_b128 v[88:91], v6 offset:9216
  ds_read_b128 v[168:171], v188 offset:4560
  ds_read_b128 v[184:187], v188 offset:2000
  buffer_load_dwordx4 v[100:103], v8, s[4:7], s13 offen offset:2048
  s_waitcnt lgkmcnt(7)
  v_mfma_f32_32x32x16_bf16 v[12:27], v[76:79], v[144:147], v[12:27]
  ds_read_b128 v[76:79], v4 offset:30720
  v_fma_mix_f32 v148, v116, v156, v172 op_sel:[0,0,0] op_sel_hi:[1,0,0]
  v_fma_mix_f32 v149, v116, v157, v173 op_sel:[1,0,0] op_sel_hi:[1,0,0]
  v_fma_mix_f32 v150, v117, v158, v174 op_sel:[0,0,0] op_sel_hi:[1,0,0]
  v_fma_mix_f32 v151, v117, v159, v175 op_sel:[1,0,0] op_sel_hi:[1,0,0]
  s_waitcnt lgkmcnt(7)
  v_mfma_f32_32x32x16_bf16 v[28:43], v[80:83], v[144:147], v[28:43]
  ds_read_b128 v[80:83], v5 offset:2048
  v_fma_mix_f32 v152, v118, v160, v176 op_sel:[0,0,0] op_sel_hi:[1,0,0]
  v_fma_mix_f32 v153, v118, v161, v177 op_sel:[1,0,0] op_sel_hi:[1,0,0]
  v_fma_mix_f32 v154, v119, v162, v178 op_sel:[0,0,0] op_sel_hi:[1,0,0]
  v_fma_mix_f32 v155, v119, v163, v179 op_sel:[1,0,0] op_sel_hi:[1,0,0]
  buffer_load_dwordx4 v7, s[4:7], s13 offen offset:3072 lds
  s_waitcnt lgkmcnt(7)
  v_mfma_f32_32x32x16_bf16 v[44:59], v[84:87], v[144:147], v[44:59]
  ds_read_b128 v[84:87], v5 offset:38912
  v_cvt_pk_bf16_f32 v140, v148, v149
  v_cvt_pk_bf16_f32 v141, v150, v151
  v_cvt_pk_bf16_f32 v142, v152, v153
  v_cvt_pk_bf16_f32 v143, v154, v155
  ds_read_b128 v[156:159], v188 offset:4608
  ds_read_b128 v[172:175], v188 offset:2048
  s_waitcnt lgkmcnt(7)
  v_mfma_f32_32x32x16_bf16 v[60:75], v[88:91], v[144:147], v[60:75]
  ds_read_b128 v[88:91], v6 offset:10240
  ds_read_b128 v[160:163], v188 offset:4624
  ds_read_b128 v[176:179], v188 offset:2064
  buffer_load_dwordx4 v[104:107], v8, s[4:7], s13 offen offset:3072
  s_waitcnt lgkmcnt(7)
  v_mfma_f32_32x32x16_bf16 v[12:27], v[76:79], v[140:143], v[12:27]
  ds_read_b128 v[76:79], v4 offset:31744
  v_fma_mix_f32 v148, v120, v164, v180 op_sel:[0,0,0] op_sel_hi:[1,0,0]
  v_fma_mix_f32 v149, v120, v165, v181 op_sel:[1,0,0] op_sel_hi:[1,0,0]
  v_fma_mix_f32 v150, v121, v166, v182 op_sel:[0,0,0] op_sel_hi:[1,0,0]
  v_fma_mix_f32 v151, v121, v167, v183 op_sel:[1,0,0] op_sel_hi:[1,0,0]
  s_waitcnt lgkmcnt(7)
  v_mfma_f32_32x32x16_bf16 v[28:43], v[80:83], v[140:143], v[28:43]
  ds_read_b128 v[80:83], v5 offset:3072
  v_fma_mix_f32 v152, v122, v168, v184 op_sel:[0,0,0] op_sel_hi:[1,0,0]
  v_fma_mix_f32 v153, v122, v169, v185 op_sel:[1,0,0] op_sel_hi:[1,0,0]
  v_fma_mix_f32 v154, v123, v170, v186 op_sel:[0,0,0] op_sel_hi:[1,0,0]
  v_fma_mix_f32 v155, v123, v171, v187 op_sel:[1,0,0] op_sel_hi:[1,0,0]
  s_waitcnt lgkmcnt(7)
  v_mfma_f32_32x32x16_bf16 v[44:59], v[84:87], v[140:143], v[44:59]
  ds_read_b128 v[84:87], v5 offset:39936
  v_cvt_pk_bf16_f32 v144, v148, v149
  v_cvt_pk_bf16_f32 v145, v150, v151
  v_cvt_pk_bf16_f32 v146, v152, v153
  v_cvt_pk_bf16_f32 v147, v154, v155
  ds_read_b128 v[164:167], v188 offset:4672
  ds_read_b128 v[180:183], v188 offset:2112
  s_waitcnt lgkmcnt(7)
  v_mfma_f32_32x32x16_bf16 v[60:75], v[88:91], v[140:143], v[60:75]
  ds_read_b128 v[88:91], v6 offset:11264
  ds_read_b128 v[168:171], v188 offset:4688
  ds_read_b128 v[184:187], v188 offset:2128
  s_waitcnt vmcnt(8)
  s_barrier
  s_waitcnt lgkmcnt(7)
  v_mfma_f32_32x32x16_bf16 v[12:27], v[76:79], v[144:147], v[12:27]
  ds_read_b128 v[76:79], v4 offset:32768
  v_fma_mix_f32 v148, v124, v156, v172 op_sel:[0,0,0] op_sel_hi:[1,0,0]
  v_fma_mix_f32 v149, v124, v157, v173 op_sel:[1,0,0] op_sel_hi:[1,0,0]
  v_fma_mix_f32 v150, v125, v158, v174 op_sel:[0,0,0] op_sel_hi:[1,0,0]
  v_fma_mix_f32 v151, v125, v159, v175 op_sel:[1,0,0] op_sel_hi:[1,0,0]
  s_waitcnt lgkmcnt(7)
  v_mfma_f32_32x32x16_bf16 v[28:43], v[80:83], v[144:147], v[28:43]
  ds_read_b128 v[80:83], v5 offset:4096
  v_fma_mix_f32 v152, v126, v160, v176 op_sel:[0,0,0] op_sel_hi:[1,0,0]
  v_fma_mix_f32 v153, v126, v161, v177 op_sel:[1,0,0] op_sel_hi:[1,0,0]
  v_fma_mix_f32 v154, v127, v162, v178 op_sel:[0,0,0] op_sel_hi:[1,0,0]
  v_fma_mix_f32 v155, v127, v163, v179 op_sel:[1,0,0] op_sel_hi:[1,0,0]
  s_waitcnt lgkmcnt(7)
  v_mfma_f32_32x32x16_bf16 v[44:59], v[84:87], v[144:147], v[44:59]
  ds_read_b128 v[84:87], v5 offset:40960
  v_cvt_pk_bf16_f32 v140, v148, v149
  v_cvt_pk_bf16_f32 v141, v150, v151
  v_cvt_pk_bf16_f32 v142, v152, v153
  v_cvt_pk_bf16_f32 v143, v154, v155
  ds_read_b128 v[156:159], v188 offset:4736
  ds_read_b128 v[172:175], v188 offset:2176
  s_waitcnt lgkmcnt(7)
  v_mfma_f32_32x32x16_bf16 v[60:75], v[88:91], v[144:147], v[60:75]
  ds_read_b128 v[88:91], v6 offset:12288
  ds_read_b128 v[160:163], v188 offset:4752
  ds_read_b128 v[176:179], v188 offset:2192
  s_waitcnt lgkmcnt(7)
  v_mfma_f32_32x32x16_bf16 v[12:27], v[76:79], v[140:143], v[12:27]
  ds_read_b128 v[76:79], v4 offset:33792
  v_fma_mix_f32 v148, v128, v164, v180 op_sel:[0,0,0] op_sel_hi:[1,0,0]
  v_fma_mix_f32 v149, v128, v165, v181 op_sel:[1,0,0] op_sel_hi:[1,0,0]
  v_fma_mix_f32 v150, v129, v166, v182 op_sel:[0,0,0] op_sel_hi:[1,0,0]
  v_fma_mix_f32 v151, v129, v167, v183 op_sel:[1,0,0] op_sel_hi:[1,0,0]
  s_waitcnt lgkmcnt(7)
  v_mfma_f32_32x32x16_bf16 v[28:43], v[80:83], v[140:143], v[28:43]
  ds_read_b128 v[80:83], v5 offset:5120
  v_fma_mix_f32 v152, v130, v168, v184 op_sel:[0,0,0] op_sel_hi:[1,0,0]
  v_fma_mix_f32 v153, v130, v169, v185 op_sel:[1,0,0] op_sel_hi:[1,0,0]
  v_fma_mix_f32 v154, v131, v170, v186 op_sel:[0,0,0] op_sel_hi:[1,0,0]
  v_fma_mix_f32 v155, v131, v171, v187 op_sel:[1,0,0] op_sel_hi:[1,0,0]
  s_waitcnt lgkmcnt(7)
  v_mfma_f32_32x32x16_bf16 v[44:59], v[84:87], v[140:143], v[44:59]
  ds_read_b128 v[84:87], v5 offset:41984
  v_cvt_pk_bf16_f32 v144, v148, v149
  v_cvt_pk_bf16_f32 v145, v150, v151
  v_cvt_pk_bf16_f32 v146, v152, v153
  v_cvt_pk_bf16_f32 v147, v154, v155
  ds_read_b128 v[164:167], v188 offset:4800
  ds_read_b128 v[180:183], v188 offset:2240
  s_waitcnt lgkmcnt(7)
  v_mfma_f32_32x32x16_bf16 v[60:75], v[88:91], v[140:143], v[60:75]
  ds_read_b128 v[88:91], v6 offset:13312
  ds_read_b128 v[168:171], v188 offset:4816
  ds_read_b128 v[184:187], v188 offset:2256
  s_waitcnt lgkmcnt(7)
  v_mfma_f32_32x32x16_bf16 v[12:27], v[76:79], v[144:147], v[12:27]
  ds_read_b128 v[76:79], v4 offset:34816
  v_fma_mix_f32 v148, v132, v156, v172 op_sel:[0,0,0] op_sel_hi:[1,0,0]
  v_fma_mix_f32 v149, v132, v157, v173 op_sel:[1,0,0] op_sel_hi:[1,0,0]
  v_fma_mix_f32 v150, v133, v158, v174 op_sel:[0,0,0] op_sel_hi:[1,0,0]
  v_fma_mix_f32 v151, v133, v159, v175 op_sel:[1,0,0] op_sel_hi:[1,0,0]
  s_waitcnt lgkmcnt(7)
  v_mfma_f32_32x32x16_bf16 v[28:43], v[80:83], v[144:147], v[28:43]
  ds_read_b128 v[80:83], v5 offset:6144
  v_fma_mix_f32 v152, v134, v160, v176 op_sel:[0,0,0] op_sel_hi:[1,0,0]
  v_fma_mix_f32 v153, v134, v161, v177 op_sel:[1,0,0] op_sel_hi:[1,0,0]
  v_fma_mix_f32 v154, v135, v162, v178 op_sel:[0,0,0] op_sel_hi:[1,0,0]
  v_fma_mix_f32 v155, v135, v163, v179 op_sel:[1,0,0] op_sel_hi:[1,0,0]
  s_waitcnt lgkmcnt(7)
  v_mfma_f32_32x32x16_bf16 v[44:59], v[84:87], v[144:147], v[44:59]
  ds_read_b128 v[84:87], v5 offset:43008
  v_cvt_pk_bf16_f32 v140, v148, v149
  v_cvt_pk_bf16_f32 v141, v150, v151
  v_cvt_pk_bf16_f32 v142, v152, v153
  v_cvt_pk_bf16_f32 v143, v154, v155
  ds_read_b128 v[156:159], v188 offset:4864
  ds_read_b128 v[172:175], v188 offset:2304
  s_waitcnt lgkmcnt(7)
  v_mfma_f32_32x32x16_bf16 v[60:75], v[88:91], v[144:147], v[60:75]
  ds_read_b128 v[88:91], v6 offset:14336
  ds_read_b128 v[160:163], v188 offset:4880
  ds_read_b128 v[176:179], v188 offset:2320
  s_waitcnt lgkmcnt(7)
  v_mfma_f32_32x32x16_bf16 v[12:27], v[76:79], v[140:143], v[12:27]
  ds_read_b128 v[76:79], v4 offset:35840
  v_fma_mix_f32 v148, v136, v164, v180 op_sel:[0,0,0] op_sel_hi:[1,0,0]
  v_fma_mix_f32 v149, v136, v165, v181 op_sel:[1,0,0] op_sel_hi:[1,0,0]
  v_fma_mix_f32 v150, v137, v166, v182 op_sel:[0,0,0] op_sel_hi:[1,0,0]
  v_fma_mix_f32 v151, v137, v167, v183 op_sel:[1,0,0] op_sel_hi:[1,0,0]
  s_waitcnt lgkmcnt(7)
  v_mfma_f32_32x32x16_bf16 v[28:43], v[80:83], v[140:143], v[28:43]
  ds_read_b128 v[80:83], v5 offset:7168
  v_fma_mix_f32 v152, v138, v168, v184 op_sel:[0,0,0] op_sel_hi:[1,0,0]
  v_fma_mix_f32 v153, v138, v169, v185 op_sel:[1,0,0] op_sel_hi:[1,0,0]
  v_fma_mix_f32 v154, v139, v170, v186 op_sel:[0,0,0] op_sel_hi:[1,0,0]
  v_fma_mix_f32 v155, v139, v171, v187 op_sel:[1,0,0] op_sel_hi:[1,0,0]
  s_waitcnt lgkmcnt(7)
  v_mfma_f32_32x32x16_bf16 v[44:59], v[84:87], v[140:143], v[44:59]
  ds_read_b128 v[84:87], v5 offset:44032
  v_cvt_pk_bf16_f32 v144, v148, v149
  v_cvt_pk_bf16_f32 v145, v150, v151
  v_cvt_pk_bf16_f32 v146, v152, v153
  v_cvt_pk_bf16_f32 v147, v154, v155
  ds_read_b128 v[164:167], v188 offset:4928
  ds_read_b128 v[180:183], v188 offset:2368
  s_waitcnt lgkmcnt(7)
  v_mfma_f32_32x32x16_bf16 v[60:75], v[88:91], v[140:143], v[60:75]
  ds_read_b128 v[88:91], v6 offset:15360
  ds_read_b128 v[168:171], v188 offset:4944
  ds_read_b128 v[184:187], v188 offset:2384
  s_waitcnt vmcnt(4)
  s_barrier
  s_waitcnt lgkmcnt(7)
  v_mfma_f32_32x32x16_bf16 v[12:27], v[76:79], v[144:147], v[12:27]
  ds_read_b128 v[76:79], v4 offset:0
  v_fma_mix_f32 v148, v92, v156, v172 op_sel:[0,0,0] op_sel_hi:[1,0,0]
  v_fma_mix_f32 v149, v92, v157, v173 op_sel:[1,0,0] op_sel_hi:[1,0,0]
  v_fma_mix_f32 v150, v93, v158, v174 op_sel:[0,0,0] op_sel_hi:[1,0,0]
  v_fma_mix_f32 v151, v93, v159, v175 op_sel:[1,0,0] op_sel_hi:[1,0,0]
  s_waitcnt lgkmcnt(7)
  v_mfma_f32_32x32x16_bf16 v[28:43], v[80:83], v[144:147], v[28:43]
  ds_read_b128 v[80:83], v4 offset:36864
  v_fma_mix_f32 v152, v94, v160, v176 op_sel:[0,0,0] op_sel_hi:[1,0,0]
  v_fma_mix_f32 v153, v94, v161, v177 op_sel:[1,0,0] op_sel_hi:[1,0,0]
  v_fma_mix_f32 v154, v95, v162, v178 op_sel:[0,0,0] op_sel_hi:[1,0,0]
  v_fma_mix_f32 v155, v95, v163, v179 op_sel:[1,0,0] op_sel_hi:[1,0,0]
  s_waitcnt lgkmcnt(7)
  v_mfma_f32_32x32x16_bf16 v[44:59], v[84:87], v[144:147], v[44:59]
  ds_read_b128 v[84:87], v5 offset:8192
  v_cvt_pk_bf16_f32 v140, v148, v149
  v_cvt_pk_bf16_f32 v141, v150, v151
  v_cvt_pk_bf16_f32 v142, v152, v153
  v_cvt_pk_bf16_f32 v143, v154, v155
  ds_read_b128 v[156:159], v188 offset:4992
  ds_read_b128 v[172:175], v188 offset:2432
  s_waitcnt lgkmcnt(7)
  v_mfma_f32_32x32x16_bf16 v[60:75], v[88:91], v[144:147], v[60:75]
  ds_read_b128 v[88:91], v5 offset:45056
  ds_read_b128 v[160:163], v188 offset:5008
  ds_read_b128 v[176:179], v188 offset:2448
  s_waitcnt lgkmcnt(7)
  v_mfma_f32_32x32x16_bf16 v[12:27], v[76:79], v[140:143], v[12:27]
  ds_read_b128 v[76:79], v4 offset:1024
  v_fma_mix_f32 v148, v96, v164, v180 op_sel:[0,0,0] op_sel_hi:[1,0,0]
  v_fma_mix_f32 v149, v96, v165, v181 op_sel:[1,0,0] op_sel_hi:[1,0,0]
  v_fma_mix_f32 v150, v97, v166, v182 op_sel:[0,0,0] op_sel_hi:[1,0,0]
  v_fma_mix_f32 v151, v97, v167, v183 op_sel:[1,0,0] op_sel_hi:[1,0,0]
  s_waitcnt lgkmcnt(7)
  v_mfma_f32_32x32x16_bf16 v[28:43], v[80:83], v[140:143], v[28:43]
  ds_read_b128 v[80:83], v4 offset:37888
  v_fma_mix_f32 v152, v98, v168, v184 op_sel:[0,0,0] op_sel_hi:[1,0,0]
  v_fma_mix_f32 v153, v98, v169, v185 op_sel:[1,0,0] op_sel_hi:[1,0,0]
  v_fma_mix_f32 v154, v99, v170, v186 op_sel:[0,0,0] op_sel_hi:[1,0,0]
  v_fma_mix_f32 v155, v99, v171, v187 op_sel:[1,0,0] op_sel_hi:[1,0,0]
  s_waitcnt lgkmcnt(7)
  v_mfma_f32_32x32x16_bf16 v[44:59], v[84:87], v[140:143], v[44:59]
  ds_read_b128 v[84:87], v5 offset:9216
  v_cvt_pk_bf16_f32 v144, v148, v149
  v_cvt_pk_bf16_f32 v145, v150, v151
  v_cvt_pk_bf16_f32 v146, v152, v153
  v_cvt_pk_bf16_f32 v147, v154, v155
  ds_read_b128 v[164:167], v188 offset:5056
  ds_read_b128 v[180:183], v188 offset:2496
  s_waitcnt lgkmcnt(7)
  v_mfma_f32_32x32x16_bf16 v[60:75], v[88:91], v[140:143], v[60:75]
  ds_read_b128 v[88:91], v5 offset:46080
  ds_read_b128 v[168:171], v188 offset:5072
  ds_read_b128 v[184:187], v188 offset:2512
  s_waitcnt vmcnt(0)
  s_barrier
  s_waitcnt lgkmcnt(7)
  v_mfma_f32_32x32x16_bf16 v[12:27], v[76:79], v[144:147], v[12:27]
  ds_read_b128 v[76:79], v4 offset:2048
  v_fma_mix_f32 v148, v100, v156, v172 op_sel:[0,0,0] op_sel_hi:[1,0,0]
  v_fma_mix_f32 v149, v100, v157, v173 op_sel:[1,0,0] op_sel_hi:[1,0,0]
  v_fma_mix_f32 v150, v101, v158, v174 op_sel:[0,0,0] op_sel_hi:[1,0,0]
  v_fma_mix_f32 v151, v101, v159, v175 op_sel:[1,0,0] op_sel_hi:[1,0,0]
  s_waitcnt lgkmcnt(7)
  v_mfma_f32_32x32x16_bf16 v[28:43], v[80:83], v[144:147], v[28:43]
  ds_read_b128 v[80:83], v4 offset:38912
  v_fma_mix_f32 v152, v102, v160, v176 op_sel:[0,0,0] op_sel_hi:[1,0,0]
  v_fma_mix_f32 v153, v102, v161, v177 op_sel:[1,0,0] op_sel_hi:[1,0,0]
  v_fma_mix_f32 v154, v103, v162, v178 op_sel:[0,0,0] op_sel_hi:[1,0,0]
  v_fma_mix_f32 v155, v103, v163, v179 op_sel:[1,0,0] op_sel_hi:[1,0,0]
  s_waitcnt lgkmcnt(7)
  v_mfma_f32_32x32x16_bf16 v[44:59], v[84:87], v[144:147], v[44:59]
  ds_read_b128 v[84:87], v5 offset:10240
  v_cvt_pk_bf16_f32 v140, v148, v149
  v_cvt_pk_bf16_f32 v141, v150, v151
  v_cvt_pk_bf16_f32 v142, v152, v153
  v_cvt_pk_bf16_f32 v143, v154, v155
  s_waitcnt lgkmcnt(5)
  v_mfma_f32_32x32x16_bf16 v[60:75], v[88:91], v[144:147], v[60:75]
  ds_read_b128 v[88:91], v5 offset:47104
  s_waitcnt lgkmcnt(3)
  v_mfma_f32_32x32x16_bf16 v[12:27], v[76:79], v[140:143], v[12:27]
  ds_read_b128 v[76:79], v4 offset:3072
  v_fma_mix_f32 v148, v104, v164, v180 op_sel:[0,0,0] op_sel_hi:[1,0,0]
  v_fma_mix_f32 v149, v104, v165, v181 op_sel:[1,0,0] op_sel_hi:[1,0,0]
  v_fma_mix_f32 v150, v105, v166, v182 op_sel:[0,0,0] op_sel_hi:[1,0,0]
  v_fma_mix_f32 v151, v105, v167, v183 op_sel:[1,0,0] op_sel_hi:[1,0,0]
  s_waitcnt lgkmcnt(3)
  v_mfma_f32_32x32x16_bf16 v[28:43], v[80:83], v[140:143], v[28:43]
  ds_read_b128 v[80:83], v4 offset:39936
  v_fma_mix_f32 v152, v106, v168, v184 op_sel:[0,0,0] op_sel_hi:[1,0,0]
  v_fma_mix_f32 v153, v106, v169, v185 op_sel:[1,0,0] op_sel_hi:[1,0,0]
  v_fma_mix_f32 v154, v107, v170, v186 op_sel:[0,0,0] op_sel_hi:[1,0,0]
  v_fma_mix_f32 v155, v107, v171, v187 op_sel:[1,0,0] op_sel_hi:[1,0,0]
  s_waitcnt lgkmcnt(3)
  v_mfma_f32_32x32x16_bf16 v[44:59], v[84:87], v[140:143], v[44:59]
  ds_read_b128 v[84:87], v5 offset:11264
  v_cvt_pk_bf16_f32 v144, v148, v149
  v_cvt_pk_bf16_f32 v145, v150, v151
  v_cvt_pk_bf16_f32 v146, v152, v153
  v_cvt_pk_bf16_f32 v147, v154, v155
  s_waitcnt lgkmcnt(3)
  v_mfma_f32_32x32x16_bf16 v[60:75], v[88:91], v[140:143], v[60:75]
  ds_read_b128 v[88:91], v5 offset:48128
  s_waitcnt lgkmcnt(3)
  v_mfma_f32_32x32x16_bf16 v[12:27], v[76:79], v[144:147], v[12:27]
  s_waitcnt lgkmcnt(2)
  v_mfma_f32_32x32x16_bf16 v[28:43], v[80:83], v[144:147], v[28:43]
  s_waitcnt lgkmcnt(1)
  v_mfma_f32_32x32x16_bf16 v[44:59], v[84:87], v[144:147], v[44:59]
  s_waitcnt lgkmcnt(0)
  v_mfma_f32_32x32x16_bf16 v[60:75], v[88:91], v[144:147], v[60:75]
  v_and_b32 v92, 31, v2
  v_lshrrev_b32 v93, 5, v2
  v_bfe_u32 v94, v92, 2, 1
  v_bfe_u32 v95, v92, 3, 1
  v_xor_b32 v94, v94, v95
  v_mul_u32_u24 v94, 12, v94
  s_cmp_ge_u32 s10, 5
  s_cselect_b32 s11, -1, 0
  s_mov_b32 s19, 1280
  s_mov_b32 s18, 5132288
  s_cselect_b32 s19, 2560, s19
  s_cselect_b32 s18, 7753728, s18
  v_and_b32 v94, s11, v94
  v_xor_b32 v92, v92, v94
  s_lshl_b32 s11, s9, 2
  s_add_u32 s11, s11, s8
  s_mul_i32 s11, s11, s19
  s_add_u32 s18, s18, s11
  s_lshl_b32 s19, s19, 6
  v_lshl_add_u32 v94, v93, 5, v92
  v_lshlrev_b32 v94, 4, v94
  v_mul_lo_u32 v95, v93, s19
  v_lshl_add_u32 v95, v92, 3, v95
  s_lshl_b32 s20, s10, 2
  s_add_u32 s20, s20, 0
  s_mul_i32 s21, s20, 205
  s_lshr_b32 s21, s21, 10
  s_mul_i32 s11, s21, 5
  s_sub_u32 s20, s20, s11
  s_and_b32 s21, s21, 3
  s_lshl_b32 s21, s21, 3
  v_cvt_pk_bf16_f32 v76, v12, v13
  v_cvt_pk_bf16_f32 v77, v14, v15
  v_cvt_pk_bf16_f32 v78, v16, v17
  v_cvt_pk_bf16_f32 v79, v18, v19
  v_cvt_pk_bf16_f32 v80, v20, v21
  v_cvt_pk_bf16_f32 v81, v22, v23
  v_cvt_pk_bf16_f32 v82, v24, v25
  v_cvt_pk_bf16_f32 v83, v26, v27
  s_cmp_eq_u32 s20, 4
  s_cbranch_scc1 k2_kernel_tail6
  s_lshl_b32 s20, s20, 1
  s_add_u32 s21, s21, s20
  s_mul_i32 s22, s21, s19
  s_add_u32 s22, s22, s18
  buffer_store_dwordx4 v[76:79], v94, s[4:7], s22 offen sc1
  s_add_u32 s22, s22, s19
  buffer_store_dwordx4 v[80:83], v94, s[4:7], s22 offen sc1
k2_kernel_next7:
  s_lshl_b32 s20, s10, 2
  s_add_u32 s20, s20, 1
  s_mul_i32 s21, s20, 205
  s_lshr_b32 s21, s21, 10
  s_mul_i32 s11, s21, 5
  s_sub_u32 s20, s20, s11
  s_and_b32 s21, s21, 3
  s_lshl_b32 s21, s21, 3
  v_cvt_pk_bf16_f32 v84, v28, v29
  v_cvt_pk_bf16_f32 v85, v30, v31
  v_cvt_pk_bf16_f32 v86, v32, v33
  v_cvt_pk_bf16_f32 v87, v34, v35
  v_cvt_pk_bf16_f32 v88, v36, v37
  v_cvt_pk_bf16_f32 v89, v38, v39
  v_cvt_pk_bf16_f32 v90, v40, v41
  v_cvt_pk_bf16_f32 v91, v42, v43
  s_cmp_eq_u32 s20, 4
  s_cbranch_scc1 k2_kernel_tail8
  s_lshl_b32 s20, s20, 1
  s_add_u32 s21, s21, s20
  s_mul_i32 s22, s21, s19
  s_add_u32 s22, s22, s18
  buffer_store_dwordx4 v[84:87], v94, s[4:7], s22 offen sc1
  s_add_u32 s22, s22, s19
  buffer_store_dwordx4 v[88:91], v94, s[4:7], s22 offen sc1
k2_kernel_next9:
  s_lshl_b32 s20, s10, 2
  s_add_u32 s20, s20, 2
  s_mul_i32 s21, s20, 205
  s_lshr_b32 s21, s21, 10
  s_mul_i32 s11, s21, 5
  s_sub_u32 s20, s20, s11
  s_and_b32 s21, s21, 3
  s_lshl_b32 s21, s21, 3
  v_cvt_pk_bf16_f32 v76, v44, v45
  v_cvt_pk_bf16_f32 v77, v46, v47
  v_cvt_pk_bf16_f32 v78, v48, v49
  v_cvt_pk_bf16_f32 v79, v50, v51
  v_cvt_pk_bf16_f32 v80, v52, v53
  v_cvt_pk_bf16_f32 v81, v54, v55
  v_cvt_pk_bf16_f32 v82, v56, v57
  v_cvt_pk_bf16_f32 v83, v58, v59
  s_cmp_eq_u32 s20, 4
  s_cbranch_scc1 k2_kernel_tail10
  s_lshl_b32 s20, s20, 1
  s_add_u32 s21, s21, s20
  s_mul_i32 s22, s21, s19
  s_add_u32 s22, s22, s18
  buffer_store_dwordx4 v[76:79], v94, s[4:7], s22 offen sc1
  s_add_u32 s22, s22, s19
  buffer_store_dwordx4 v[80:83], v94, s[4:7], s22 offen sc1
k2_kernel_next11:
  s_lshl_b32 s20, s10, 2
  s_add_u32 s20, s20, 3
  s_mul_i32 s21, s20, 205
  s_lshr_b32 s21, s21, 10
  s_mul_i32 s11, s21, 5
  s_sub_u32 s20, s20, s11
  s_and_b32 s21, s21, 3
  s_lshl_b32 s21, s21, 3
  v_cvt_pk_bf16_f32 v84, v60, v61
  v_cvt_pk_bf16_f32 v85, v62, v63
  v_cvt_pk_bf16_f32 v86, v64, v65
  v_cvt_pk_bf16_f32 v87, v66, v67
  v_cvt_pk_bf16_f32 v88, v68, v69
  v_cvt_pk_bf16_f32 v89, v70, v71
  v_cvt_pk_bf16_f32 v90, v72, v73
  v_cvt_pk_bf16_f32 v91, v74, v75
  s_cmp_eq_u32 s20, 4
  s_cbranch_scc1 k2_kernel_tail12
  s_lshl_b32 s20, s20, 1
  s_add_u32 s21, s21, s20
  s_mul_i32 s22, s21, s19
  s_add_u32 s22, s22, s18
  buffer_store_dwordx4 v[84:87], v94, s[4:7], s22 offen sc1
  s_add_u32 s22, s22, s19
  buffer_store_dwordx4 v[88:91], v94, s[4:7], s22 offen sc1
k2_kernel_next13:
  s_endpgm
k2_kernel_tail6:
  s_mul_i32 s22, s21, s19
  s_add_u32 s22, s22, s18
  s_lshl_b32 s11, s19, 1
  buffer_store_dwordx2 v[76:77], v95, s[4:7], s22 offen offset:1024 sc1
  s_add_u32 s22, s22, s11
  buffer_store_dwordx2 v[78:79], v95, s[4:7], s22 offen offset:1024 sc1
  s_add_u32 s22, s22, s11
  buffer_store_dwordx2 v[80:81], v95, s[4:7], s22 offen offset:1024 sc1
  s_add_u32 s22, s22, s11
  buffer_store_dwordx2 v[82:83], v95, s[4:7], s22 offen offset:1024 sc1
  s_add_u32 s22, s22, s11
  s_branch k2_kernel_next7
k2_kernel_tail8:
  s_mul_i32 s22, s21, s19
  s_add_u32 s22, s22, s18
  s_lshl_b32 s11, s19, 1
  buffer_store_dwordx2 v[84:85], v95, s[4:7], s22 offen offset:1024 sc1
  s_add_u32 s22, s22, s11
  buffer_store_dwordx2 v[86:87], v95, s[4:7], s22 offen offset:1024 sc1
  s_add_u32 s22, s22, s11
  buffer_store_dwordx2 v[88:89], v95, s[4:7], s22 offen offset:1024 sc1
  s_add_u32 s22, s22, s11
  buffer_store_dwordx2 v[90:91], v95, s[4:7], s22 offen offset:1024 sc1
  s_add_u32 s22, s22, s11
  s_branch k2_kernel_next9
k2_kernel_tail10:
  s_mul_i32 s22, s21, s19
  s_add_u32 s22, s22, s18
  s_lshl_b32 s11, s19, 1
  buffer_store_dwordx2 v[76:77], v95, s[4:7], s22 offen offset:1024 sc1
  s_add_u32 s22, s22, s11
  buffer_store_dwordx2 v[78:79], v95, s[4:7], s22 offen offset:1024 sc1
  s_add_u32 s22, s22, s11
  buffer_store_dwordx2 v[80:81], v95, s[4:7], s22 offen offset:1024 sc1
  s_add_u32 s22, s22, s11
  buffer_store_dwordx2 v[82:83], v95, s[4:7], s22 offen offset:1024 sc1
  s_add_u32 s22, s22, s11
  s_branch k2_kernel_next11
k2_kernel_tail12:
  s_mul_i32 s22, s21, s19
  s_add_u32 s22, s22, s18
  s_lshl_b32 s11, s19, 1
  buffer_store_dwordx2 v[84:85], v95, s[4:7], s22 offen offset:1024 sc1
  s_add_u32 s22, s22, s11
  buffer_store_dwordx2 v[86:87], v95, s[4:7], s22 offen offset:1024 sc1
  s_add_u32 s22, s22, s11
  buffer_store_dwordx2 v[88:89], v95, s[4:7], s22 offen offset:1024 sc1
  s_add_u32 s22, s22, s11
  buffer_store_dwordx2 v[90:91], v95, s[4:7], s22 offen offset:1024 sc1
  s_add_u32 s22, s22, s11
  s_branch k2_kernel_next13
k2_kernel_vpath2:
  s_waitcnt lgkmcnt(7)
  v_mfma_f32_32x32x16_bf16 v[12:27], v[140:143], v[76:79], 0
  ds_read_b128 v[76:79], v4 offset:1024
  v_fma_mix_f32 v148, v96, v164, v180 op_sel:[0,0,0] op_sel_hi:[1,0,0]
  v_fma_mix_f32 v149, v96, v165, v181 op_sel:[1,0,0] op_sel_hi:[1,0,0]
  v_fma_mix_f32 v150, v97, v166, v182 op_sel:[0,0,0] op_sel_hi:[1,0,0]
  v_fma_mix_f32 v151, v97, v167, v183 op_sel:[1,0,0] op_sel_hi:[1,0,0]
  s_waitcnt lgkmcnt(7)
  v_mfma_f32_32x32x16_bf16 v[28:43], v[140:143], v[80:83], 0
  ds_read_b128 v[80:83], v4 offset:37888
  v_fma_mix_f32 v152, v98, v168, v184 op_sel:[0,0,0] op_sel_hi:[1,0,0]
  v_fma_mix_f32 v153, v98, v169, v185 op_sel:[1,0,0] op_sel_hi:[1,0,0]
  v_fma_mix_f32 v154, v99, v170, v186 op_sel:[0,0,0] op_sel_hi:[1,0,0]
  v_fma_mix_f32 v155, v99, v171, v187 op_sel:[1,0,0] op_sel_hi:[1,0,0]
  buffer_load_dwordx4 v7, s[4:7], s13 offen offset:2048 lds
  buffer_load_dwordx4 v[116:119], v8, s[4:7], s13 offen offset:2048
  s_waitcnt lgkmcnt(7)
  v_mfma_f32_32x32x16_bf16 v[44:59], v[140:143], v[84:87], 0
  ds_read_b128 v[84:87], v5 offset:9216
  v_cvt_pk_bf16_f32 v144, v148, v149
  v_cvt_pk_bf16_f32 v145, v150, v151
  v_cvt_pk_bf16_f32 v146, v152, v153
  v_cvt_pk_bf16_f32 v147, v154, v155
  ds_read_b128 v[164:167], v188 offset:2752
  ds_read_b128 v[180:183], v188 offset:192
  s_waitcnt lgkmcnt(9)
  v_mfma_f32_32x32x16_bf16 v[60:75], v[140:143], v[88:91], 0
  ds_read_b128 v[88:91], v5 offset:46080
  ds_read_b128 v[168:171], v188 offset:2768
  ds_read_b128 v[184:187], v188 offset:208
  buffer_load_dwordx4 v7, s[4:7], s13 offen offset:3072 lds
  buffer_load_dwordx4 v[120:123], v8, s[4:7], s13 offen offset:3072
  s_add_u32 m0, s14, 8192
  s_mov_b32 s13, 8192
  buffer_load_dwordx4 v7, s[4:7], s13 offen offset:0 lds
  buffer_load_dwordx4 v[124:127], v8, s[4:7], s13 offen offset:0
  buffer_load_dwordx4 v7, s[4:7], s13 offen offset:1024 lds
  buffer_load_dwordx4 v[128:131], v8, s[4:7], s13 offen offset:1024
  s_waitcnt vmcnt(12)
  s_barrier
  s_waitcnt lgkmcnt(7)
  v_mfma_f32_32x32x16_bf16 v[12:27], v[144:147], v[76:79], v[12:27]
  ds_read_b128 v[76:79], v4 offset:2048
  v_fma_mix_f32 v148, v100, v156, v172 op_sel:[0,0,0] op_sel_hi:[1,0,0]
  v_fma_mix_f32 v149, v100, v157, v173 op_sel:[1,0,0] op_sel_hi:[1,0,0]
  v_fma_mix_f32 v150, v101, v158, v174 op_sel:[0,0,0] op_sel_hi:[1,0,0]
  v_fma_mix_f32 v151, v101, v159, v175 op_sel:[1,0,0] op_sel_hi:[1,0,0]
  s_waitcnt lgkmcnt(7)
  v_mfma_f32_32x32x16_bf16 v[28:43], v[144:147], v[80:83], v[28:43]
  ds_read_b128 v[80:83], v4 offset:38912
  v_fma_mix_f32 v152, v102, v160, v176 op_sel:[0,0,0] op_sel_hi:[1,0,0]
  v_fma_mix_f32 v153, v102, v161, v177 op_sel:[1,0,0] op_sel_hi:[1,0,0]
  v_fma_mix_f32 v154, v103, v162, v178 op_sel:[0,0,0] op_sel_hi:[1,0,0]
  v_fma_mix_f32 v155, v103, v163, v179 op_sel:[1,0,0] op_sel_hi:[1,0,0]
  s_waitcnt lgkmcnt(7)
  v_mfma_f32_32x32x16_bf16 v[44:59], v[144:147], v[84:87], v[44:59]
  ds_read_b128 v[84:87], v5 offset:10240
  v_cvt_pk_bf16_f32 v140, v148, v149
  v_cvt_pk_bf16_f32 v141, v150, v151
  v_cvt_pk_bf16_f32 v142, v152, v153
  v_cvt_pk_bf16_f32 v143, v154, v155
  ds_read_b128 v[156:159], v188 offset:2816
  ds_read_b128 v[172:175], v188 offset:256
  s_waitcnt lgkmcnt(7)
  v_mfma_f32_32x32x16_bf16 v[60:75], v[144:147], v[88:91], v[60:75]
  ds_read_b128 v[88:91], v5 offset:47104
  ds_read_b128 v[160:163], v188 offset:2832
  ds_read_b128 v[176:179], v188 offset:272
  s_waitcnt lgkmcnt(7)
  v_mfma_f32_32x32x16_bf16 v[12:27], v[140:143], v[76:79], v[12:27]
  ds_read_b128 v[76:79], v4 offset:3072
  v_fma_mix_f32 v148, v104, v164, v180 op_sel:[0,0,0] op_sel_hi:[1,0,0]
  v_fma_mix_f32 v149, v104, v165, v181 op_sel:[1,0,0] op_sel_hi:[1,0,0]
  v_fma_mix_f32 v150, v105, v166, v182 op_sel:[0,0,0] op_sel_hi:[1,0,0]
  v_fma_mix_f32 v151, v105, v167, v183 op_sel:[1,0,0] op_sel_hi:[1,0,0]
  s_waitcnt lgkmcnt(7)
  v_mfma_f32_32x32x16_bf16 v[28:43], v[140:143], v[80:83], v[28:43]
  ds_read_b128 v[80:83], v4 offset:39936
  v_fma_mix_f32 v152, v106, v168, v184 op_sel:[0,0,0] op_sel_hi:[1,0,0]
  v_fma_mix_f32 v153, v106, v169, v185 op_sel:[1,0,0] op_sel_hi:[1,0,0]
  v_fma_mix_f32 v154, v107, v170, v186 op_sel:[0,0,0] op_sel_hi:[1,0,0]
  v_fma_mix_f32 v155, v107, v171, v187 op_sel:[1,0,0] op_sel_hi:[1,0,0]
  buffer_load_dwordx4 v7, s[4:7], s13 offen offset:2048 lds
  buffer_load_dwordx4 v[132:135], v8, s[4:7], s13 offen offset:2048
  s_waitcnt lgkmcnt(7)
  v_mfma_f32_32x32x16_bf16 v[44:59], v[140:143], v[84:87], v[44:59]
  ds_read_b128 v[84:87], v5 offset:11264
  v_cvt_pk_bf16_f32 v144, v148, v149
  v_cvt_pk_bf16_f32 v145, v150, v151
  v_cvt_pk_bf16_f32 v146, v152, v153
  v_cvt_pk_bf16_f32 v147, v154, v155
  ds_read_b128 v[164:167], v188 offset:2880
  ds_read_b128 v[180:183], v188 offset:320
  s_waitcnt lgkmcnt(7)
  v_mfma_f32_32x32x16_bf16 v[60:75], v[140:143], v[88:91], v[60:75]
  ds_read_b128 v[88:91], v5 offset:48128
  ds_read_b128 v[168:171], v188 offset:2896
  ds_read_b128 v[184:187], v188 offset:336
  buffer_load_dwordx4 v7, s[4:7], s13 offen offset:3072 lds
  buffer_load_dwordx4 v[136:139], v8, s[4:7], s13 offen offset:3072
  s_add_u32 m0, s14, 12288
  s_mov_b32 s13, 12288
  buffer_load_dwordx4 v7, s[4:7], s13 offen offset:0 lds
  buffer_load_dwordx4 v[92:95], v8, s[4:7], s13 offen offset:0
  buffer_load_dwordx4 v7, s[4:7], s13 offen offset:1024 lds
  buffer_load_dwordx4 v[96:99], v8, s[4:7], s13 offen offset:1024
  s_waitcnt vmcnt(12)
  s_barrier
  s_waitcnt lgkmcnt(7)
  v_mfma_f32_32x32x16_bf16 v[12:27], v[144:147], v[76:79], v[12:27]
  ds_read_b128 v[76:79], v4 offset:4096
  v_fma_mix_f32 v148, v108, v156, v172 op_sel:[0,0,0] op_sel_hi:[1,0,0]
  v_fma_mix_f32 v149, v108, v157, v173 op_sel:[1,0,0] op_sel_hi:[1,0,0]
  v_fma_mix_f32 v150, v109, v158, v174 op_sel:[0,0,0] op_sel_hi:[1,0,0]
  v_fma_mix_f32 v151, v109, v159, v175 op_sel:[1,0,0] op_sel_hi:[1,0,0]
  s_waitcnt lgkmcnt(7)
  v_mfma_f32_32x32x16_bf16 v[28:43], v[144:147], v[80:83], v[28:43]
  ds_read_b128 v[80:83], v4 offset:40960
  v_fma_mix_f32 v152, v110, v160, v176 op_sel:[0,0,0] op_sel_hi:[1,0,0]
  v_fma_mix_f32 v153, v110, v161, v177 op_sel:[1,0,0] op_sel_hi:[1,0,0]
  v_fma_mix_f32 v154, v111, v162, v178 op_sel:[0,0,0] op_sel_hi:[1,0,0]
  v_fma_mix_f32 v155, v111, v163, v179 op_sel:[1,0,0] op_sel_hi:[1,0,0]
  s_waitcnt lgkmcnt(7)
  v_mfma_f32_32x32x16_bf16 v[44:59], v[144:147], v[84:87], v[44:59]
  ds_read_b128 v[84:87], v5 offset:12288
  v_cvt_pk_bf16_f32 v140, v148, v149
  v_cvt_pk_bf16_f32 v141, v150, v151
  v_cvt_pk_bf16_f32 v142, v152, v153
  v_cvt_pk_bf16_f32 v143, v154, v155
  ds_read_b128 v[156:159], v188 offset:2944
  ds_read_b128 v[172:175], v188 offset:384
  s_waitcnt lgkmcnt(7)
  v_mfma_f32_32x32x16_bf16 v[60:75], v[144:147], v[88:91], v[60:75]
  ds_read_b128 v[88:91], v5 offset:49152
  ds_read_b128 v[160:163], v188 offset:2960
  ds_read_b128 v[176:179], v188 offset:400
  s_waitcnt lgkmcnt(7)
  v_mfma_f32_32x32x16_bf16 v[12:27], v[140:143], v[76:79], v[12:27]
  ds_read_b128 v[76:79], v4 offset:5120
  v_fma_mix_f32 v148, v112, v164, v180 op_sel:[0,0,0] op_sel_hi:[1,0,0]
  v_fma_mix_f32 v149, v112, v165, v181 op_sel:[1,0,0] op_sel_hi:[1,0,0]
  v_fma_mix_f32 v150, v113, v166, v182 op_sel:[0,0,0] op_sel_hi:[1,0,0]
  v_fma_mix_f32 v151, v113, v167, v183 op_sel:[1,0,0] op_sel_hi:[1,0,0]
  s_waitcnt lgkmcnt(7)
  v_mfma_f32_32x32x16_bf16 v[28:43], v[140:143], v[80:83], v[28:43]
  ds_read_b128 v[80:83], v4 offset:41984
  v_fma_mix_f32 v152, v114, v168, v184 op_sel:[0,0,0] op_sel_hi:[1,0,0]
  v_fma_mix_f32 v153, v114, v169, v185 op_sel:[1,0,0] op_sel_hi:[1,0,0]
  v_fma_mix_f32 v154, v115, v170, v186 op_sel:[0,0,0] op_sel_hi:[1,0,0]
  v_fma_mix_f32 v155, v115, v171, v187 op_sel:[1,0,0] op_sel_hi:[1,0,0]
  buffer_load_dwordx4 v7, s[4:7], s13 offen offset:2048 lds
  s_waitcnt lgkmcnt(7)
  v_mfma_f32_32x32x16_bf16 v[44:59], v[140:143], v[84:87], v[44:59]
  ds_read_b128 v[84:87], v5 offset:13312
  v_cvt_pk_bf16_f32 v144, v148, v149
  v_cvt_pk_bf16_f32 v145, v150, v151
  v_cvt_pk_bf16_f32 v146, v152, v153
  v_cvt_pk_bf16_f32 v147, v154, v155
  ds_read_b128 v[164:167], v188 offset:3008
  ds_read_b128 v[180:183], v188 offset:448
  s_waitcnt lgkmcnt(7)
  v_mfma_f32_32x32x16_bf16 v[60:75], v[140:143], v[88:91], v[60:75]
  ds_read_b128 v[88:91], v5 offset:50176
  ds_read_b128 v[168:171], v188 offset:3024
  ds_read_b128 v[184:187], v188 offset:464
  buffer_load_dwordx4 v[100:103], v8, s[4:7], s13 offen offset:2048
  s_waitcnt lgkmcnt(7)
  v_mfma_f32_32x32x16_bf16 v[12:27], v[144:147], v[76:79], v[12:27]
  ds_read_b128 v[76:79], v4 offset:6144
  v_fma_mix_f32 v148, v116, v156, v172 op_sel:[0,0,0] op_sel_hi:[1,0,0]
  v_fma_mix_f32 v149, v116, v157, v173 op_sel:[1,0,0] op_sel_hi:[1,0,0]
  v_fma_mix_f32 v150, v117, v158, v174 op_sel:[0,0,0] op_sel_hi:[1,0,0]
  v_fma_mix_f32 v151, v117, v159, v175 op_sel:[1,0,0] op_sel_hi:[1,0,0]
  s_waitcnt lgkmcnt(7)
  v_mfma_f32_32x32x16_bf16 v[28:43], v[144:147], v[80:83], v[28:43]
  ds_read_b128 v[80:83], v4 offset:43008
  v_fma_mix_f32 v152, v118, v160, v176 op_sel:[0,0,0] op_sel_hi:[1,0,0]
  v_fma_mix_f32 v153, v118, v161, v177 op_sel:[1,0,0] op_sel_hi:[1,0,0]
  v_fma_mix_f32 v154, v119, v162, v178 op_sel:[0,0,0] op_sel_hi:[1,0,0]
  v_fma_mix_f32 v155, v119, v163, v179 op_sel:[1,0,0] op_sel_hi:[1,0,0]
  buffer_load_dwordx4 v7, s[4:7], s13 offen offset:3072 lds
  s_waitcnt lgkmcnt(7)
  v_mfma_f32_32x32x16_bf16 v[44:59], v[144:147], v[84:87], v[44:59]
  ds_read_b128 v[84:87], v5 offset:14336
  v_cvt_pk_bf16_f32 v140, v148, v149
  v_cvt_pk_bf16_f32 v141, v150, v151
  v_cvt_pk_bf16_f32 v142, v152, v153
  v_cvt_pk_bf16_f32 v143, v154, v155
  ds_read_b128 v[156:159], v188 offset:3072
  ds_read_b128 v[172:175], v188 offset:512
  s_waitcnt lgkmcnt(7)
  v_mfma_f32_32x32x16_bf16 v[60:75], v[144:147], v[88:91], v[60:75]
  ds_read_b128 v[88:91], v5 offset:51200
  ds_read_b128 v[160:163], v188 offset:3088
  ds_read_b128 v[176:179], v188 offset:528
  buffer_load_dwordx4 v[104:107], v8, s[4:7], s13 offen offset:3072
  s_waitcnt lgkmcnt(7)
  v_mfma_f32_32x32x16_bf16 v[12:27], v[140:143], v[76:79], v[12:27]
  ds_read_b128 v[76:79], v4 offset:7168
  v_fma_mix_f32 v148, v120, v164, v180 op_sel:[0,0,0] op_sel_hi:[1,0,0]
  v_fma_mix_f32 v149, v120, v165, v181 op_sel:[1,0,0] op_sel_hi:[1,0,0]
  v_fma_mix_f32 v150, v121, v166, v182 op_sel:[0,0,0] op_sel_hi:[1,0,0]
  v_fma_mix_f32 v151, v121, v167, v183 op_sel:[1,0,0] op_sel_hi:[1,0,0]
  s_waitcnt lgkmcnt(7)
  v_mfma_f32_32x32x16_bf16 v[28:43], v[140:143], v[80:83], v[28:43]
  ds_read_b128 v[80:83], v4 offset:44032
  v_fma_mix_f32 v152, v122, v168, v184 op_sel:[0,0,0] op_sel_hi:[1,0,0]
  v_fma_mix_f32 v153, v122, v169, v185 op_sel:[1,0,0] op_sel_hi:[1,0,0]
  v_fma_mix_f32 v154, v123, v170, v186 op_sel:[0,0,0] op_sel_hi:[1,0,0]
  v_fma_mix_f32 v155, v123, v171, v187 op_sel:[1,0,0] op_sel_hi:[1,0,0]
  s_add_u32 m0, s14, 16384
  s_mov_b32 s13, 16384
  s_waitcnt lgkmcnt(7)
  v_mfma_f32_32x32x16_bf16 v[44:59], v[140:143], v[84:87], v[44:59]
  ds_read_b128 v[84:87], v5 offset:15360
  v_cvt_pk_bf16_f32 v144, v148, v149
  v_cvt_pk_bf16_f32 v145, v150, v151
  v_cvt_pk_bf16_f32 v146, v152, v153
  v_cvt_pk_bf16_f32 v147, v154, v155
  ds_read_b128 v[164:167], v188 offset:3136
  ds_read_b128 v[180:183], v188 offset:576
  s_waitcnt lgkmcnt(7)
  v_mfma_f32_32x32x16_bf16 v[60:75], v[140:143], v[88:91], v[60:75]
  ds_read_b128 v[88:91], v5 offset:52224
  ds_read_b128 v[168:171], v188 offset:3152
  ds_read_b128 v[184:187], v188 offset:592
  buffer_load_dwordx4 v7, s[4:7], s13 offen offset:0 lds
  buffer_load_dwordx4 v[108:111], v8, s[4:7], s13 offen offset:0
  buffer_load_dwordx4 v7, s[4:7], s13 offen offset:1024 lds
  buffer_load_dwordx4 v[112:115], v8, s[4:7], s13 offen offset:1024
  s_waitcnt vmcnt(12)
  s_barrier
  s_waitcnt lgkmcnt(7)
  v_mfma_f32_32x32x16_bf16 v[12:27], v[144:147], v[76:79], v[12:27]
  ds_read_b128 v[76:79], v4 offset:8192
  v_fma_mix_f32 v148, v124, v156, v172 op_sel:[0,0,0] op_sel_hi:[1,0,0]
  v_fma_mix_f32 v149, v124, v157, v173 op_sel:[1,0,0] op_sel_hi:[1,0,0]
  v_fma_mix_f32 v150, v125, v158, v174 op_sel:[0,0,0] op_sel_hi:[1,0,0]
  v_fma_mix_f32 v151, v125, v159, v175 op_sel:[1,0,0] op_sel_hi:[1,0,0]
  s_waitcnt lgkmcnt(7)
  v_mfma_f32_32x32x16_bf16 v[28:43], v[144:147], v[80:83], v[28:43]
  ds_read_b128 v[80:83], v4 offset:45056
  v_fma_mix_f32 v152, v126, v160, v176 op_sel:[0,0,0] op_sel_hi:[1,0,0]
  v_fma_mix_f32 v153, v126, v161, v177 op_sel:[1,0,0] op_sel_hi:[1,0,0]
  v_fma_mix_f32 v154, v127, v162, v178 op_sel:[0,0,0] op_sel_hi:[1,0,0]
  v_fma_mix_f32 v155, v127, v163, v179 op_sel:[1,0,0] op_sel_hi:[1,0,0]
  s_waitcnt lgkmcnt(7)
  v_mfma_f32_32x32x16_bf16 v[44:59], v[144:147], v[84:87], v[44:59]
  ds_read_b128 v[84:87], v5 offset:16384
  v_cvt_pk_bf16_f32 v140, v148, v149
  v_cvt_pk_bf16_f32 v141, v150, v151
  v_cvt_pk_bf16_f32 v142, v152, v153
  v_cvt_pk_bf16_f32 v143, v154, v155
  ds_read_b128 v[156:159], v188 offset:3200
  ds_read_b128 v[172:175], v188 offset:640
  s_waitcnt lgkmcnt(7)
  v_mfma_f32_32x32x16_bf16 v[60:75], v[144:147], v[88:91], v[60:75]
  ds_read_b128 v[88:91], v5 offset:53248
  ds_read_b128 v[160:163], v188 offset:3216
  ds_read_b128 v[176:179], v188 offset:656
  s_waitcnt lgkmcnt(7)
  v_mfma_f32_32x32x16_bf16 v[12:27], v[140:143], v[76:79], v[12:27]
  ds_read_b128 v[76:79], v4 offset:9216
  v_fma_mix_f32 v148, v128, v164, v180 op_sel:[0,0,0] op_sel_hi:[1,0,0]
  v_fma_mix_f32 v149, v128, v165, v181 op_sel:[1,0,0] op_sel_hi:[1,0,0]
  v_fma_mix_f32 v150, v129, v166, v182 op_sel:[0,0,0] op_sel_hi:[1,0,0]
  v_fma_mix_f32 v151, v129, v167, v183 op_sel:[1,0,0] op_sel_hi:[1,0,0]
  s_waitcnt lgkmcnt(7)
  v_mfma_f32_32x32x16_bf16 v[28:43], v[140:143], v[80:83], v[28:43]
  ds_read_b128 v[80:83], v4 offset:46080
  v_fma_mix_f32 v152, v130, v168, v184 op_sel:[0,0,0] op_sel_hi:[1,0,0]
  v_fma_mix_f32 v153, v130, v169, v185 op_sel:[1,0,0] op_sel_hi:[1,0,0]
  v_fma_mix_f32 v154, v131, v170, v186 op_sel:[0,0,0] op_sel_hi:[1,0,0]
  v_fma_mix_f32 v155, v131, v171, v187 op_sel:[1,0,0] op_sel_hi:[1,0,0]
  buffer_load_dwordx4 v7, s[4:7], s13 offen offset:2048 lds
  s_waitcnt lgkmcnt(7)
  v_mfma_f32_32x32x16_bf16 v[44:59], v[140:143], v[84:87], v[44:59]
  ds_read_b128 v[84:87], v5 offset:17408
  v_cvt_pk_bf16_f32 v144, v148, v149
  v_cvt_pk_bf16_f32 v145, v150, v151
  v_cvt_pk_bf16_f32 v146, v152, v153
  v_cvt_pk_bf16_f32 v147, v154, v155
  ds_read_b128 v[164:167], v188 offset:3264
  ds_read_b128 v[180:183], v188 offset:704
  s_waitcnt lgkmcnt(7)
  v_mfma_f32_32x32x16_bf16 v[60:75], v[140:143], v[88:91], v[60:75]
  ds_read_b128 v[88:91], v5 offset:54272
  ds_read_b128 v[168:171], v188 offset:3280
  ds_read_b128 v[184:187], v188 offset:720
  buffer_load_dwordx4 v[116:119], v8, s[4:7], s13 offen offset:2048
  s_waitcnt lgkmcnt(7)
  v_mfma_f32_32x32x16_bf16 v[12:27], v[144:147], v[76:79], v[12:27]
  ds_read_b128 v[76:79], v4 offset:10240
  v_fma_mix_f32 v148, v132, v156, v172 op_sel:[0,0,0] op_sel_hi:[1,0,0]
  v_fma_mix_f32 v149, v132, v157, v173 op_sel:[1,0,0] op_sel_hi:[1,0,0]
  v_fma_mix_f32 v150, v133, v158, v174 op_sel:[0,0,0] op_sel_hi:[1,0,0]
  v_fma_mix_f32 v151, v133, v159, v175 op_sel:[1,0,0] op_sel_hi:[1,0,0]
  s_waitcnt lgkmcnt(7)
  v_mfma_f32_32x32x16_bf16 v[28:43], v[144:147], v[80:83], v[28:43]
  ds_read_b128 v[80:83], v4 offset:47104
  v_fma_mix_f32 v152, v134, v160, v176 op_sel:[0,0,0] op_sel_hi:[1,0,0]
  v_fma_mix_f32 v153, v134, v161, v177 op_sel:[1,0,0] op_sel_hi:[1,0,0]
  v_fma_mix_f32 v154, v135, v162, v178 op_sel:[0,0,0] op_sel_hi:[1,0,0]
  v_fma_mix_f32 v155, v135, v163, v179 op_sel:[1,0,0] op_sel_hi:[1,0,0]
  buffer_load_dwordx4 v7, s[4:7], s13 offen offset:3072 lds
  s_waitcnt lgkmcnt(7)
  v_mfma_f32_32x32x16_bf16 v[44:59], v[144:147], v[84:87], v[44:59]
  ds_read_b128 v[84:87], v5 offset:18432
  v_cvt_pk_bf16_f32 v140, v148, v149
  v_cvt_pk_bf16_f32 v141, v150, v151
  v_cvt_pk_bf16_f32 v142, v152, v153
  v_cvt_pk_bf16_f32 v143, v154, v155
  ds_read_b128 v[156:159], v188 offset:3328
  ds_read_b128 v[172:175], v188 offset:768
  s_waitcnt lgkmcnt(7)
  v_mfma_f32_32x32x16_bf16 v[60:75], v[144:147], v[88:91], v[60:75]
  ds_read_b128 v[88:91], v5 offset:55296
  ds_read_b128 v[160:163], v188 offset:3344
  ds_read_b128 v[176:179], v188 offset:784
  buffer_load_dwordx4 v[120:123], v8, s[4:7], s13 offen offset:3072
  s_waitcnt lgkmcnt(7)
  v_mfma_f32_32x32x16_bf16 v[12:27], v[140:143], v[76:79], v[12:27]
  ds_read_b128 v[76:79], v4 offset:11264
  v_fma_mix_f32 v148, v136, v164, v180 op_sel:[0,0,0] op_sel_hi:[1,0,0]
  v_fma_mix_f32 v149, v136, v165, v181 op_sel:[1,0,0] op_sel_hi:[1,0,0]
  v_fma_mix_f32 v150, v137, v166, v182 op_sel:[0,0,0] op_sel_hi:[1,0,0]
  v_fma_mix_f32 v151, v137, v167, v183 op_sel:[1,0,0] op_sel_hi:[1,0,0]
  s_waitcnt lgkmcnt(7)
  v_mfma_f32_32x32x16_bf16 v[28:43], v[140:143], v[80:83], v[28:43]
  ds_read_b128 v[80:83], v4 offset:48128
  v_fma_mix_f32 v152, v138, v168, v184 op_sel:[0,0,0] op_sel_hi:[1,0,0]
  v_fma_mix_f32 v153, v138, v169, v185 op_sel:[1,0,0] op_sel_hi:[1,0,0]
  v_fma_mix_f32 v154, v139, v170, v186 op_sel:[0,0,0] op_sel_hi:[1,0,0]
  v_fma_mix_f32 v155, v139, v171, v187 op_sel:[1,0,0] op_sel_hi:[1,0,0]
  s_add_u32 m0, s14, 20480
  s_mov_b32 s13, 20480
  s_waitcnt lgkmcnt(7)
  v_mfma_f32_32x32x16_bf16 v[44:59], v[140:143], v[84:87], v[44:59]
  ds_read_b128 v[84:87], v5 offset:19456
  v_cvt_pk_bf16_f32 v144, v148, v149
  v_cvt_pk_bf16_f32 v145, v150, v151
  v_cvt_pk_bf16_f32 v146, v152, v153
  v_cvt_pk_bf16_f32 v147, v154, v155
  ds_read_b128 v[164:167], v188 offset:3392
  ds_read_b128 v[180:183], v188 offset:832
  s_waitcnt lgkmcnt(7)
  v_mfma_f32_32x32x16_bf16 v[60:75], v[140:143], v[88:91], v[60:75]
  ds_read_b128 v[88:91], v5 offset:56320
  ds_read_b128 v[168:171], v188 offset:3408
  ds_read_b128 v[184:187], v188 offset:848
  buffer_load_dwordx4 v7, s[4:7], s13 offen offset:0 lds
  buffer_load_dwordx4 v[124:127], v8, s[4:7], s13 offen offset:0
  buffer_load_dwordx4 v7, s[4:7], s13 offen offset:1024 lds
  buffer_load_dwordx4 v[128:131], v8, s[4:7], s13 offen offset:1024
  s_waitcnt vmcnt(12)
  s_barrier
  s_waitcnt lgkmcnt(7)
  v_mfma_f32_32x32x16_bf16 v[12:27], v[144:147], v[76:79], v[12:27]
  ds_read_b128 v[76:79], v4 offset:12288
  v_fma_mix_f32 v148, v92, v156, v172 op_sel:[0,0,0] op_sel_hi:[1,0,0]
  v_fma_mix_f32 v149, v92, v157, v173 op_sel:[1,0,0] op_sel_hi:[1,0,0]
  v_fma_mix_f32 v150, v93, v158, v174 op_sel:[0,0,0] op_sel_hi:[1,0,0]
  v_fma_mix_f32 v151, v93, v159, v175 op_sel:[1,0,0] op_sel_hi:[1,0,0]
  s_waitcnt lgkmcnt(7)
  v_mfma_f32_32x32x16_bf16 v[28:43], v[144:147], v[80:83], v[28:43]
  ds_read_b128 v[80:83], v4 offset:49152
  v_fma_mix_f32 v152, v94, v160, v176 op_sel:[0,0,0] op_sel_hi:[1,0,0]
  v_fma_mix_f32 v153, v94, v161, v177 op_sel:[1,0,0] op_sel_hi:[1,0,0]
  v_fma_mix_f32 v154, v95, v162, v178 op_sel:[0,0,0] op_sel_hi:[1,0,0]
  v_fma_mix_f32 v155, v95, v163, v179 op_sel:[1,0,0] op_sel_hi:[1,0,0]
  s_waitcnt lgkmcnt(7)
  v_mfma_f32_32x32x16_bf16 v[44:59], v[144:147], v[84:87], v[44:59]
  ds_read_b128 v[84:87], v5 offset:20480
  v_cvt_pk_bf16_f32 v140, v148, v149
  v_cvt_pk_bf16_f32 v141, v150, v151
  v_cvt_pk_bf16_f32 v142, v152, v153
  v_cvt_pk_bf16_f32 v143, v154, v155
  ds_read_b128 v[156:159], v188 offset:3456
  ds_read_b128 v[172:175], v188 offset:896
  s_waitcnt lgkmcnt(7)
  v_mfma_f32_32x32x16_bf16 v[60:75], v[144:147], v[88:91], v[60:75]
  ds_read_b128 v[88:91], v5 offset:57344
  ds_read_b128 v[160:163], v188 offset:3472
  ds_read_b128 v[176:179], v188 offset:912
  s_waitcnt lgkmcnt(7)
  v_mfma_f32_32x32x16_bf16 v[12:27], v[140:143], v[76:79], v[12:27]
  ds_read_b128 v[76:79], v4 offset:13312
  v_fma_mix_f32 v148, v96, v164, v180 op_sel:[0,0,0] op_sel_hi:[1,0,0]
  v_fma_mix_f32 v149, v96, v165, v181 op_sel:[1,0,0] op_sel_hi:[1,0,0]
  v_fma_mix_f32 v150, v97, v166, v182 op_sel:[0,0,0] op_sel_hi:[1,0,0]
  v_fma_mix_f32 v151, v97, v167, v183 op_sel:[1,0,0] op_sel_hi:[1,0,0]
  s_waitcnt lgkmcnt(7)
  v_mfma_f32_32x32x16_bf16 v[28:43], v[140:143], v[80:83], v[28:43]
  ds_read_b128 v[80:83], v4 offset:50176
  v_fma_mix_f32 v152, v98, v168, v184 op_sel:[0,0,0] op_sel_hi:[1,0,0]
  v_fma_mix_f32 v153, v98, v169, v185 op_sel:[1,0,0] op_sel_hi:[1,0,0]
  v_fma_mix_f32 v154, v99, v170, v186 op_sel:[0,0,0] op_sel_hi:[1,0,0]
  v_fma_mix_f32 v155, v99, v171, v187 op_sel:[1,0,0] op_sel_hi:[1,0,0]
  buffer_load_dwordx4 v7, s[4:7], s13 offen offset:2048 lds
  s_waitcnt lgkmcnt(7)
  v_mfma_f32_32x32x16_bf16 v[44:59], v[140:143], v[84:87], v[44:59]
  ds_read_b128 v[84:87], v5 offset:21504
  v_cvt_pk_bf16_f32 v144, v148, v149
  v_cvt_pk_bf16_f32 v145, v150, v151
  v_cvt_pk_bf16_f32 v146, v152, v153
  v_cvt_pk_bf16_f32 v147, v154, v155
  ds_read_b128 v[164:167], v188 offset:3520
  ds_read_b128 v[180:183], v188 offset:960
  s_waitcnt lgkmcnt(7)
  v_mfma_f32_32x32x16_bf16 v[60:75], v[140:143], v[88:91], v[60:75]
  ds_read_b128 v[88:91], v5 offset:58368
  ds_read_b128 v[168:171], v188 offset:3536
  ds_read_b128 v[184:187], v188 offset:976
  buffer_load_dwordx4 v[132:135], v8, s[4:7], s13 offen offset:2048
  s_waitcnt lgkmcnt(7)
  v_mfma_f32_32x32x16_bf16 v[12:27], v[144:147], v[76:79], v[12:27]
  ds_read_b128 v[76:79], v4 offset:14336
  v_fma_mix_f32 v148, v100, v156, v172 op_sel:[0,0,0] op_sel_hi:[1,0,0]
  v_fma_mix_f32 v149, v100, v157, v173 op_sel:[1,0,0] op_sel_hi:[1,0,0]
  v_fma_mix_f32 v150, v101, v158, v174 op_sel:[0,0,0] op_sel_hi:[1,0,0]
  v_fma_mix_f32 v151, v101, v159, v175 op_sel:[1,0,0] op_sel_hi:[1,0,0]
  s_waitcnt lgkmcnt(7)
  v_mfma_f32_32x32x16_bf16 v[28:43], v[144:147], v[80:83], v[28:43]
  ds_read_b128 v[80:83], v4 offset:51200
  v_fma_mix_f32 v152, v102, v160, v176 op_sel:[0,0,0] op_sel_hi:[1,0,0]
  v_fma_mix_f32 v153, v102, v161, v177 op_sel:[1,0,0] op_sel_hi:[1,0,0]
  v_fma_mix_f32 v154, v103, v162, v178 op_sel:[0,0,0] op_sel_hi:[1,0,0]
  v_fma_mix_f32 v155, v103, v163, v179 op_sel:[1,0,0] op_sel_hi:[1,0,0]
  buffer_load_dwordx4 v7, s[4:7], s13 offen offset:3072 lds
  s_waitcnt lgkmcnt(7)
  v_mfma_f32_32x32x16_bf16 v[44:59], v[144:147], v[84:87], v[44:59]
  ds_read_b128 v[84:87], v5 offset:22528
  v_cvt_pk_bf16_f32 v140, v148, v149
  v_cvt_pk_bf16_f32 v141, v150, v151
  v_cvt_pk_bf16_f32 v142, v152, v153
  v_cvt_pk_bf16_f32 v143, v154, v155
  ds_read_b128 v[156:159], v188 offset:3584
  ds_read_b128 v[172:175], v188 offset:1024
  s_waitcnt lgkmcnt(7)
  v_mfma_f32_32x32x16_bf16 v[60:75], v[144:147], v[88:91], v[60:75]
  ds_read_b128 v[88:91], v5 offset:59392
  ds_read_b128 v[160:163], v188 offset:3600
  ds_read_b128 v[176:179], v188 offset:1040
  buffer_load_dwordx4 v[136:139], v8, s[4:7], s13 offen offset:3072
  s_waitcnt lgkmcnt(7)
  v_mfma_f32_32x32x16_bf16 v[12:27], v[140:143], v[76:79], v[12:27]
  ds_read_b128 v[76:79], v4 offset:15360
  v_fma_mix_f32 v148, v104, v164, v180 op_sel:[0,0,0] op_sel_hi:[1,0,0]
  v_fma_mix_f32 v149, v104, v165, v181 op_sel:[1,0,0] op_sel_hi:[1,0,0]
  v_fma_mix_f32 v150, v105, v166, v182 op_sel:[0,0,0] op_sel_hi:[1,0,0]
  v_fma_mix_f32 v151, v105, v167, v183 op_sel:[1,0,0] op_sel_hi:[1,0,0]
  s_waitcnt lgkmcnt(7)
  v_mfma_f32_32x32x16_bf16 v[28:43], v[140:143], v[80:83], v[28:43]
  ds_read_b128 v[80:83], v4 offset:52224
  v_fma_mix_f32 v152, v106, v168, v184 op_sel:[0,0,0] op_sel_hi:[1,0,0]
  v_fma_mix_f32 v153, v106, v169, v185 op_sel:[1,0,0] op_sel_hi:[1,0,0]
  v_fma_mix_f32 v154, v107, v170, v186 op_sel:[0,0,0] op_sel_hi:[1,0,0]
  v_fma_mix_f32 v155, v107, v171, v187 op_sel:[1,0,0] op_sel_hi:[1,0,0]
  s_add_u32 m0, s14, 24576
  s_mov_b32 s13, 24576
  s_waitcnt lgkmcnt(7)
  v_mfma_f32_32x32x16_bf16 v[44:59], v[140:143], v[84:87], v[44:59]
  ds_read_b128 v[84:87], v5 offset:23552
  v_cvt_pk_bf16_f32 v144, v148, v149
  v_cvt_pk_bf16_f32 v145, v150, v151
  v_cvt_pk_bf16_f32 v146, v152, v153
  v_cvt_pk_bf16_f32 v147, v154, v155
  ds_read_b128 v[164:167], v188 offset:3648
  ds_read_b128 v[180:183], v188 offset:1088
  s_waitcnt lgkmcnt(7)
  v_mfma_f32_32x32x16_bf16 v[60:75], v[140:143], v[88:91], v[60:75]
  ds_read_b128 v[88:91], v5 offset:60416
  ds_read_b128 v[168:171], v188 offset:3664
  ds_read_b128 v[184:187], v188 offset:1104
  buffer_load_dwordx4 v7, s[4:7], s13 offen offset:0 lds
  buffer_load_dwordx4 v[92:95], v8, s[4:7], s13 offen offset:0
  buffer_load_dwordx4 v7, s[4:7], s13 offen offset:1024 lds
  buffer_load_dwordx4 v[96:99], v8, s[4:7], s13 offen offset:1024
  s_waitcnt vmcnt(12)
  s_barrier
  s_waitcnt lgkmcnt(7)
  v_mfma_f32_32x32x16_bf16 v[12:27], v[144:147], v[76:79], v[12:27]
  ds_read_b128 v[76:79], v4 offset:16384
  v_fma_mix_f32 v148, v108, v156, v172 op_sel:[0,0,0] op_sel_hi:[1,0,0]
  v_fma_mix_f32 v149, v108, v157, v173 op_sel:[1,0,0] op_sel_hi:[1,0,0]
  v_fma_mix_f32 v150, v109, v158, v174 op_sel:[0,0,0] op_sel_hi:[1,0,0]
  v_fma_mix_f32 v151, v109, v159, v175 op_sel:[1,0,0] op_sel_hi:[1,0,0]
  s_waitcnt lgkmcnt(7)
  v_mfma_f32_32x32x16_bf16 v[28:43], v[144:147], v[80:83], v[28:43]
  ds_read_b128 v[80:83], v4 offset:53248
  v_fma_mix_f32 v152, v110, v160, v176 op_sel:[0,0,0] op_sel_hi:[1,0,0]
  v_fma_mix_f32 v153, v110, v161, v177 op_sel:[1,0,0] op_sel_hi:[1,0,0]
  v_fma_mix_f32 v154, v111, v162, v178 op_sel:[0,0,0] op_sel_hi:[1,0,0]
  v_fma_mix_f32 v155, v111, v163, v179 op_sel:[1,0,0] op_sel_hi:[1,0,0]
  s_waitcnt lgkmcnt(7)
  v_mfma_f32_32x32x16_bf16 v[44:59], v[144:147], v[84:87], v[44:59]
  ds_read_b128 v[84:87], v5 offset:24576
  v_cvt_pk_bf16_f32 v140, v148, v149
  v_cvt_pk_bf16_f32 v141, v150, v151
  v_cvt_pk_bf16_f32 v142, v152, v153
  v_cvt_pk_bf16_f32 v143, v154, v155
  ds_read_b128 v[156:159], v188 offset:3712
  ds_read_b128 v[172:175], v188 offset:1152
  s_waitcnt lgkmcnt(7)
  v_mfma_f32_32x32x16_bf16 v[60:75], v[144:147], v[88:91], v[60:75]
  ds_read_b128 v[88:91], v5 offset:61440
  ds_read_b128 v[160:163], v188 offset:3728
  ds_read_b128 v[176:179], v188 offset:1168
  s_waitcnt lgkmcnt(7)
  v_mfma_f32_32x32x16_bf16 v[12:27], v[140:143], v[76:79], v[12:27]
  ds_read_b128 v[76:79], v4 offset:17408
  v_fma_mix_f32 v148, v112, v164, v180 op_sel:[0,0,0] op_sel_hi:[1,0,0]
  v_fma_mix_f32 v149, v112, v165, v181 op_sel:[1,0,0] op_sel_hi:[1,0,0]
  v_fma_mix_f32 v150, v113, v166, v182 op_sel:[0,0,0] op_sel_hi:[1,0,0]
  v_fma_mix_f32 v151, v113, v167, v183 op_sel:[1,0,0] op_sel_hi:[1,0,0]
  s_waitcnt lgkmcnt(7)
  v_mfma_f32_32x32x16_bf16 v[28:43], v[140:143], v[80:83], v[28:43]
  ds_read_b128 v[80:83], v4 offset:54272
  v_fma_mix_f32 v152, v114, v168, v184 op_sel:[0,0,0] op_sel_hi:[1,0,0]
  v_fma_mix_f32 v153, v114, v169, v185 op_sel:[1,0,0] op_sel_hi:[1,0,0]
  v_fma_mix_f32 v154, v115, v170, v186 op_sel:[0,0,0] op_sel_hi:[1,0,0]
  v_fma_mix_f32 v155, v115, v171, v187 op_sel:[1,0,0] op_sel_hi:[1,0,0]
  buffer_load_dwordx4 v7, s[4:7], s13 offen offset:2048 lds
  s_waitcnt lgkmcnt(7)
  v_mfma_f32_32x32x16_bf16 v[44:59], v[140:143], v[84:87], v[44:59]
  ds_read_b128 v[84:87], v5 offset:25600
  v_cvt_pk_bf16_f32 v144, v148, v149
  v_cvt_pk_bf16_f32 v145, v150, v151
  v_cvt_pk_bf16_f32 v146, v152, v153
  v_cvt_pk_bf16_f32 v147, v154, v155
  ds_read_b128 v[164:167], v188 offset:3776
  ds_read_b128 v[180:183], v188 offset:1216
  s_waitcnt lgkmcnt(7)
  v_mfma_f32_32x32x16_bf16 v[60:75], v[140:143], v[88:91], v[60:75]
  ds_read_b128 v[88:91], v5 offset:62464
  ds_read_b128 v[168:171], v188 offset:3792
  ds_read_b128 v[184:187], v188 offset:1232
  buffer_load_dwordx4 v[100:103], v8, s[4:7], s13 offen offset:2048
  s_waitcnt lgkmcnt(7)
  v_mfma_f32_32x32x16_bf16 v[12:27], v[144:147], v[76:79], v[12:27]
  ds_read_b128 v[76:79], v4 offset:18432
  v_fma_mix_f32 v148, v116, v156, v172 op_sel:[0,0,0] op_sel_hi:[1,0,0]
  v_fma_mix_f32 v149, v116, v157, v173 op_sel:[1,0,0] op_sel_hi:[1,0,0]
  v_fma_mix_f32 v150, v117, v158, v174 op_sel:[0,0,0] op_sel_hi:[1,0,0]
  v_fma_mix_f32 v151, v117, v159, v175 op_sel:[1,0,0] op_sel_hi:[1,0,0]
  s_waitcnt lgkmcnt(7)
  v_mfma_f32_32x32x16_bf16 v[28:43], v[144:147], v[80:83], v[28:43]
  ds_read_b128 v[80:83], v4 offset:55296
  v_fma_mix_f32 v152, v118, v160, v176 op_sel:[0,0,0] op_sel_hi:[1,0,0]
  v_fma_mix_f32 v153, v118, v161, v177 op_sel:[1,0,0] op_sel_hi:[1,0,0]
  v_fma_mix_f32 v154, v119, v162, v178 op_sel:[0,0,0] op_sel_hi:[1,0,0]
  v_fma_mix_f32 v155, v119, v163, v179 op_sel:[1,0,0] op_sel_hi:[1,0,0]
  buffer_load_dwordx4 v7, s[4:7], s13 offen offset:3072 lds
  s_waitcnt lgkmcnt(7)
  v_mfma_f32_32x32x16_bf16 v[44:59], v[144:147], v[84:87], v[44:59]
  ds_read_b128 v[84:87], v5 offset:26624
  v_cvt_pk_bf16_f32 v140, v148, v149
  v_cvt_pk_bf16_f32 v141, v150, v151
  v_cvt_pk_bf16_f32 v142, v152, v153
  v_cvt_pk_bf16_f32 v143, v154, v155
  ds_read_b128 v[156:159], v188 offset:3840
  ds_read_b128 v[172:175], v188 offset:1280
  s_waitcnt lgkmcnt(7)
  v_mfma_f32_32x32x16_bf16 v[60:75], v[144:147], v[88:91], v[60:75]
  ds_read_b128 v[88:91], v5 offset:63488
  ds_read_b128 v[160:163], v188 offset:3856
  ds_read_b128 v[176:179], v188 offset:1296
  buffer_load_dwordx4 v[104:107], v8, s[4:7], s13 offen offset:3072
  s_waitcnt lgkmcnt(7)
  v_mfma_f32_32x32x16_bf16 v[12:27], v[140:143], v[76:79], v[12:27]
  ds_read_b128 v[76:79], v4 offset:19456
  v_fma_mix_f32 v148, v120, v164, v180 op_sel:[0,0,0] op_sel_hi:[1,0,0]
  v_fma_mix_f32 v149, v120, v165, v181 op_sel:[1,0,0] op_sel_hi:[1,0,0]
  v_fma_mix_f32 v150, v121, v166, v182 op_sel:[0,0,0] op_sel_hi:[1,0,0]
  v_fma_mix_f32 v151, v121, v167, v183 op_sel:[1,0,0] op_sel_hi:[1,0,0]
  s_waitcnt lgkmcnt(7)
  v_mfma_f32_32x32x16_bf16 v[28:43], v[140:143], v[80:83], v[28:43]
  ds_read_b128 v[80:83], v4 offset:56320
  v_fma_mix_f32 v152, v122, v168, v184 op_sel:[0,0,0] op_sel_hi:[1,0,0]
  v_fma_mix_f32 v153, v122, v169, v185 op_sel:[1,0,0] op_sel_hi:[1,0,0]
  v_fma_mix_f32 v154, v123, v170, v186 op_sel:[0,0,0] op_sel_hi:[1,0,0]
  v_fma_mix_f32 v155, v123, v171, v187 op_sel:[1,0,0] op_sel_hi:[1,0,0]
  s_add_u32 m0, s14, 28672
  s_mov_b32 s13, 28672
  s_waitcnt lgkmcnt(7)
  v_mfma_f32_32x32x16_bf16 v[44:59], v[140:143], v[84:87], v[44:59]
  ds_read_b128 v[84:87], v5 offset:27648
  v_cvt_pk_bf16_f32 v144, v148, v149
  v_cvt_pk_bf16_f32 v145, v150, v151
  v_cvt_pk_bf16_f32 v146, v152, v153
  v_cvt_pk_bf16_f32 v147, v154, v155
  ds_read_b128 v[164:167], v188 offset:3904
  ds_read_b128 v[180:183], v188 offset:1344
  s_waitcnt lgkmcnt(7)
  v_mfma_f32_32x32x16_bf16 v[60:75], v[140:143], v[88:91], v[60:75]
  ds_read_b128 v[88:91], v5 offset:64512
  ds_read_b128 v[168:171], v188 offset:3920
  ds_read_b128 v[184:187], v188 offset:1360
  buffer_load_dwordx4 v7, s[4:7], s13 offen offset:0 lds
  buffer_load_dwordx4 v[108:111], v8, s[4:7], s13 offen offset:0
  buffer_load_dwordx4 v7, s[4:7], s13 offen offset:1024 lds
  buffer_load_dwordx4 v[112:115], v8, s[4:7], s13 offen offset:1024
  s_waitcnt vmcnt(12)
  s_barrier
  s_waitcnt lgkmcnt(7)
  v_mfma_f32_32x32x16_bf16 v[12:27], v[144:147], v[76:79], v[12:27]
  ds_read_b128 v[76:79], v4 offset:20480
  v_fma_mix_f32 v148, v124, v156, v172 op_sel:[0,0,0] op_sel_hi:[1,0,0]
  v_fma_mix_f32 v149, v124, v157, v173 op_sel:[1,0,0] op_sel_hi:[1,0,0]
  v_fma_mix_f32 v150, v125, v158, v174 op_sel:[0,0,0] op_sel_hi:[1,0,0]
  v_fma_mix_f32 v151, v125, v159, v175 op_sel:[1,0,0] op_sel_hi:[1,0,0]
  s_waitcnt lgkmcnt(7)
  v_mfma_f32_32x32x16_bf16 v[28:43], v[144:147], v[80:83], v[28:43]
  ds_read_b128 v[80:83], v4 offset:57344
  v_fma_mix_f32 v152, v126, v160, v176 op_sel:[0,0,0] op_sel_hi:[1,0,0]
  v_fma_mix_f32 v153, v126, v161, v177 op_sel:[1,0,0] op_sel_hi:[1,0,0]
  v_fma_mix_f32 v154, v127, v162, v178 op_sel:[0,0,0] op_sel_hi:[1,0,0]
  v_fma_mix_f32 v155, v127, v163, v179 op_sel:[1,0,0] op_sel_hi:[1,0,0]
  s_waitcnt lgkmcnt(7)
  v_mfma_f32_32x32x16_bf16 v[44:59], v[144:147], v[84:87], v[44:59]
  ds_read_b128 v[84:87], v5 offset:28672
  v_cvt_pk_bf16_f32 v140, v148, v149
  v_cvt_pk_bf16_f32 v141, v150, v151
  v_cvt_pk_bf16_f32 v142, v152, v153
  v_cvt_pk_bf16_f32 v143, v154, v155
  ds_read_b128 v[156:159], v188 offset:3968
  ds_read_b128 v[172:175], v188 offset:1408
  s_waitcnt lgkmcnt(7)
  v_mfma_f32_32x32x16_bf16 v[60:75], v[144:147], v[88:91], v[60:75]
  ds_read_b128 v[88:91], v6 offset:0
  ds_read_b128 v[160:163], v188 offset:3984
  ds_read_b128 v[176:179], v188 offset:1424
  s_waitcnt lgkmcnt(7)
  v_mfma_f32_32x32x16_bf16 v[12:27], v[140:143], v[76:79], v[12:27]
  ds_read_b128 v[76:79], v4 offset:21504
  v_fma_mix_f32 v148, v128, v164, v180 op_sel:[0,0,0] op_sel_hi:[1,0,0]
  v_fma_mix_f32 v149, v128, v165, v181 op_sel:[1,0,0] op_sel_hi:[1,0,0]
  v_fma_mix_f32 v150, v129, v166, v182 op_sel:[0,0,0] op_sel_hi:[1,0,0]
  v_fma_mix_f32 v151, v129, v167, v183 op_sel:[1,0,0] op_sel_hi:[1,0,0]
  s_waitcnt lgkmcnt(7)
  v_mfma_f32_32x32x16_bf16 v[28:43], v[140:143], v[80:83], v[28:43]
  ds_read_b128 v[80:83], v4 offset:58368
  v_fma_mix_f32 v152, v130, v168, v184 op_sel:[0,0,0] op_sel_hi:[1,0,0]
  v_fma_mix_f32 v153, v130, v169, v185 op_sel:[1,0,0] op_sel_hi:[1,0,0]
  v_fma_mix_f32 v154, v131, v170, v186 op_sel:[0,0,0] op_sel_hi:[1,0,0]
  v_fma_mix_f32 v155, v131, v171, v187 op_sel:[1,0,0] op_sel_hi:[1,0,0]
  buffer_load_dwordx4 v7, s[4:7], s13 offen offset:2048 lds
  s_waitcnt lgkmcnt(7)
  v_mfma_f32_32x32x16_bf16 v[44:59], v[140:143], v[84:87], v[44:59]
  ds_read_b128 v[84:87], v5 offset:29696
  v_cvt_pk_bf16_f32 v144, v148, v149
  v_cvt_pk_bf16_f32 v145, v150, v151
  v_cvt_pk_bf16_f32 v146, v152, v153
  v_cvt_pk_bf16_f32 v147, v154, v155
  ds_read_b128 v[164:167], v188 offset:4032
  ds_read_b128 v[180:183], v188 offset:1472
  s_waitcnt lgkmcnt(7)
  v_mfma_f32_32x32x16_bf16 v[60:75], v[140:143], v[88:91], v[60:75]
  ds_read_b128 v[88:91], v6 offset:1024
  ds_read_b128 v[168:171], v188 offset:4048
  ds_read_b128 v[184:187], v188 offset:1488
  buffer_load_dwordx4 v[116:119], v8, s[4:7], s13 offen offset:2048
  s_waitcnt lgkmcnt(7)
  v_mfma_f32_32x32x16_bf16 v[12:27], v[144:147], v[76:79], v[12:27]
  ds_read_b128 v[76:79], v4 offset:22528
  v_fma_mix_f32 v148, v132, v156, v172 op_sel:[0,0,0] op_sel_hi:[1,0,0]
  v_fma_mix_f32 v149, v132, v157, v173 op_sel:[1,0,0] op_sel_hi:[1,0,0]
  v_fma_mix_f32 v150, v133, v158, v174 op_sel:[0,0,0] op_sel_hi:[1,0,0]
  v_fma_mix_f32 v151, v133, v159, v175 op_sel:[1,0,0] op_sel_hi:[1,0,0]
  s_waitcnt lgkmcnt(7)
  v_mfma_f32_32x32x16_bf16 v[28:43], v[144:147], v[80:83], v[28:43]
  ds_read_b128 v[80:83], v4 offset:59392
  v_fma_mix_f32 v152, v134, v160, v176 op_sel:[0,0,0] op_sel_hi:[1,0,0]
  v_fma_mix_f32 v153, v134, v161, v177 op_sel:[1,0,0] op_sel_hi:[1,0,0]
  v_fma_mix_f32 v154, v135, v162, v178 op_sel:[0,0,0] op_sel_hi:[1,0,0]
  v_fma_mix_f32 v155, v135, v163, v179 op_sel:[1,0,0] op_sel_hi:[1,0,0]
  buffer_load_dwordx4 v7, s[4:7], s13 offen offset:3072 lds
  s_waitcnt lgkmcnt(7)
  v_mfma_f32_32x32x16_bf16 v[44:59], v[144:147], v[84:87], v[44:59]
  ds_read_b128 v[84:87], v5 offset:30720
  v_cvt_pk_bf16_f32 v140, v148, v149
  v_cvt_pk_bf16_f32 v141, v150, v151
  v_cvt_pk_bf16_f32 v142, v152, v153
  v_cvt_pk_bf16_f32 v143, v154, v155
  ds_read_b128 v[156:159], v188 offset:4096
  ds_read_b128 v[172:175], v188 offset:1536
  s_waitcnt lgkmcnt(7)
  v_mfma_f32_32x32x16_bf16 v[60:75], v[144:147], v[88:91], v[60:75]
  ds_read_b128 v[88:91], v6 offset:2048
  ds_read_b128 v[160:163], v188 offset:4112
  ds_read_b128 v[176:179], v188 offset:1552
  buffer_load_dwordx4 v[120:123], v8, s[4:7], s13 offen offset:3072
  s_waitcnt lgkmcnt(7)
  v_mfma_f32_32x32x16_bf16 v[12:27], v[140:143], v[76:79], v[12:27]
  ds_read_b128 v[76:79], v4 offset:23552
  v_fma_mix_f32 v148, v136, v164, v180 op_sel:[0,0,0] op_sel_hi:[1,0,0]
  v_fma_mix_f32 v149, v136, v165, v181 op_sel:[1,0,0] op_sel_hi:[1,0,0]
  v_fma_mix_f32 v150, v137, v166, v182 op_sel:[0,0,0] op_sel_hi:[1,0,0]
  v_fma_mix_f32 v151, v137, v167, v183 op_sel:[1,0,0] op_sel_hi:[1,0,0]
  s_waitcnt lgkmcnt(7)
  v_mfma_f32_32x32x16_bf16 v[28:43], v[140:143], v[80:83], v[28:43]
  ds_read_b128 v[80:83], v4 offset:60416
  v_fma_mix_f32 v152, v138, v168, v184 op_sel:[0,0,0] op_sel_hi:[1,0,0]
  v_fma_mix_f32 v153, v138, v169, v185 op_sel:[1,0,0] op_sel_hi:[1,0,0]
  v_fma_mix_f32 v154, v139, v170, v186 op_sel:[0,0,0] op_sel_hi:[1,0,0]
  v_fma_mix_f32 v155, v139, v171, v187 op_sel:[1,0,0] op_sel_hi:[1,0,0]
  s_add_u32 m0, s14, 32768
  s_mov_b32 s13, 32768
  s_waitcnt lgkmcnt(7)
  v_mfma_f32_32x32x16_bf16 v[44:59], v[140:143], v[84:87], v[44:59]
  ds_read_b128 v[84:87], v5 offset:31744
  v_cvt_pk_bf16_f32 v144, v148, v149
  v_cvt_pk_bf16_f32 v145, v150, v151
  v_cvt_pk_bf16_f32 v146, v152, v153
  v_cvt_pk_bf16_f32 v147, v154, v155
  ds_read_b128 v[164:167], v188 offset:4160
  ds_read_b128 v[180:183], v188 offset:1600
  s_waitcnt lgkmcnt(7)
  v_mfma_f32_32x32x16_bf16 v[60:75], v[140:143], v[88:91], v[60:75]
  ds_read_b128 v[88:91], v6 offset:3072
  ds_read_b128 v[168:171], v188 offset:4176
  ds_read_b128 v[184:187], v188 offset:1616
  buffer_load_dwordx4 v7, s[4:7], s13 offen offset:0 lds
  buffer_load_dwordx4 v[124:127], v8, s[4:7], s13 offen offset:0
  buffer_load_dwordx4 v7, s[4:7], s13 offen offset:1024 lds
  buffer_load_dwordx4 v[128:131], v8, s[4:7], s13 offen offset:1024
  s_waitcnt vmcnt(12)
  s_barrier
  s_waitcnt lgkmcnt(7)
  v_mfma_f32_32x32x16_bf16 v[12:27], v[144:147], v[76:79], v[12:27]
  ds_read_b128 v[76:79], v4 offset:24576
  v_fma_mix_f32 v148, v92, v156, v172 op_sel:[0,0,0] op_sel_hi:[1,0,0]
  v_fma_mix_f32 v149, v92, v157, v173 op_sel:[1,0,0] op_sel_hi:[1,0,0]
  v_fma_mix_f32 v150, v93, v158, v174 op_sel:[0,0,0] op_sel_hi:[1,0,0]
  v_fma_mix_f32 v151, v93, v159, v175 op_sel:[1,0,0] op_sel_hi:[1,0,0]
  s_waitcnt lgkmcnt(7)
  v_mfma_f32_32x32x16_bf16 v[28:43], v[144:147], v[80:83], v[28:43]
  ds_read_b128 v[80:83], v4 offset:61440
  v_fma_mix_f32 v152, v94, v160, v176 op_sel:[0,0,0] op_sel_hi:[1,0,0]
  v_fma_mix_f32 v153, v94, v161, v177 op_sel:[1,0,0] op_sel_hi:[1,0,0]
  v_fma_mix_f32 v154, v95, v162, v178 op_sel:[0,0,0] op_sel_hi:[1,0,0]
  v_fma_mix_f32 v155, v95, v163, v179 op_sel:[1,0,0] op_sel_hi:[1,0,0]
  s_waitcnt lgkmcnt(7)
  v_mfma_f32_32x32x16_bf16 v[44:59], v[144:147], v[84:87], v[44:59]
  ds_read_b128 v[84:87], v5 offset:32768
  v_cvt_pk_bf16_f32 v140, v148, v149
  v_cvt_pk_bf16_f32 v141, v150, v151
  v_cvt_pk_bf16_f32 v142, v152, v153
  v_cvt_pk_bf16_f32 v143, v154, v155
  ds_read_b128 v[156:159], v188 offset:4224
  ds_read_b128 v[172:175], v188 offset:1664
  s_waitcnt lgkmcnt(7)
  v_mfma_f32_32x32x16_bf16 v[60:75], v[144:147], v[88:91], v[60:75]
  ds_read_b128 v[88:91], v6 offset:4096
  ds_read_b128 v[160:163], v188 offset:4240
  ds_read_b128 v[176:179], v188 offset:1680
  s_waitcnt lgkmcnt(7)
  v_mfma_f32_32x32x16_bf16 v[12:27], v[140:143], v[76:79], v[12:27]
  ds_read_b128 v[76:79], v4 offset:25600
  v_fma_mix_f32 v148, v96, v164, v180 op_sel:[0,0,0] op_sel_hi:[1,0,0]
  v_fma_mix_f32 v149, v96, v165, v181 op_sel:[1,0,0] op_sel_hi:[1,0,0]
  v_fma_mix_f32 v150, v97, v166, v182 op_sel:[0,0,0] op_sel_hi:[1,0,0]
  v_fma_mix_f32 v151, v97, v167, v183 op_sel:[1,0,0] op_sel_hi:[1,0,0]
  s_waitcnt lgkmcnt(7)
  v_mfma_f32_32x32x16_bf16 v[28:43], v[140:143], v[80:83], v[28:43]
  ds_read_b128 v[80:83], v4 offset:62464
  v_fma_mix_f32 v152, v98, v168, v184 op_sel:[0,0,0] op_sel_hi:[1,0,0]
  v_fma_mix_f32 v153, v98, v169, v185 op_sel:[1,0,0] op_sel_hi:[1,0,0]
  v_fma_mix_f32 v154, v99, v170, v186 op_sel:[0,0,0] op_sel_hi:[1,0,0]
  v_fma_mix_f32 v155, v99, v171, v187 op_sel:[1,0,0] op_sel_hi:[1,0,0]
  buffer_load_dwordx4 v7, s[4:7], s13 offen offset:2048 lds
  s_waitcnt lgkmcnt(7)
  v_mfma_f32_32x32x16_bf16 v[44:59], v[140:143], v[84:87], v[44:59]
  ds_read_b128 v[84:87], v5 offset:33792
  v_cvt_pk_bf16_f32 v144, v148, v149
  v_cvt_pk_bf16_f32 v145, v150, v151
  v_cvt_pk_bf16_f32 v146, v152, v153
  v_cvt_pk_bf16_f32 v147, v154, v155
  ds_read_b128 v[164:167], v188 offset:4288
  ds_read_b128 v[180:183], v188 offset:1728
  s_waitcnt lgkmcnt(7)
  v_mfma_f32_32x32x16_bf16 v[60:75], v[140:143], v[88:91], v[60:75]
  ds_read_b128 v[88:91], v6 offset:5120
  ds_read_b128 v[168:171], v188 offset:4304
  ds_read_b128 v[184:187], v188 offset:1744
  buffer_load_dwordx4 v[132:135], v8, s[4:7], s13 offen offset:2048
  s_waitcnt lgkmcnt(7)
  v_mfma_f32_32x32x16_bf16 v[12:27], v[144:147], v[76:79], v[12:27]
  ds_read_b128 v[76:79], v4 offset:26624
  v_fma_mix_f32 v148, v100, v156, v172 op_sel:[0,0,0] op_sel_hi:[1,0,0]
  v_fma_mix_f32 v149, v100, v157, v173 op_sel:[1,0,0] op_sel_hi:[1,0,0]
  v_fma_mix_f32 v150, v101, v158, v174 op_sel:[0,0,0] op_sel_hi:[1,0,0]
  v_fma_mix_f32 v151, v101, v159, v175 op_sel:[1,0,0] op_sel_hi:[1,0,0]
  s_waitcnt lgkmcnt(7)
  v_mfma_f32_32x32x16_bf16 v[28:43], v[144:147], v[80:83], v[28:43]
  ds_read_b128 v[80:83], v4 offset:63488
  v_fma_mix_f32 v152, v102, v160, v176 op_sel:[0,0,0] op_sel_hi:[1,0,0]
  v_fma_mix_f32 v153, v102, v161, v177 op_sel:[1,0,0] op_sel_hi:[1,0,0]
  v_fma_mix_f32 v154, v103, v162, v178 op_sel:[0,0,0] op_sel_hi:[1,0,0]
  v_fma_mix_f32 v155, v103, v163, v179 op_sel:[1,0,0] op_sel_hi:[1,0,0]
  buffer_load_dwordx4 v7, s[4:7], s13 offen offset:3072 lds
  s_waitcnt lgkmcnt(7)
  v_mfma_f32_32x32x16_bf16 v[44:59], v[144:147], v[84:87], v[44:59]
  ds_read_b128 v[84:87], v5 offset:34816
  v_cvt_pk_bf16_f32 v140, v148, v149
  v_cvt_pk_bf16_f32 v141, v150, v151
  v_cvt_pk_bf16_f32 v142, v152, v153
  v_cvt_pk_bf16_f32 v143, v154, v155
  ds_read_b128 v[156:159], v188 offset:4352
  ds_read_b128 v[172:175], v188 offset:1792
  s_waitcnt lgkmcnt(7)
  v_mfma_f32_32x32x16_bf16 v[60:75], v[144:147], v[88:91], v[60:75]
  ds_read_b128 v[88:91], v6 offset:6144
  ds_read_b128 v[160:163], v188 offset:4368
  ds_read_b128 v[176:179], v188 offset:1808
  buffer_load_dwordx4 v[136:139], v8, s[4:7], s13 offen offset:3072
  s_waitcnt lgkmcnt(7)
  v_mfma_f32_32x32x16_bf16 v[12:27], v[140:143], v[76:79], v[12:27]
  ds_read_b128 v[76:79], v4 offset:27648
  v_fma_mix_f32 v148, v104, v164, v180 op_sel:[0,0,0] op_sel_hi:[1,0,0]
  v_fma_mix_f32 v149, v104, v165, v181 op_sel:[1,0,0] op_sel_hi:[1,0,0]
  v_fma_mix_f32 v150, v105, v166, v182 op_sel:[0,0,0] op_sel_hi:[1,0,0]
  v_fma_mix_f32 v151, v105, v167, v183 op_sel:[1,0,0] op_sel_hi:[1,0,0]
  s_waitcnt lgkmcnt(7)
  v_mfma_f32_32x32x16_bf16 v[28:43], v[140:143], v[80:83], v[28:43]
  ds_read_b128 v[80:83], v4 offset:64512
  v_fma_mix_f32 v152, v106, v168, v184 op_sel:[0,0,0] op_sel_hi:[1,0,0]
  v_fma_mix_f32 v153, v106, v169, v185 op_sel:[1,0,0] op_sel_hi:[1,0,0]
  v_fma_mix_f32 v154, v107, v170, v186 op_sel:[0,0,0] op_sel_hi:[1,0,0]
  v_fma_mix_f32 v155, v107, v171, v187 op_sel:[1,0,0] op_sel_hi:[1,0,0]
  s_add_u32 m0, s14, 0
  s_mov_b32 s13, 36864
  s_waitcnt lgkmcnt(7)
  v_mfma_f32_32x32x16_bf16 v[44:59], v[140:143], v[84:87], v[44:59]
  ds_read_b128 v[84:87], v5 offset:35840
  v_cvt_pk_bf16_f32 v144, v148, v149
  v_cvt_pk_bf16_f32 v145, v150, v151
  v_cvt_pk_bf16_f32 v146, v152, v153
  v_cvt_pk_bf16_f32 v147, v154, v155
  ds_read_b128 v[164:167], v188 offset:4416
  ds_read_b128 v[180:183], v188 offset:1856
  s_waitcnt lgkmcnt(7)
  v_mfma_f32_32x32x16_bf16 v[60:75], v[140:143], v[88:91], v[60:75]
  ds_read_b128 v[88:91], v6 offset:7168
  ds_read_b128 v[168:171], v188 offset:4432
  ds_read_b128 v[184:187], v188 offset:1872
  buffer_load_dwordx4 v7, s[4:7], s13 offen offset:0 lds
  buffer_load_dwordx4 v[92:95], v8, s[4:7], s13 offen offset:0
  buffer_load_dwordx4 v7, s[4:7], s13 offen offset:1024 lds
  buffer_load_dwordx4 v[96:99], v8, s[4:7], s13 offen offset:1024
  s_waitcnt vmcnt(12)
  s_barrier
  s_waitcnt lgkmcnt(7)
  v_mfma_f32_32x32x16_bf16 v[12:27], v[144:147], v[76:79], v[12:27]
  ds_read_b128 v[76:79], v4 offset:28672
  v_fma_mix_f32 v148, v108, v156, v172 op_sel:[0,0,0] op_sel_hi:[1,0,0]
  v_fma_mix_f32 v149, v108, v157, v173 op_sel:[1,0,0] op_sel_hi:[1,0,0]
  v_fma_mix_f32 v150, v109, v158, v174 op_sel:[0,0,0] op_sel_hi:[1,0,0]
  v_fma_mix_f32 v151, v109, v159, v175 op_sel:[1,0,0] op_sel_hi:[1,0,0]
  s_waitcnt lgkmcnt(7)
  v_mfma_f32_32x32x16_bf16 v[28:43], v[144:147], v[80:83], v[28:43]
  ds_read_b128 v[80:83], v5 offset:0
  v_fma_mix_f32 v152, v110, v160, v176 op_sel:[0,0,0] op_sel_hi:[1,0,0]
  v_fma_mix_f32 v153, v110, v161, v177 op_sel:[1,0,0] op_sel_hi:[1,0,0]
  v_fma_mix_f32 v154, v111, v162, v178 op_sel:[0,0,0] op_sel_hi:[1,0,0]
  v_fma_mix_f32 v155, v111, v163, v179 op_sel:[1,0,0] op_sel_hi:[1,0,0]
  s_waitcnt lgkmcnt(7)
  v_mfma_f32_32x32x16_bf16 v[44:59], v[144:147], v[84:87], v[44:59]
  ds_read_b128 v[84:87], v5 offset:36864
  v_cvt_pk_bf16_f32 v140, v148, v149
  v_cvt_pk_bf16_f32 v141, v150, v151
  v_cvt_pk_bf16_f32 v142, v152, v153
  v_cvt_pk_bf16_f32 v143, v154, v155
  ds_read_b128 v[156:159], v188 offset:4480
  ds_read_b128 v[172:175], v188 offset:1920
  s_waitcnt lgkmcnt(7)
  v_mfma_f32_32x32x16_bf16 v[60:75], v[144:147], v[88:91], v[60:75]
  ds_read_b128 v[88:91], v6 offset:8192
  ds_read_b128 v[160:163], v188 offset:4496
  ds_read_b128 v[176:179], v188 offset:1936
  s_waitcnt lgkmcnt(7)
  v_mfma_f32_32x32x16_bf16 v[12:27], v[140:143], v[76:79], v[12:27]
  ds_read_b128 v[76:79], v4 offset:29696
  v_fma_mix_f32 v148, v112, v164, v180 op_sel:[0,0,0] op_sel_hi:[1,0,0]
  v_fma_mix_f32 v149, v112, v165, v181 op_sel:[1,0,0] op_sel_hi:[1,0,0]
  v_fma_mix_f32 v150, v113, v166, v182 op_sel:[0,0,0] op_sel_hi:[1,0,0]
  v_fma_mix_f32 v151, v113, v167, v183 op_sel:[1,0,0] op_sel_hi:[1,0,0]
  s_waitcnt lgkmcnt(7)
  v_mfma_f32_32x32x16_bf16 v[28:43], v[140:143], v[80:83], v[28:43]
  ds_read_b128 v[80:83], v5 offset:1024
  v_fma_mix_f32 v152, v114, v168, v184 op_sel:[0,0,0] op_sel_hi:[1,0,0]
  v_fma_mix_f32 v153, v114, v169, v185 op_sel:[1,0,0] op_sel_hi:[1,0,0]
  v_fma_mix_f32 v154, v115, v170, v186 op_sel:[0,0,0] op_sel_hi:[1,0,0]
  v_fma_mix_f32 v155, v115, v171, v187 op_sel:[1,0,0] op_sel_hi:[1,0,0]
  buffer_load_dwordx4 v7, s[4:7], s13 offen offset:2048 lds
  s_waitcnt lgkmcnt(7)
  v_mfma_f32_32x32x16_bf16 v[44:59], v[140:143], v[84:87], v[44:59]
  ds_read_b128 v[84:87], v5 offset:37888
  v_cvt_pk_bf16_f32 v144, v148, v149
  v_cvt_pk_bf16_f32 v145, v150, v151
  v_cvt_pk_bf16_f32 v146, v152, v153
  v_cvt_pk_bf16_f32 v147, v154, v155
  ds_read_b128 v[164:167], v188 offset:4544
  ds_read_b128 v[180:183], v188 offset:1984
  s_waitcnt lgkmcnt(7)
  v_mfma_f32_32x32x16_bf16 v[60:75], v[140:143], v[88:91], v[60:75]
  ds_read_b128 v[88:91], v6 offset:9216
  ds_read_b128 v[168:171], v188 offset:4560
  ds_read_b128 v[184:187], v188 offset:2000
  buffer_load_dwordx4 v[100:103], v8, s[4:7], s13 offen offset:2048
  s_waitcnt lgkmcnt(7)
  v_mfma_f32_32x32x16_bf16 v[12:27], v[144:147], v[76:79], v[12:27]
  ds_read_b128 v[76:79], v4 offset:30720
  v_fma_mix_f32 v148, v116, v156, v172 op_sel:[0,0,0] op_sel_hi:[1,0,0]
  v_fma_mix_f32 v149, v116, v157, v173 op_sel:[1,0,0] op_sel_hi:[1,0,0]
  v_fma_mix_f32 v150, v117, v158, v174 op_sel:[0,0,0] op_sel_hi:[1,0,0]
  v_fma_mix_f32 v151, v117, v159, v175 op_sel:[1,0,0] op_sel_hi:[1,0,0]
  s_waitcnt lgkmcnt(7)
  v_mfma_f32_32x32x16_bf16 v[28:43], v[144:147], v[80:83], v[28:43]
  ds_read_b128 v[80:83], v5 offset:2048
  v_fma_mix_f32 v152, v118, v160, v176 op_sel:[0,0,0] op_sel_hi:[1,0,0]
  v_fma_mix_f32 v153, v118, v161, v177 op_sel:[1,0,0] op_sel_hi:[1,0,0]
  v_fma_mix_f32 v154, v119, v162, v178 op_sel:[0,0,0] op_sel_hi:[1,0,0]
  v_fma_mix_f32 v155, v119, v163, v179 op_sel:[1,0,0] op_sel_hi:[1,0,0]
  buffer_load_dwordx4 v7, s[4:7], s13 offen offset:3072 lds
  s_waitcnt lgkmcnt(7)
  v_mfma_f32_32x32x16_bf16 v[44:59], v[144:147], v[84:87], v[44:59]
  ds_read_b128 v[84:87], v5 offset:38912
  v_cvt_pk_bf16_f32 v140, v148, v149
  v_cvt_pk_bf16_f32 v141, v150, v151
  v_cvt_pk_bf16_f32 v142, v152, v153
  v_cvt_pk_bf16_f32 v143, v154, v155
  ds_read_b128 v[156:159], v188 offset:4608
  ds_read_b128 v[172:175], v188 offset:2048
  s_waitcnt lgkmcnt(7)
  v_mfma_f32_32x32x16_bf16 v[60:75], v[144:147], v[88:91], v[60:75]
  ds_read_b128 v[88:91], v6 offset:10240
  ds_read_b128 v[160:163], v188 offset:4624
  ds_read_b128 v[176:179], v188 offset:2064
  buffer_load_dwordx4 v[104:107], v8, s[4:7], s13 offen offset:3072
  s_waitcnt lgkmcnt(7)
  v_mfma_f32_32x32x16_bf16 v[12:27], v[140:143], v[76:79], v[12:27]
  ds_read_b128 v[76:79], v4 offset:31744
  v_fma_mix_f32 v148, v120, v164, v180 op_sel:[0,0,0] op_sel_hi:[1,0,0]
  v_fma_mix_f32 v149, v120, v165, v181 op_sel:[1,0,0] op_sel_hi:[1,0,0]
  v_fma_mix_f32 v150, v121, v166, v182 op_sel:[0,0,0] op_sel_hi:[1,0,0]
  v_fma_mix_f32 v151, v121, v167, v183 op_sel:[1,0,0] op_sel_hi:[1,0,0]
  s_waitcnt lgkmcnt(7)
  v_mfma_f32_32x32x16_bf16 v[28:43], v[140:143], v[80:83], v[28:43]
  ds_read_b128 v[80:83], v5 offset:3072
  v_fma_mix_f32 v152, v122, v168, v184 op_sel:[0,0,0] op_sel_hi:[1,0,0]
  v_fma_mix_f32 v153, v122, v169, v185 op_sel:[1,0,0] op_sel_hi:[1,0,0]
  v_fma_mix_f32 v154, v123, v170, v186 op_sel:[0,0,0] op_sel_hi:[1,0,0]
  v_fma_mix_f32 v155, v123, v171, v187 op_sel:[1,0,0] op_sel_hi:[1,0,0]
  s_waitcnt lgkmcnt(7)
  v_mfma_f32_32x32x16_bf16 v[44:59], v[140:143], v[84:87], v[44:59]
  ds_read_b128 v[84:87], v5 offset:39936
  v_cvt_pk_bf16_f32 v144, v148, v149
  v_cvt_pk_bf16_f32 v145, v150, v151
  v_cvt_pk_bf16_f32 v146, v152, v153
  v_cvt_pk_bf16_f32 v147, v154, v155
  ds_read_b128 v[164:167], v188 offset:4672
  ds_read_b128 v[180:183], v188 offset:2112
  s_waitcnt lgkmcnt(7)
  v_mfma_f32_32x32x16_bf16 v[60:75], v[140:143], v[88:91], v[60:75]
  ds_read_b128 v[88:91], v6 offset:11264
  ds_read_b128 v[168:171], v188 offset:4688
  ds_read_b128 v[184:187], v188 offset:2128
  s_waitcnt vmcnt(8)
  s_barrier
  s_waitcnt lgkmcnt(7)
  v_mfma_f32_32x32x16_bf16 v[12:27], v[144:147], v[76:79], v[12:27]
  ds_read_b128 v[76:79], v4 offset:32768
  v_fma_mix_f32 v148, v124, v156, v172 op_sel:[0,0,0] op_sel_hi:[1,0,0]
  v_fma_mix_f32 v149, v124, v157, v173 op_sel:[1,0,0] op_sel_hi:[1,0,0]
  v_fma_mix_f32 v150, v125, v158, v174 op_sel:[0,0,0] op_sel_hi:[1,0,0]
  v_fma_mix_f32 v151, v125, v159, v175 op_sel:[1,0,0] op_sel_hi:[1,0,0]
  s_waitcnt lgkmcnt(7)
  v_mfma_f32_32x32x16_bf16 v[28:43], v[144:147], v[80:83], v[28:43]
  ds_read_b128 v[80:83], v5 offset:4096
  v_fma_mix_f32 v152, v126, v160, v176 op_sel:[0,0,0] op_sel_hi:[1,0,0]
  v_fma_mix_f32 v153, v126, v161, v177 op_sel:[1,0,0] op_sel_hi:[1,0,0]
  v_fma_mix_f32 v154, v127, v162, v178 op_sel:[0,0,0] op_sel_hi:[1,0,0]
  v_fma_mix_f32 v155, v127, v163, v179 op_sel:[1,0,0] op_sel_hi:[1,0,0]
  s_waitcnt lgkmcnt(7)
  v_mfma_f32_32x32x16_bf16 v[44:59], v[144:147], v[84:87], v[44:59]
  ds_read_b128 v[84:87], v5 offset:40960
  v_cvt_pk_bf16_f32 v140, v148, v149
  v_cvt_pk_bf16_f32 v141, v150, v151
  v_cvt_pk_bf16_f32 v142, v152, v153
  v_cvt_pk_bf16_f32 v143, v154, v155
  ds_read_b128 v[156:159], v188 offset:4736
  ds_read_b128 v[172:175], v188 offset:2176
  s_waitcnt lgkmcnt(7)
  v_mfma_f32_32x32x16_bf16 v[60:75], v[144:147], v[88:91], v[60:75]
  ds_read_b128 v[88:91], v6 offset:12288
  ds_read_b128 v[160:163], v188 offset:4752
  ds_read_b128 v[176:179], v188 offset:2192
  s_waitcnt lgkmcnt(7)
  v_mfma_f32_32x32x16_bf16 v[12:27], v[140:143], v[76:79], v[12:27]
  ds_read_b128 v[76:79], v4 offset:33792
  v_fma_mix_f32 v148, v128, v164, v180 op_sel:[0,0,0] op_sel_hi:[1,0,0]
  v_fma_mix_f32 v149, v128, v165, v181 op_sel:[1,0,0] op_sel_hi:[1,0,0]
  v_fma_mix_f32 v150, v129, v166, v182 op_sel:[0,0,0] op_sel_hi:[1,0,0]
  v_fma_mix_f32 v151, v129, v167, v183 op_sel:[1,0,0] op_sel_hi:[1,0,0]
  s_waitcnt lgkmcnt(7)
  v_mfma_f32_32x32x16_bf16 v[28:43], v[140:143], v[80:83], v[28:43]
  ds_read_b128 v[80:83], v5 offset:5120
  v_fma_mix_f32 v152, v130, v168, v184 op_sel:[0,0,0] op_sel_hi:[1,0,0]
  v_fma_mix_f32 v153, v130, v169, v185 op_sel:[1,0,0] op_sel_hi:[1,0,0]
  v_fma_mix_f32 v154, v131, v170, v186 op_sel:[0,0,0] op_sel_hi:[1,0,0]
  v_fma_mix_f32 v155, v131, v171, v187 op_sel:[1,0,0] op_sel_hi:[1,0,0]
  s_waitcnt lgkmcnt(7)
  v_mfma_f32_32x32x16_bf16 v[44:59], v[140:143], v[84:87], v[44:59]
  ds_read_b128 v[84:87], v5 offset:41984
  v_cvt_pk_bf16_f32 v144, v148, v149
  v_cvt_pk_bf16_f32 v145, v150, v151
  v_cvt_pk_bf16_f32 v146, v152, v153
  v_cvt_pk_bf16_f32 v147, v154, v155
  ds_read_b128 v[164:167], v188 offset:4800
  ds_read_b128 v[180:183], v188 offset:2240
  s_waitcnt lgkmcnt(7)
  v_mfma_f32_32x32x16_bf16 v[60:75], v[140:143], v[88:91], v[60:75]
  ds_read_b128 v[88:91], v6 offset:13312
  ds_read_b128 v[168:171], v188 offset:4816
  ds_read_b128 v[184:187], v188 offset:2256
  s_waitcnt lgkmcnt(7)
  v_mfma_f32_32x32x16_bf16 v[12:27], v[144:147], v[76:79], v[12:27]
  ds_read_b128 v[76:79], v4 offset:34816
  v_fma_mix_f32 v148, v132, v156, v172 op_sel:[0,0,0] op_sel_hi:[1,0,0]
  v_fma_mix_f32 v149, v132, v157, v173 op_sel:[1,0,0] op_sel_hi:[1,0,0]
  v_fma_mix_f32 v150, v133, v158, v174 op_sel:[0,0,0] op_sel_hi:[1,0,0]
  v_fma_mix_f32 v151, v133, v159, v175 op_sel:[1,0,0] op_sel_hi:[1,0,0]
  s_waitcnt lgkmcnt(7)
  v_mfma_f32_32x32x16_bf16 v[28:43], v[144:147], v[80:83], v[28:43]
  ds_read_b128 v[80:83], v5 offset:6144
  v_fma_mix_f32 v152, v134, v160, v176 op_sel:[0,0,0] op_sel_hi:[1,0,0]
  v_fma_mix_f32 v153, v134, v161, v177 op_sel:[1,0,0] op_sel_hi:[1,0,0]
  v_fma_mix_f32 v154, v135, v162, v178 op_sel:[0,0,0] op_sel_hi:[1,0,0]
  v_fma_mix_f32 v155, v135, v163, v179 op_sel:[1,0,0] op_sel_hi:[1,0,0]
  s_waitcnt lgkmcnt(7)
  v_mfma_f32_32x32x16_bf16 v[44:59], v[144:147], v[84:87], v[44:59]
  ds_read_b128 v[84:87], v5 offset:43008
  v_cvt_pk_bf16_f32 v140, v148, v149
  v_cvt_pk_bf16_f32 v141, v150, v151
  v_cvt_pk_bf16_f32 v142, v152, v153
  v_cvt_pk_bf16_f32 v143, v154, v155
  ds_read_b128 v[156:159], v188 offset:4864
  ds_read_b128 v[172:175], v188 offset:2304
  s_waitcnt lgkmcnt(7)
  v_mfma_f32_32x32x16_bf16 v[60:75], v[144:147], v[88:91], v[60:75]
  ds_read_b128 v[88:91], v6 offset:14336
  ds_read_b128 v[160:163], v188 offset:4880
  ds_read_b128 v[176:179], v188 offset:2320
  s_waitcnt lgkmcnt(7)
  v_mfma_f32_32x32x16_bf16 v[12:27], v[140:143], v[76:79], v[12:27]
  ds_read_b128 v[76:79], v4 offset:35840
  v_fma_mix_f32 v148, v136, v164, v180 op_sel:[0,0,0] op_sel_hi:[1,0,0]
  v_fma_mix_f32 v149, v136, v165, v181 op_sel:[1,0,0] op_sel_hi:[1,0,0]
  v_fma_mix_f32 v150, v137, v166, v182 op_sel:[0,0,0] op_sel_hi:[1,0,0]
  v_fma_mix_f32 v151, v137, v167, v183 op_sel:[1,0,0] op_sel_hi:[1,0,0]
  s_waitcnt lgkmcnt(7)
  v_mfma_f32_32x32x16_bf16 v[28:43], v[140:143], v[80:83], v[28:43]
  ds_read_b128 v[80:83], v5 offset:7168
  v_fma_mix_f32 v152, v138, v168, v184 op_sel:[0,0,0] op_sel_hi:[1,0,0]
  v_fma_mix_f32 v153, v138, v169, v185 op_sel:[1,0,0] op_sel_hi:[1,0,0]
  v_fma_mix_f32 v154, v139, v170, v186 op_sel:[0,0,0] op_sel_hi:[1,0,0]
  v_fma_mix_f32 v155, v139, v171, v187 op_sel:[1,0,0] op_sel_hi:[1,0,0]
  s_waitcnt lgkmcnt(7)
  v_mfma_f32_32x32x16_bf16 v[44:59], v[140:143], v[84:87], v[44:59]
  ds_read_b128 v[84:87], v5 offset:44032
  v_cvt_pk_bf16_f32 v144, v148, v149
  v_cvt_pk_bf16_f32 v145, v150, v151
  v_cvt_pk_bf16_f32 v146, v152, v153
  v_cvt_pk_bf16_f32 v147, v154, v155
  ds_read_b128 v[164:167], v188 offset:4928
  ds_read_b128 v[180:183], v188 offset:2368
  s_waitcnt lgkmcnt(7)
  v_mfma_f32_32x32x16_bf16 v[60:75], v[140:143], v[88:91], v[60:75]
  ds_read_b128 v[88:91], v6 offset:15360
  ds_read_b128 v[168:171], v188 offset:4944
  ds_read_b128 v[184:187], v188 offset:2384
  s_waitcnt vmcnt(4)
  s_barrier
  s_waitcnt lgkmcnt(7)
  v_mfma_f32_32x32x16_bf16 v[12:27], v[144:147], v[76:79], v[12:27]
  ds_read_b128 v[76:79], v4 offset:0
  v_fma_mix_f32 v148, v92, v156, v172 op_sel:[0,0,0] op_sel_hi:[1,0,0]
  v_fma_mix_f32 v149, v92, v157, v173 op_sel:[1,0,0] op_sel_hi:[1,0,0]
  v_fma_mix_f32 v150, v93, v158, v174 op_sel:[0,0,0] op_sel_hi:[1,0,0]
  v_fma_mix_f32 v151, v93, v159, v175 op_sel:[1,0,0] op_sel_hi:[1,0,0]
  s_waitcnt lgkmcnt(7)
  v_mfma_f32_32x32x16_bf16 v[28:43], v[144:147], v[80:83], v[28:43]
  ds_read_b128 v[80:83], v4 offset:36864
  v_fma_mix_f32 v152, v94, v160, v176 op_sel:[0,0,0] op_sel_hi:[1,0,0]
  v_fma_mix_f32 v153, v94, v161, v177 op_sel:[1,0,0] op_sel_hi:[1,0,0]
  v_fma_mix_f32 v154, v95, v162, v178 op_sel:[0,0,0] op_sel_hi:[1,0,0]
  v_fma_mix_f32 v155, v95, v163, v179 op_sel:[1,0,0] op_sel_hi:[1,0,0]
  s_waitcnt lgkmcnt(7)
  v_mfma_f32_32x32x16_bf16 v[44:59], v[144:147], v[84:87], v[44:59]
  ds_read_b128 v[84:87], v5 offset:8192
  v_cvt_pk_bf16_f32 v140, v148, v149
  v_cvt_pk_bf16_f32 v141, v150, v151
  v_cvt_pk_bf16_f32 v142, v152, v153
  v_cvt_pk_bf16_f32 v143, v154, v155
  ds_read_b128 v[156:159], v188 offset:4992
  ds_read_b128 v[172:175], v188 offset:2432
  s_waitcnt lgkmcnt(7)
  v_mfma_f32_32x32x16_bf16 v[60:75], v[144:147], v[88:91], v[60:75]
  ds_read_b128 v[88:91], v5 offset:45056
  ds_read_b128 v[160:163], v188 offset:5008
  ds_read_b128 v[176:179], v188 offset:2448
  s_waitcnt lgkmcnt(7)
  v_mfma_f32_32x32x16_bf16 v[12:27], v[140:143], v[76:79], v[12:27]
  ds_read_b128 v[76:79], v4 offset:1024
  v_fma_mix_f32 v148, v96, v164, v180 op_sel:[0,0,0] op_sel_hi:[1,0,0]
  v_fma_mix_f32 v149, v96, v165, v181 op_sel:[1,0,0] op_sel_hi:[1,0,0]
  v_fma_mix_f32 v150, v97, v166, v182 op_sel:[0,0,0] op_sel_hi:[1,0,0]
  v_fma_mix_f32 v151, v97, v167, v183 op_sel:[1,0,0] op_sel_hi:[1,0,0]
  s_waitcnt lgkmcnt(7)
  v_mfma_f32_32x32x16_bf16 v[28:43], v[140:143], v[80:83], v[28:43]
  ds_read_b128 v[80:83], v4 offset:37888
  v_fma_mix_f32 v152, v98, v168, v184 op_sel:[0,0,0] op_sel_hi:[1,0,0]
  v_fma_mix_f32 v153, v98, v169, v185 op_sel:[1,0,0] op_sel_hi:[1,0,0]
  v_fma_mix_f32 v154, v99, v170, v186 op_sel:[0,0,0] op_sel_hi:[1,0,0]
  v_fma_mix_f32 v155, v99, v171, v187 op_sel:[1,0,0] op_sel_hi:[1,0,0]
  s_waitcnt lgkmcnt(7)
  v_mfma_f32_32x32x16_bf16 v[44:59], v[140:143], v[84:87], v[44:59]
  ds_read_b128 v[84:87], v5 offset:9216
  v_cvt_pk_bf16_f32 v144, v148, v149
  v_cvt_pk_bf16_f32 v145, v150, v151
  v_cvt_pk_bf16_f32 v146, v152, v153
  v_cvt_pk_bf16_f32 v147, v154, v155
  ds_read_b128 v[164:167], v188 offset:5056
  ds_read_b128 v[180:183], v188 offset:2496
  s_waitcnt lgkmcnt(7)
  v_mfma_f32_32x32x16_bf16 v[60:75], v[140:143], v[88:91], v[60:75]
  ds_read_b128 v[88:91], v5 offset:46080
  ds_read_b128 v[168:171], v188 offset:5072
  ds_read_b128 v[184:187], v188 offset:2512
  s_waitcnt vmcnt(0)
  s_barrier
  s_waitcnt lgkmcnt(7)
  v_mfma_f32_32x32x16_bf16 v[12:27], v[144:147], v[76:79], v[12:27]
  ds_read_b128 v[76:79], v4 offset:2048
  v_fma_mix_f32 v148, v100, v156, v172 op_sel:[0,0,0] op_sel_hi:[1,0,0]
  v_fma_mix_f32 v149, v100, v157, v173 op_sel:[1,0,0] op_sel_hi:[1,0,0]
  v_fma_mix_f32 v150, v101, v158, v174 op_sel:[0,0,0] op_sel_hi:[1,0,0]
  v_fma_mix_f32 v151, v101, v159, v175 op_sel:[1,0,0] op_sel_hi:[1,0,0]
  s_waitcnt lgkmcnt(7)
  v_mfma_f32_32x32x16_bf16 v[28:43], v[144:147], v[80:83], v[28:43]
  ds_read_b128 v[80:83], v4 offset:38912
  v_fma_mix_f32 v152, v102, v160, v176 op_sel:[0,0,0] op_sel_hi:[1,0,0]
  v_fma_mix_f32 v153, v102, v161, v177 op_sel:[1,0,0] op_sel_hi:[1,0,0]
  v_fma_mix_f32 v154, v103, v162, v178 op_sel:[0,0,0] op_sel_hi:[1,0,0]
  v_fma_mix_f32 v155, v103, v163, v179 op_sel:[1,0,0] op_sel_hi:[1,0,0]
  s_waitcnt lgkmcnt(7)
  v_mfma_f32_32x32x16_bf16 v[44:59], v[144:147], v[84:87], v[44:59]
  ds_read_b128 v[84:87], v5 offset:10240
  v_cvt_pk_bf16_f32 v140, v148, v149
  v_cvt_pk_bf16_f32 v141, v150, v151
  v_cvt_pk_bf16_f32 v142, v152, v153
  v_cvt_pk_bf16_f32 v143, v154, v155
  s_waitcnt lgkmcnt(5)
  v_mfma_f32_32x32x16_bf16 v[60:75], v[144:147], v[88:91], v[60:75]
  ds_read_b128 v[88:91], v5 offset:47104
  s_waitcnt lgkmcnt(3)
  v_mfma_f32_32x32x16_bf16 v[12:27], v[140:143], v[76:79], v[12:27]
  ds_read_b128 v[76:79], v4 offset:3072
  v_fma_mix_f32 v148, v104, v164, v180 op_sel:[0,0,0] op_sel_hi:[1,0,0]
  v_fma_mix_f32 v149, v104, v165, v181 op_sel:[1,0,0] op_sel_hi:[1,0,0]
  v_fma_mix_f32 v150, v105, v166, v182 op_sel:[0,0,0] op_sel_hi:[1,0,0]
  v_fma_mix_f32 v151, v105, v167, v183 op_sel:[1,0,0] op_sel_hi:[1,0,0]
  s_waitcnt lgkmcnt(3)
  v_mfma_f32_32x32x16_bf16 v[28:43], v[140:143], v[80:83], v[28:43]
  ds_read_b128 v[80:83], v4 offset:39936
  v_fma_mix_f32 v152, v106, v168, v184 op_sel:[0,0,0] op_sel_hi:[1,0,0]
  v_fma_mix_f32 v153, v106, v169, v185 op_sel:[1,0,0] op_sel_hi:[1,0,0]
  v_fma_mix_f32 v154, v107, v170, v186 op_sel:[0,0,0] op_sel_hi:[1,0,0]
  v_fma_mix_f32 v155, v107, v171, v187 op_sel:[1,0,0] op_sel_hi:[1,0,0]
  s_waitcnt lgkmcnt(3)
  v_mfma_f32_32x32x16_bf16 v[44:59], v[140:143], v[84:87], v[44:59]
  ds_read_b128 v[84:87], v5 offset:11264
  v_cvt_pk_bf16_f32 v144, v148, v149
  v_cvt_pk_bf16_f32 v145, v150, v151
  v_cvt_pk_bf16_f32 v146, v152, v153
  v_cvt_pk_bf16_f32 v147, v154, v155
  s_waitcnt lgkmcnt(3)
  v_mfma_f32_32x32x16_bf16 v[60:75], v[140:143], v[88:91], v[60:75]
  ds_read_b128 v[88:91], v5 offset:48128
  s_waitcnt lgkmcnt(3)
  v_mfma_f32_32x32x16_bf16 v[12:27], v[144:147], v[76:79], v[12:27]
  s_waitcnt lgkmcnt(2)
  v_mfma_f32_32x32x16_bf16 v[28:43], v[144:147], v[80:83], v[28:43]
  s_waitcnt lgkmcnt(1)
  v_mfma_f32_32x32x16_bf16 v[44:59], v[144:147], v[84:87], v[44:59]
  s_waitcnt lgkmcnt(0)
  v_mfma_f32_32x32x16_bf16 v[60:75], v[144:147], v[88:91], v[60:75]
  s_lshl_b32 s22, s9, 2
  s_add_u32 s22, s22, s8
  s_mul_i32 s22, s22, 2560
  s_add_u32 s22, s22, 7755008
  s_lshl_b32 s11, s10, 7
  s_sub_u32 s11, s11, 1280
  v_and_b32 v92, 31, v2
  v_add_u32 v92, s11, v92
  v_lshrrev_b32 v93, 5, v2
  v_mul_u32_u24 v93, 320, v93
  v_mul_u32_u24 v94, 3277, v92
  v_lshrrev_b32 v94, 16, v94
  v_mul_u32_u24 v95, 163520, v94
  v_lshl_add_u32 v96, v92, 4, v93
  v_add_u32 v96, v96, v95
  v_add_u32 v92, 32, v92
  v_cvt_pk_bf16_f32 v76, v12, v13
  v_cvt_pk_bf16_f32 v77, v14, v15
  v_cvt_pk_bf16_f32 v78, v16, v17
  v_cvt_pk_bf16_f32 v79, v18, v19
  v_cvt_pk_bf16_f32 v80, v20, v21
  v_cvt_pk_bf16_f32 v81, v22, v23
  v_cvt_pk_bf16_f32 v82, v24, v25
  v_cvt_pk_bf16_f32 v83, v26, v27
  buffer_store_dwordx4 v[76:79], v96, s[4:7], s22 offen sc1
  buffer_store_dwordx4 v[80:83], v96, s[4:7], s22 offen offset:640 sc1
  v_mul_u32_u24 v94, 3277, v92
  v_lshrrev_b32 v94, 16, v94
  v_mul_u32_u24 v95, 163520, v94
  v_lshl_add_u32 v97, v92, 4, v93
  v_add_u32 v97, v97, v95
  v_add_u32 v92, 32, v92
  v_cvt_pk_bf16_f32 v84, v28, v29
  v_cvt_pk_bf16_f32 v85, v30, v31
  v_cvt_pk_bf16_f32 v86, v32, v33
  v_cvt_pk_bf16_f32 v87, v34, v35
  v_cvt_pk_bf16_f32 v88, v36, v37
  v_cvt_pk_bf16_f32 v89, v38, v39
  v_cvt_pk_bf16_f32 v90, v40, v41
  v_cvt_pk_bf16_f32 v91, v42, v43
  buffer_store_dwordx4 v[84:87], v97, s[4:7], s22 offen sc1
  buffer_store_dwordx4 v[88:91], v97, s[4:7], s22 offen offset:640 sc1
  v_mul_u32_u24 v94, 3277, v92
  v_lshrrev_b32 v94, 16, v94
  v_mul_u32_u24 v95, 163520, v94
  v_lshl_add_u32 v98, v92, 4, v93
  v_add_u32 v98, v98, v95
  v_add_u32 v92, 32, v92
  v_cvt_pk_bf16_f32 v76, v44, v45
  v_cvt_pk_bf16_f32 v77, v46, v47
  v_cvt_pk_bf16_f32 v78, v48, v49
  v_cvt_pk_bf16_f32 v79, v50, v51
  v_cvt_pk_bf16_f32 v80, v52, v53
  v_cvt_pk_bf16_f32 v81, v54, v55
  v_cvt_pk_bf16_f32 v82, v56, v57
  v_cvt_pk_bf16_f32 v83, v58, v59
  buffer_store_dwordx4 v[76:79], v98, s[4:7], s22 offen sc1
  buffer_store_dwordx4 v[80:83], v98, s[4:7], s22 offen offset:640 sc1
  v_mul_u32_u24 v94, 3277, v92
  v_lshrrev_b32 v94, 16, v94
  v_mul_u32_u24 v95, 163520, v94
  v_lshl_add_u32 v99, v92, 4, v93
  v_add_u32 v99, v99, v95
  v_add_u32 v92, 32, v92
  v_cvt_pk_bf16_f32 v84, v60, v61
  v_cvt_pk_bf16_f32 v85, v62, v63
  v_cvt_pk_bf16_f32 v86, v64, v65
  v_cvt_pk_bf16_f32 v87, v66, v67
  v_cvt_pk_bf16_f32 v88, v68, v69
  v_cvt_pk_bf16_f32 v89, v70, v71
  v_cvt_pk_bf16_f32 v90, v72, v73
  v_cvt_pk_bf16_f32 v91, v74, v75
  buffer_store_dwordx4 v[84:87], v99, s[4:7], s22 offen sc1
  buffer_store_dwordx4 v[88:91], v99, s[4:7], s22 offen offset:640 sc1
  s_endpgm
k2_kernel_mod3:
  s_cmp_lg_u32 s9, 10
  s_cbranch_scc1 k2_kernel_z14
  v_mov_b32 v16, 0
  v_mov_b32 v17, 0
  v_mov_b32 v18, 0
  v_mov_b32 v19, 0
  v_lshlrev_b32 v9, 4, v0
  s_mov_b32 s23, 35921920
  s_waitcnt lgkmcnt(0)
  buffer_store_dwordx4 v[16:19], v9, s[4:7], s23 offen
  s_mov_b32 s23, 35926016
  buffer_store_dwordx4 v[16:19], v9, s[4:7], s23 offen
k2_kernel_z14:
  s_cmp_ge_u32 s9, 10
  s_cbranch_scc1 k2_kernel_end1
  s_lshl_b32 s23, s9, 8
  v_add_u32 v8, s23, v0
  v_lshlrev_b32 v9, 2, v8
  s_mov_b32 s23, 5120
  s_waitcnt lgkmcnt(0)
  buffer_load_dword v12, v9, s[4:7], s23 offen
  s_mov_b32 s23, 20480
  buffer_load_dword v13, v9, s[4:7], s23 offen
  v_mul_u32_u24 v11, 13108, v8
  v_lshrrev_b32 v11, 23, v11
  v_cmp_eq_u32 vcc, 2, v11
  v_mov_b32 v14, 1.0
  v_mul_u32_u24 v10, 640, v11
  v_cndmask_b32 v14, 0, v14, vcc
  v_sub_u32 v8, v8, v10
  s_waitcnt vmcnt(0)
  v_add_f32 v12, v12, v13
  v_cvt_pk_bf16_f32 v12, v12, v12
  v_lshlrev_b32 v12, 16, v12
  v_add_f32 v12, v14, v12
  v_cvt_pk_bf16_f32 v13, v12, v12
  v_lshlrev_b32 v12, 16, v13
  s_mov_b32 s23, 37888
  buffer_store_dword v12, v9, s[4:7], s23 offen
  v_lshrrev_b32 v9, 4, v8
  v_lshlrev_b32 v9, 6, v9
  v_bfe_u32 v10, v8, 2, 1
  v_lshl_add_u32 v9, v10, 5, v9
  v_bfe_u32 v10, v8, 3, 1
  v_lshl_add_u32 v9, v10, 3, v9
  v_and_b32 v10, 3, v8
  v_lshl_add_u32 v9, v10, 1, v9
  v_and_b32 v10, 1, v11
  v_lshl_add_u32 v9, v10, 4, v9
  v_subrev_u32 v11, 1, v11
  v_cmp_gt_u32 vcc, 2, v11
  s_mov_b32 s23, 49152
  s_and_b64 exec, exec, vcc
  s_cbranch_execz k2_kernel_end1
  buffer_store_short v13, v9, s[4:7], s23 offen
k2_kernel_end1:
  s_endpgm
.globl k3_kernel
.p2align 8
.type k3_kernel,@function
k3_kernel:
  s_cmp_ge_u32 s2, 256
  s_cbranch_scc1 k3_kernel_end1
  s_load_dwordx2 s[4:5], s[0:1], 88
  s_mov_b32 s6, 35930112
  s_mov_b32 s7, 0x20000
  s_load_dwordx2 s[8:9], s[0:1], 16
  s_load_dwordx2 s[10:11], s[0:1], 32
  s_load_dwordx2 s[12:13], s[0:1], 40
  s_load_dwordx2 s[14:15], s[0:1], 48
  s_load_dwordx2 s[16:17], s[0:1], 0
  s_mov_b32 s18, 2621440
  s_mov_b32 s19, 0x20000
  v_lshrrev_b32 v1, 6, v0
  v_and_b32 v2, 63, v0
  v_readfirstlane_b32 s20, v1
  s_and_b32 s21, s2, 31
  s_lshr_b32 s22, s2, 5
  s_lshl_b32 s22, s22, 3
  s_add_u32 s22, s22, s20
  v_lshlrev_b32 v3, 4, v2
  v_lshlrev_b32 v8, 4, v2
  v_and_b32 v5, 31, v2
  v_lshrrev_b32 v6, 5, v2
  s_add_u32 s25, s20, 1
  s_mul_i32 s26, s21, 163840
  s_add_u32 s30, s26, 7753728
  s_lshl_b32 s23, s21, 6
  s_add_u32 s23, s23, s22
  s_mul_i32 s23, s23, 1280
  s_add_u32 s23, s23, 5132288
  v_lshlrev_b32 v9, 3, v5
  s_waitcnt lgkmcnt(0)
  s_cmp_ge_u32 s20, 4
  s_cbranch_scc1 k3_kernel_q2
  buffer_load_dwordx4 v[16:19], v3, s[4:7], s23 offen
  buffer_load_dwordx2 v[20:21], v9, s[4:7], s23 offen offset:1024
  buffer_load_dwordx4 v[24:27], v8, s[4:7], s30 offen
  buffer_load_dwordx2 v[32:33], v9, s[4:7], s30 offen offset:1024
k3_kernel_q2:
  s_mul_i32 s24, s25, 205
  s_lshl_b32 s26, s25, 10
  s_lshr_b32 s24, s24, 10
  s_lshl_b32 s24, s24, 4
  s_add_u32 s24, s24, s26
  s_sub_u32 m0, s24, 1024
  s_add_u32 s26, s26, s30
  buffer_load_dwordx4 v8, s[4:7], s26 offen lds
  s_add_u32 s25, s25, 8
  s_mul_i32 s24, s25, 205
  s_lshl_b32 s26, s25, 10
  s_lshr_b32 s24, s24, 10
  s_lshl_b32 s24, s24, 4
  s_add_u32 s24, s24, s26
  s_sub_u32 m0, s24, 1024
  s_add_u32 s26, s26, s30
  buffer_load_dwordx4 v8, s[4:7], s26 offen lds
  s_add_u32 s25, s25, 8
  s_mul_i32 s24, s25, 205
  s_lshl_b32 s26, s25, 10
  s_lshr_b32 s24, s24, 10
  s_lshl_b32 s24, s24, 4
  s_add_u32 s24, s24, s26
  s_sub_u32 m0, s24, 1024
  s_add_u32 s26, s26, s30
  buffer_load_dwordx4 v8, s[4:7], s26 offen lds
  s_add_u32 s25, s25, 8
  v_mov_b32 v117, 0
  v_mov_b32 v118, 0
  v_mov_b32 v119, 0
  v_mov_b32 v120, 0
  v_mov_b32 v121, 0
  v_mov_b32 v122, 0
  s_mov_b32 s44, s14
  s_mov_b32 s45, s15
  s_mov_b32 s46, 0
  s_mov_b32 s47, 0x20000
  v_mad_u32_u24 v10, v6, 20, v5
  v_lshlrev_b32 v10, 4, v10
  v_mov_b32 v7, 0x40000
  v_cmp_lt_u32 vcc, 20, v5
  v_mov_b32 v116, 0xdddd
  s_mov_b32 s28, 0
  v_cndmask_b32 v10, v10, v7, vcc
  v_cmp_eq_u32 vcc, 20, v5
  v_add_u32 v11, 640, v10
  v_mov_b32 v7, 1280
  v_cndmask_b32 v12, v10, v7, vcc
  v_cndmask_b32 v13, v11, v7, vcc
  v_mov_b32 v7, 3840
  v_cndmask_b32 v10, v10, v7, vcc
  v_cndmask_b32 v11, v11, v7, vcc
  v_mul_u32_u24 v7, 5136, v5
  v_mov_b32 v100, 0x3f803f80
  v_mov_b32 v101, 0x3f803f80
  v_mov_b32 v102, 0x3f803f80
  v_mov_b32 v103, 0x3f803f80
  ds_write_b128 v7, v[100:103] offset:4096
  s_cmp_ge_u32 s20, 4
  s_cselect_b32 s29, 182, 6
  s_mov_b32 s55, 1024
  s_cmp_lt_u32 s20, 4
  s_cbranch_scc1 k3_kernel_go3
  s_waitcnt vmcnt(0) lgkmcnt(0)
  s_barrier
  s_sub_u32 s25, s25, 4
  buffer_load_dwordx4 v[16:19], v3, s[4:7], s23 offen
  buffer_load_dwordx2 v[20:21], v9, s[4:7], s23 offen offset:1024
  buffer_load_dwordx4 v[24:27], v8, s[4:7], s30 offen
  buffer_load_dwordx2 v[32:33], v9, s[4:7], s30 offen offset:1024
  s_mul_i32 s24, s25, 205
  s_lshl_b32 s26, s25, 10
  s_lshr_b32 s24, s24, 10
  s_lshl_b32 s24, s24, 4
  s_add_u32 s24, s24, s26
  s_sub_u32 m0, s24, 1024
  s_add_u32 s26, s26, s30
  buffer_load_dwordx4 v8, s[4:7], s26 offen lds
  s_add_u32 s25, s25, 4
  s_mul_i32 s24, s25, 205
  s_lshl_b32 s26, s25, 10
  s_lshr_b32 s24, s24, 10
  s_lshl_b32 s24, s24, 4
  s_add_u32 s24, s24, s26
  s_sub_u32 m0, s24, 1024
  s_add_u32 s26, s26, s30
  buffer_load_dwordx4 v8, s[4:7], s26 offen lds
  s_add_u32 s25, s25, 4
  s_mul_i32 s24, s25, 205
  s_lshl_b32 s26, s25, 10
  s_lshr_b32 s24, s24, 10
  s_lshl_b32 s24, s24, 4
  s_add_u32 s24, s24, s26
  s_sub_u32 m0, s24, 1024
  s_add_u32 s26, s26, s30
  buffer_load_dwordx4 v8, s[4:7], s26 offen lds
  s_add_u32 s25, s25, 4
  s_mul_i32 s24, s25, 205
  s_lshl_b32 s26, s25, 10
  s_lshr_b32 s24, s24, 10
  s_lshl_b32 s24, s24, 4
  s_add_u32 s24, s24, s26
  s_sub_u32 m0, s24, 1024
  s_add_u32 s26, s26, s30
  buffer_load_dwordx4 v8, s[4:7], s26 offen lds
  s_add_u32 s25, s25, 4
  s_mul_i32 s24, s25, 205
  s_lshl_b32 s26, s25, 10
  s_lshr_b32 s24, s24, 10
  s_lshl_b32 s24, s24, 4
  s_add_u32 s24, s24, s26
  s_sub_u32 m0, s24, 1024
  s_add_u32 s26, s26, s30
  buffer_load_dwordx4 v8, s[4:7], s26 offen lds
  s_add_u32 s25, s25, 4
  s_mul_i32 s24, s25, 205
  s_lshl_b32 s26, s25, 10
  s_lshr_b32 s24, s24, 10
  s_lshl_b32 s24, s24, 4
  s_add_u32 s24, s24, s26
  s_sub_u32 m0, s24, 1024
  s_add_u32 s26, s26, s30
  buffer_load_dwordx4 v8, s[4:7], s26 offen lds
  s_add_u32 s25, s25, 4
  s_mul_i32 s24, s25, 205
  s_lshl_b32 s26, s25, 10
  s_lshr_b32 s24, s24, 10
  s_lshl_b32 s24, s24, 4
  s_add_u32 s24, s24, s26
  s_sub_u32 m0, s24, 1024
  s_add_u32 s26, s26, s30
  buffer_load_dwordx4 v8, s[4:7], s26 offen lds
  s_add_u32 s25, s25, 4
  s_mul_i32 s24, s25, 205
  s_lshl_b32 s26, s25, 10
  s_lshr_b32 s24, s24, 10
  s_lshl_b32 s24, s24, 4
  s_add_u32 s24, s24, s26
  s_sub_u32 m0, s24, 1024
  s_add_u32 s26, s26, s30
  buffer_load_dwordx4 v8, s[4:7], s26 offen lds
  s_add_u32 s25, s25, 4
  s_mul_i32 s24, s25, 205
  s_lshl_b32 s26, s25, 10
  s_lshr_b32 s24, s24, 10
  s_lshl_b32 s24, s24, 4
  s_add_u32 s24, s24, s26
  s_sub_u32 m0, s24, 1024
  s_add_u32 s26, s26, s30
  buffer_load_dwordx4 v8, s[4:7], s26 offen lds
  s_add_u32 s25, s25, 4
  s_mul_i32 s24, s25, 205
  s_lshl_b32 s26, s25, 10
  s_lshr_b32 s24, s24, 10
  s_lshl_b32 s24, s24, 4
  s_add_u32 s24, s24, s26
  s_sub_u32 m0, s24, 1024
  s_add_u32 s26, s26, s30
  buffer_load_dwordx4 v8, s[4:7], s26 offen lds
  s_add_u32 s25, s25, 4
  s_mul_i32 s24, s25, 205
  s_lshl_b32 s26, s25, 10
  s_lshr_b32 s24, s24, 10
  s_lshl_b32 s24, s24, 4
  s_add_u32 s24, s24, s26
  s_sub_u32 m0, s24, 1024
  s_add_u32 s26, s26, s30
  buffer_load_dwordx4 v8, s[4:7], s26 offen lds
  s_add_u32 s25, s25, 4
  s_mul_i32 s24, s25, 205
  s_lshl_b32 s26, s25, 10
  s_lshr_b32 s24, s24, 10
  s_lshl_b32 s24, s24, 4
  s_add_u32 s24, s24, s26
  s_sub_u32 m0, s24, 1024
  s_add_u32 s26, s26, s30
  buffer_load_dwordx4 v8, s[4:7], s26 offen lds
  s_add_u32 s25, s25, 4
  s_mul_i32 s24, s25, 205
  s_lshl_b32 s26, s25, 10
  s_lshr_b32 s24, s24, 10
  s_lshl_b32 s24, s24, 4
  s_add_u32 s24, s24, s26
  s_sub_u32 m0, s24, 1024
  s_add_u32 s26, s26, s30
  buffer_load_dwordx4 v8, s[4:7], s26 offen lds
  s_add_u32 s25, s25, 4
  s_mul_i32 s24, s25, 205
  s_lshl_b32 s26, s25, 10
  s_lshr_b32 s24, s24, 10
  s_lshl_b32 s24, s24, 4
  s_add_u32 s24, s24, s26
  s_sub_u32 m0, s24, 1024
  s_add_u32 s26, s26, s30
  buffer_load_dwordx4 v8, s[4:7], s26 offen lds
  s_add_u32 s25, s25, 4
  s_mul_i32 s24, s25, 205
  s_lshl_b32 s26, s25, 10
  s_lshr_b32 s24, s24, 10
  s_lshl_b32 s24, s24, 4
  s_add_u32 s24, s24, s26
  s_sub_u32 m0, s24, 1024
  s_add_u32 s26, s26, s30
  buffer_load_dwordx4 v8, s[4:7], s26 offen lds
  s_add_u32 s25, s25, 4
  s_mul_i32 s24, s25, 205
  s_lshl_b32 s26, s25, 10
  s_lshr_b32 s24, s24, 10
  s_lshl_b32 s24, s24, 4
  s_add_u32 s24, s24, s26
  s_sub_u32 m0, s24, 1024
  s_add_u32 s26, s26, s30
  buffer_load_dwordx4 v8, s[4:7], s26 offen lds
  s_add_u32 s25, s25, 4
  s_waitcnt vmcnt(11)
  s_barrier
  s_mul_i32 s24, s25, 205
  s_lshl_b32 s26, s25, 10
  s_lshr_b32 s24, s24, 10
  s_lshl_b32 s24, s24, 4
  s_add_u32 s24, s24, s26
  s_sub_u32 m0, s24, 1024
  s_add_u32 s26, s26, s30
  buffer_load_dwordx4 v8, s[4:7], s26 offen lds
  s_add_u32 s25, s25, 4
  s_mul_i32 s24, s25, 205
  s_lshl_b32 s26, s25, 10
  s_lshr_b32 s24, s24, 10
  s_lshl_b32 s24, s24, 4
  s_add_u32 s24, s24, s26
  s_sub_u32 m0, s24, 1024
  s_add_u32 s26, s26, s30
  buffer_load_dwordx4 v8, s[4:7], s26 offen lds
  s_add_u32 s25, s25, 4
  s_mul_i32 s24, s25, 205
  s_lshl_b32 s26, s25, 10
  s_lshr_b32 s24, s24, 10
  s_lshl_b32 s24, s24, 4
  s_add_u32 s24, s24, s26
  s_sub_u32 m0, s24, 1024
  s_add_u32 s26, s26, s30
  buffer_load_dwordx4 v8, s[4:7], s26 offen lds
  s_add_u32 s25, s25, 4
  s_mul_i32 s24, s25, 205
  s_lshl_b32 s26, s25, 10
  s_lshr_b32 s24, s24, 10
  s_lshl_b32 s24, s24, 4
  s_add_u32 s24, s24, s26
  s_sub_u32 m0, s24, 1024
  s_add_u32 s26, s26, s30
  buffer_load_dwordx4 v8, s[4:7], s26 offen lds
  s_add_u32 s25, s25, 4
  s_mul_i32 s24, s25, 205
  s_lshl_b32 s26, s25, 10
  s_lshr_b32 s24, s24, 10
  s_lshl_b32 s24, s24, 4
  s_add_u32 s24, s24, s26
  s_sub_u32 m0, s24, 1024
  s_add_u32 s26, s26, s30
  buffer_load_dwordx4 v8, s[4:7], s26 offen lds
  s_add_u32 s25, s25, 4
  s_mul_i32 s24, s25, 205
  s_lshl_b32 s26, s25, 10
  s_lshr_b32 s24, s24, 10
  s_lshl_b32 s24, s24, 4
  s_add_u32 s24, s24, s26
  s_sub_u32 m0, s24, 1024
  s_add_u32 s26, s26, s30
  buffer_load_dwordx4 v8, s[4:7], s26 offen lds
  s_add_u32 s25, s25, 4
  s_mul_i32 s24, s25, 205
  s_lshl_b32 s26, s25, 10
  s_lshr_b32 s24, s24, 10
  s_lshl_b32 s24, s24, 4
  s_add_u32 s24, s24, s26
  s_sub_u32 m0, s24, 1024
  s_add_u32 s26, s26, s30
  buffer_load_dwordx4 v8, s[4:7], s26 offen lds
  s_add_u32 s25, s25, 4
  s_mul_i32 s24, s25, 205
  s_lshl_b32 s26, s25, 10
  s_lshr_b32 s24, s24, 10
  s_lshl_b32 s24, s24, 4
  s_add_u32 s24, s24, s26
  s_sub_u32 m0, s24, 1024
  s_add_u32 s26, s26, s30
  buffer_load_dwordx4 v8, s[4:7], s26 offen lds
  s_add_u32 s25, s25, 4
  s_mul_i32 s24, s25, 205
  s_lshl_b32 s26, s25, 10
  s_lshr_b32 s24, s24, 10
  s_lshl_b32 s24, s24, 4
  s_add_u32 s24, s24, s26
  s_sub_u32 m0, s24, 1024
  s_add_u32 s26, s26, s30
  buffer_load_dwordx4 v8, s[4:7], s26 offen lds
  s_add_u32 s25, s25, 4
  s_mul_i32 s24, s25, 205
  s_lshl_b32 s26, s25, 10
  s_lshr_b32 s24, s24, 10
  s_lshl_b32 s24, s24, 4
  s_add_u32 s24, s24, s26
  s_sub_u32 m0, s24, 1024
  s_add_u32 s26, s26, s30
  buffer_load_dwordx4 v8, s[4:7], s26 offen lds
  s_add_u32 s25, s25, 4
  s_mul_i32 s24, s25, 205
  s_lshl_b32 s26, s25, 10
  s_lshr_b32 s24, s24, 10
  s_lshl_b32 s24, s24, 4
  s_add_u32 s24, s24, s26
  s_sub_u32 m0, s24, 1024
  s_add_u32 s26, s26, s30
  buffer_load_dwordx4 v8, s[4:7], s26 offen lds
  s_add_u32 s25, s25, 4
  s_mul_i32 s24, s25, 205
  s_lshl_b32 s26, s25, 10
  s_lshr_b32 s24, s24, 10
  s_lshl_b32 s24, s24, 4
  s_add_u32 s24, s24, s26
  s_sub_u32 m0, s24, 1024
  s_add_u32 s26, s26, s30
  buffer_load_dwordx4 v8, s[4:7], s26 offen lds
  s_add_u32 s25, s25, 4
  s_mul_i32 s24, s25, 205
  s_lshl_b32 s26, s25, 10
  s_lshr_b32 s24, s24, 10
  s_lshl_b32 s24, s24, 4
  s_add_u32 s24, s24, s26
  s_sub_u32 m0, s24, 1024
  s_add_u32 s26, s26, s30
  buffer_load_dwordx4 v8, s[4:7], s26 offen lds
  s_add_u32 s25, s25, 4
  s_mul_i32 s24, s25, 205
  s_lshl_b32 s26, s25, 10
  s_lshr_b32 s24, s24, 10
  s_lshl_b32 s24, s24, 4
  s_add_u32 s24, s24, s26
  s_sub_u32 m0, s24, 1024
  s_add_u32 s26, s26, s30
  buffer_load_dwordx4 v8, s[4:7], s26 offen lds
  s_add_u32 s25, s25, 4
  s_mul_i32 s24, s25, 205
  s_lshl_b32 s26, s25, 10
  s_lshr_b32 s24, s24, 10
  s_lshl_b32 s24, s24, 4
  s_add_u32 s24, s24, s26
  s_sub_u32 m0, s24, 1024
  s_add_u32 s26, s26, s30
  buffer_load_dwordx4 v8, s[4:7], s26 offen lds
  s_add_u32 s25, s25, 4
  s_mul_i32 s24, s25, 205
  s_lshl_b32 s26, s25, 10
  s_lshr_b32 s24, s24, 10
  s_lshl_b32 s24, s24, 4
  s_add_u32 s24, s24, s26
  s_sub_u32 m0, s24, 1024
  s_add_u32 s26, s26, s30
  buffer_load_dwordx4 v8, s[4:7], s26 offen lds
  s_add_u32 s25, s25, 4
  s_mul_i32 s24, s25, 205
  s_lshl_b32 s26, s25, 10
  s_lshr_b32 s24, s24, 10
  s_lshl_b32 s24, s24, 4
  s_add_u32 s24, s24, s26
  s_sub_u32 m0, s24, 1024
  s_add_u32 s26, s26, s30
  buffer_load_dwordx4 v8, s[4:7], s26 offen lds
  s_add_u32 s25, s25, 4
  s_min_u32 s25, s25, 159
  s_mul_i32 s24, s25, 205
  s_lshl_b32 s26, s25, 10
  s_lshr_b32 s24, s24, 10
  s_lshl_b32 s24, s24, 4
  s_add_u32 s24, s24, s26
  s_sub_u32 m0, s24, 1024
  s_add_u32 s26, s26, s30
  buffer_load_dwordx4 v8, s[4:7], s26 offen lds
  s_add_u32 s25, s25, 4
k3_kernel_go3:
  v_cmp_gt_u32 vcc, 32, v2
  v_mov_b32 v7, 0x40000
  s_waitcnt vmcnt(3)
  v_cndmask_b32 v20, 0, v20, vcc
  v_cndmask_b32 v21, 0, v21, vcc
  v_cndmask_b32 v7, v7, v6, vcc
  v_mfma_f32_32x32x16_bf16 v[52:67], v[24:27], v[16:19], 0
  v_mfma_f32_32x32x8bf16_1k v[52:67], v[32:33], v[20:21], v[52:67]
  v_add3_u32 v4, v9, v7, s55
  s_nop 10
  v_max3_f32 v52, v52, v53, v54
  v_max3_f32 v55, v55, v56, v57
  v_max3_f32 v58, v58, v59, v60
  v_max3_f32 v61, v61, v62, v63
  v_max3_f32 v64, v64, v65, v66
  v_max3_f32 v52, v52, v55, v58
  v_max3_f32 v61, v61, v64, v67
  v_max_f32 v212, v52, v61
  v_mov_b32 v7, v212
  s_nop 1
  v_permlane32_swap_b32 v212, v7
  v_max_f32 v212, v212, v7
  v_sub_f32 v84, 0, v212
  v_sub_f32 v85, 0, v212
  v_sub_f32 v86, 0, v212
  v_sub_f32 v87, 0, v212
  v_sub_f32 v88, 0, v212
  v_sub_f32 v89, 0, v212
  v_sub_f32 v90, 0, v212
  v_sub_f32 v91, 0, v212
  v_sub_f32 v92, 0, v212
  v_sub_f32 v93, 0, v212
  v_sub_f32 v94, 0, v212
  v_sub_f32 v95, 0, v212
  v_sub_f32 v96, 0, v212
  v_sub_f32 v97, 0, v212
  v_sub_f32 v98, 0, v212
  v_sub_f32 v99, 0, v212
  s_waitcnt vmcnt(0) lgkmcnt(0)
  s_barrier
  s_cmp_lt_u32 s20, 4
  s_cbranch_scc1 k3_kernel_go24
  s_setprio 1
k3_kernel_go24:
k3_kernel_main5:
  ds_read_b128 v[28:31], v3 offset:1536
  ds_read_b64 v[34:35], v4 offset:1536
  ds_read_b128 v[36:39], v10 offset:256
  ds_read_b128 v[40:43], v11 offset:256
  v_mfma_f32_32x32x16_bf16 v[52:67], v[24:27], v[16:19], v[84:99]
  v_mfma_f32_32x32x8bf16_1k v[52:67], v[32:33], v[20:21], v[52:67]
  v_mov_b32 v100, 0
  v_mov_b32 v101, 0
  v_mov_b32 v102, 0
  v_mov_b32 v103, 0
  v_mov_b32 v104, 0
  v_mov_b32 v105, 0
  v_mov_b32 v106, 0
  v_mov_b32 v107, 0
  v_mov_b32 v108, 0
  v_mov_b32 v109, 0
  v_mov_b32 v110, 0
  v_mov_b32 v111, 0
  v_mov_b32 v112, 0
  v_mov_b32 v113, 0
  v_mov_b32 v114, 0
  v_mov_b32 v115, 0
  v_mov_b32 v76, 0
  v_mov_b32 v77, 0
  v_mov_b32 v78, 0
  v_mov_b32 v79, 0
  v_mov_b32 v80, 0
  v_mov_b32 v81, 0
  v_mov_b32 v82, 0
  v_mov_b32 v83, 0
  v_mov_b32 v48, 0
  v_mov_b32 v49, 0
  v_mov_b32 v50, 0
  v_mov_b32 v51, 0
  s_mov_b32 s27, 0
.p2align 6
k3_kernel_loop6:
  s_or_b32 s23, s27, s28
  s_bitcmp1_b32 s29, s23
  s_cbranch_scc1 k3_kernel_stub8
k3_kernel_wn9:
  v_exp_f32 v52, v52
  v_exp_f32 v53, v53
  v_smfmac_f32_32x32x32_bf16 v[100:115], v[48:51], v[76:83], v116
  ds_read_b128 v[44:47], v12 offset:2816
  ds_read_b128 v[48:51], v13 offset:2816
  v_exp_f32 v54, v54
  v_exp_f32 v55, v55
  s_waitcnt lgkmcnt(2)
  v_mfma_f32_32x32x16_bf16 v[68:83], v[28:31], v[16:19], v[84:99]
  v_exp_f32 v56, v56
  v_exp_f32 v57, v57
  v_exp_f32 v58, v58
  v_mfma_f32_32x32x8bf16_1k v[68:83], v[34:35], v[20:21], v[68:83]
  ds_read_b128 v[24:27], v3 offset:4112
  ds_read_b64 v[32:33], v4 offset:4112
  v_exp_f32 v59, v59
  v_exp_f32 v60, v60
  v_exp_f32 v61, v61
  v_exp_f32 v62, v62
  v_smfmac_f32_32x32x32_bf16 v[100:115], v[36:39], v[52:59], v116
  v_exp_f32 v63, v63
  v_exp_f32 v64, v64
  v_exp_f32 v65, v65
  v_exp_f32 v66, v66
  v_exp_f32 v67, v67
  v_exp_f32 v68, v68
  v_exp_f32 v69, v69
  v_smfmac_f32_32x32x32_bf16 v[100:115], v[40:43], v[60:67], v116
  ds_read_b128 v[36:39], v10 offset:5392
  ds_read_b128 v[40:43], v11 offset:5392
  v_exp_f32 v70, v70
  v_exp_f32 v71, v71
  s_waitcnt lgkmcnt(2)
  v_mfma_f32_32x32x16_bf16 v[52:67], v[24:27], v[16:19], v[84:99]
  v_exp_f32 v72, v72
  v_exp_f32 v73, v73
  v_exp_f32 v74, v74
  v_mfma_f32_32x32x8bf16_1k v[52:67], v[32:33], v[20:21], v[52:67]
  ds_read_b128 v[28:31], v3 offset:6672
  ds_read_b64 v[34:35], v4 offset:6672
  v_exp_f32 v75, v75
  v_exp_f32 v76, v76
  v_exp_f32 v77, v77
  v_exp_f32 v78, v78
  v_smfmac_f32_32x32x32_bf16 v[100:115], v[44:47], v[68:75], v116
  v_exp_f32 v79, v79
  v_exp_f32 v80, v80
  v_exp_f32 v81, v81
  v_exp_f32 v82, v82
  v_exp_f32 v83, v83
  v_exp_f32 v52, v52
  v_exp_f32 v53, v53
  v_smfmac_f32_32x32x32_bf16 v[100:115], v[48:51], v[76:83], v116
  ds_read_b128 v[44:47], v12 offset:7952
  ds_read_b128 v[48:51], v13 offset:7952
  v_exp_f32 v54, v54
  v_exp_f32 v55, v55
  s_waitcnt lgkmcnt(2)
  v_mfma_f32_32x32x16_bf16 v[68:83], v[28:31], v[16:19], v[84:99]
  v_exp_f32 v56, v56
  v_exp_f32 v57, v57
  v_exp_f32 v58, v58
  v_mfma_f32_32x32x8bf16_1k v[68:83], v[34:35], v[20:21], v[68:83]
  ds_read_b128 v[24:27], v3 offset:9248
  ds_read_b64 v[32:33], v4 offset:9248
  v_exp_f32 v59, v59
  v_exp_f32 v60, v60
  v_exp_f32 v61, v61
  v_exp_f32 v62, v62
  v_smfmac_f32_32x32x32_bf16 v[100:115], v[36:39], v[52:59], v116
  v_exp_f32 v63, v63
  v_exp_f32 v64, v64
  v_exp_f32 v65, v65
  v_exp_f32 v66, v66
  v_exp_f32 v67, v67
  v_exp_f32 v68, v68
  v_exp_f32 v69, v69
  v_smfmac_f32_32x32x32_bf16 v[100:115], v[40:43], v[60:67], v116
  ds_read_b128 v[36:39], v10 offset:10528
  ds_read_b128 v[40:43], v11 offset:10528
  v_exp_f32 v70, v70
  v_exp_f32 v71, v71
  s_waitcnt lgkmcnt(2)
  v_mfma_f32_32x32x16_bf16 v[52:67], v[24:27], v[16:19], v[84:99]
  v_exp_f32 v72, v72
  v_exp_f32 v73, v73
  v_exp_f32 v74, v74
  v_mfma_f32_32x32x8bf16_1k v[52:67], v[32:33], v[20:21], v[52:67]
  ds_read_b128 v[28:31], v3 offset:11808
  ds_read_b64 v[34:35], v4 offset:11808
  v_exp_f32 v75, v75
  v_exp_f32 v76, v76
  v_exp_f32 v77, v77
  v_exp_f32 v78, v78
  v_smfmac_f32_32x32x32_bf16 v[100:115], v[44:47], v[68:75], v116
  v_exp_f32 v79, v79
  v_exp_f32 v80, v80
  v_exp_f32 v81, v81
  v_exp_f32 v82, v82
  v_exp_f32 v83, v83
  v_exp_f32 v52, v52
  v_exp_f32 v53, v53
  v_smfmac_f32_32x32x32_bf16 v[100:115], v[48:51], v[76:83], v116
  ds_read_b128 v[44:47], v12 offset:13088
  ds_read_b128 v[48:51], v13 offset:13088
  v_exp_f32 v54, v54
  v_exp_f32 v55, v55
  s_waitcnt lgkmcnt(2)
  v_mfma_f32_32x32x16_bf16 v[68:83], v[28:31], v[16:19], v[84:99]
  v_exp_f32 v56, v56
  v_exp_f32 v57, v57
  v_exp_f32 v58, v58
  v_mfma_f32_32x32x8bf16_1k v[68:83], v[34:35], v[20:21], v[68:83]
  ds_read_b128 v[24:27], v3 offset:14384
  ds_read_b64 v[32:33], v4 offset:14384
  v_exp_f32 v59, v59
  v_exp_f32 v60, v60
  v_exp_f32 v61, v61
  v_exp_f32 v62, v62
  v_smfmac_f32_32x32x32_bf16 v[100:115], v[36:39], v[52:59], v116
  v_exp_f32 v63, v63
  v_exp_f32 v64, v64
  v_exp_f32 v65, v65
  v_exp_f32 v66, v66
  v_exp_f32 v67, v67
  v_exp_f32 v68, v68
  v_exp_f32 v69, v69
  v_smfmac_f32_32x32x32_bf16 v[100:115], v[40:43], v[60:67], v116
  ds_read_b128 v[36:39], v10 offset:15664
  ds_read_b128 v[40:43], v11 offset:15664
  v_exp_f32 v70, v70
  v_exp_f32 v71, v71
  s_waitcnt lgkmcnt(2)
  v_mfma_f32_32x32x16_bf16 v[52:67], v[24:27], v[16:19], v[84:99]
  v_exp_f32 v72, v72
  v_exp_f32 v73, v73
  v_exp_f32 v74, v74
  v_mfma_f32_32x32x8bf16_1k v[52:67], v[32:33], v[20:21], v[52:67]
  ds_read_b128 v[28:31], v3 offset:16944
  ds_read_b64 v[34:35], v4 offset:16944
  v_exp_f32 v75, v75
  v_exp_f32 v76, v76
  v_exp_f32 v77, v77
  v_exp_f32 v78, v78
  v_smfmac_f32_32x32x32_bf16 v[100:115], v[44:47], v[68:75], v116
  v_exp_f32 v79, v79
  v_exp_f32 v80, v80
  v_exp_f32 v81, v81
  v_exp_f32 v82, v82
  v_exp_f32 v83, v83
  v_exp_f32 v52, v52
  v_exp_f32 v53, v53
  v_smfmac_f32_32x32x32_bf16 v[100:115], v[48:51], v[76:83], v116
  ds_read_b128 v[44:47], v12 offset:18224
  ds_read_b128 v[48:51], v13 offset:18224
  v_exp_f32 v54, v54
  v_exp_f32 v55, v55
  s_waitcnt lgkmcnt(2)
  v_mfma_f32_32x32x16_bf16 v[68:83], v[28:31], v[16:19], v[84:99]
  v_exp_f32 v56, v56
  v_exp_f32 v57, v57
  v_exp_f32 v58, v58
  v_mfma_f32_32x32x8bf16_1k v[68:83], v[34:35], v[20:21], v[68:83]
  ds_read_b128 v[24:27], v3 offset:19520
  ds_read_b64 v[32:33], v4 offset:19520
  v_exp_f32 v59, v59
  v_exp_f32 v60, v60
  v_exp_f32 v61, v61
  v_exp_f32 v62, v62
  v_smfmac_f32_32x32x32_bf16 v[100:115], v[36:39], v[52:59], v116
  v_exp_f32 v63, v63
  v_exp_f32 v64, v64
  v_exp_f32 v65, v65
  v_exp_f32 v66, v66
  v_exp_f32 v67, v67
  v_exp_f32 v68, v68
  v_exp_f32 v69, v69
  v_smfmac_f32_32x32x32_bf16 v[100:115], v[40:43], v[60:67], v116
  ds_read_b128 v[36:39], v10 offset:20800
  ds_read_b128 v[40:43], v11 offset:20800
  v_exp_f32 v70, v70
  v_exp_f32 v71, v71
  s_waitcnt lgkmcnt(2)
  v_mfma_f32_32x32x16_bf16 v[52:67], v[24:27], v[16:19], v[84:99]
  v_exp_f32 v72, v72
  v_exp_f32 v73, v73
  v_exp_f32 v74, v74
  v_mfma_f32_32x32x8bf16_1k v[52:67], v[32:33], v[20:21], v[52:67]
  ds_read_b128 v[28:31], v3 offset:22080
  ds_read_b64 v[34:35], v4 offset:22080
  v_exp_f32 v75, v75
  v_exp_f32 v76, v76
  v_exp_f32 v77, v77
  v_exp_f32 v78, v78
  v_smfmac_f32_32x32x32_bf16 v[100:115], v[44:47], v[68:75], v116
  v_exp_f32 v79, v79
  v_exp_f32 v80, v80
  v_exp_f32 v81, v81
  v_exp_f32 v82, v82
  v_exp_f32 v83, v83
  v_add_u32 v3, 20544, v3
  v_add_u32 v4, 20544, v4
  v_add_u32 v10, 20544, v10
  v_add_u32 v11, 20544, v11
  v_add_u32 v12, 20544, v12
  v_add_u32 v13, 20544, v13
  s_add_u32 s27, s27, 1
  s_cmp_lt_u32 s27, 8
  s_cbranch_scc1 k3_kernel_loop6
  v_smfmac_f32_32x32x32_bf16 v[100:115], v[48:51], v[76:83], v116
  v_subrev_u32 v3, 164352, v3
  v_subrev_u32 v4, 164352, v4
  v_subrev_u32 v10, 164352, v10
  v_subrev_u32 v11, 164352, v11
  v_subrev_u32 v12, 164352, v12
  v_subrev_u32 v13, 164352, v13
  s_waitcnt lgkmcnt(0)
  s_nop 7
  v_mov_b32 v212, v108
  v_mov_b32 v7, v108
  s_nop 1
  v_permlane32_swap_b32 v7, v212
  v_rcp_f32 v52, v212
  s_nop 0
  v_mul_f32 v100, v100, v52
  v_mul_f32 v101, v101, v52
  v_mul_f32 v102, v102, v52
  v_mul_f32 v103, v103, v52
  v_mul_f32 v104, v104, v52
  v_mul_f32 v105, v105, v52
  v_mul_f32 v106, v106, v52
  v_mul_f32 v107, v107, v52
  v_mul_f32 v108, v108, v52
  v_mul_f32 v109, v109, v52
  v_mul_f32 v110, v110, v52
  v_mul_f32 v111, v111, v52
  s_cmp_lg_u32 s28, 0
  s_cbranch_scc1 k3_kernel_store10
  v_mul_f32 v53, 0, v100
  v_fmac_f32 v53, 0, v101
  v_fmac_f32 v53, 0, v102
  v_fmac_f32 v53, 0, v103
  v_fmac_f32 v53, 0, v104
  v_fmac_f32 v53, 0, v105
  v_fmac_f32 v53, 0, v106
  v_fmac_f32 v53, 0, v107
  v_fmac_f32 v53, 0, v108
  v_fmac_f32 v53, 0, v109
  v_fmac_f32 v53, 0, v110
  v_fmac_f32 v53, 0, v111
  v_add_f32 v53, v53, v212
  v_cmp_nge_f32 vcc, 0x5f800000, v53
  s_cbranch_vccnz k3_kernel_fallback11
k3_kernel_store10:
  v_cvt_pk_bf16_f32 v68, v100, v101
  v_cvt_pk_bf16_f32 v69, v102, v103
  v_cvt_pk_bf16_f32 v70, v104, v105
  v_cvt_pk_bf16_f32 v71, v106, v107
  v_cvt_pk_bf16_f32 v72, v108, v109
  v_cvt_pk_bf16_f32 v73, v110, v111
  s_mul_i32 s23, s22, 40
  s_add_u32 s24, s23, s21
  s_lshl_b32 s24, s24, 10
  s_add_u32 s24, s24, 13000704
  buffer_store_dwordx4 v[68:71], v3, s[4:7], s24 offen sc1
  s_lshr_b32 s24, s21, 2
  s_add_u32 s23, s23, s24
  s_lshl_b32 s23, s23, 10
  s_and_b32 s24, s21, 2
  s_lshl_b32 s24, s24, 8
  s_add_u32 s23, s23, s24
  s_and_b32 s24, s21, 1
  s_lshl_b32 s24, s24, 3
  s_add_u32 s23, s23, s24
  s_add_u32 s23, s23, 13033472
  s_mov_b64 exec, 0xffffffff
  buffer_store_dwordx2 v[72:73], v3, s[4:7], s23 offen
  s_mov_b64 exec, -1
k3_kernel_end1:
  s_endpgm
k3_kernel_stub8:
  s_cmp_ge_u32 s20, 4
  s_cbranch_scc1 k3_kernel_e12
  s_barrier
  s_branch k3_kernel_wn9
k3_kernel_e12:
  s_cmp_lg_u32 s27, 7
  s_cbranch_scc1 k3_kernel_e13
  s_setprio 0
k3_kernel_e13:
  s_cmp_lg_u32 s27, 5
  s_cbranch_scc1 k3_kernel_e16
  s_cmp_lg_u32 s20, 7
  s_cbranch_scc1 k3_kernel_e16
  s_cmp_ge_u32 s2, 8
  s_cbranch_scc1 k3_kernel_e16
  s_waitcnt vmcnt(0)
  s_cmp_ge_u32 s2, 8
  s_cbranch_scc1 k3_kernel_cpf17
  s_cmp_lg_u32 s20, 7
  s_cbranch_scc1 k3_kernel_cpf17
  s_getpc_b64 s[56:57]
k3_kernel_pc18:
  s_add_u32 s56, s56, k456_kernel - k3_kernel_pc18
  s_addc_u32 s57, s57, 0
  v_and_b32 v214, 63, v0
  v_lshlrev_b32 v214, 7, v214
  v_min_u32 v215, code_end - k456_kernel - 4, v214
  global_load_dword v216, v215, s[56:57]
  v_add_u32 v214, 8192, v214
  v_min_u32 v215, code_end - k456_kernel - 4, v214
  global_load_dword v217, v215, s[56:57]
  v_add_u32 v214, 8192, v214
  v_min_u32 v215, code_end - k456_kernel - 4, v214
  global_load_dword v218, v215, s[56:57]
  v_add_u32 v214, 8192, v214
  v_min_u32 v215, code_end - k456_kernel - 4, v214
  global_load_dword v219, v215, s[56:57]
k3_kernel_cpf17:
  buffer_wbl2 sc1
k3_kernel_e16:
  s_cmp_lg_u32 s27, 1
  s_cbranch_scc1 k3_kernel_e14
  v_and_b32 v119, 7, v2
  v_bfe_u32 v120, v2, 3, 2
  v_lshrrev_b32 v121, 5, v2
  s_and_b32 s32, s2, 7
  s_mul_i32 s32, s32, 327680
  s_lshr_b32 s33, s2, 3
  s_lshl_b32 s33, s33, 2
  s_add_u32 s33, s33, s20
  s_mul_i32 s33, s33, 2560
  s_add_u32 s32, s32, s33
  s_sub_u32 s32, s32, 10240
  v_min_u32 v122, 19, v2
  v_lshlrev_b32 v122, 7, v122
  buffer_load_dword v118, v122, s[16:19], s32 offen
  s_lshl_b32 s31, s2, 2
  s_add_u32 s31, s31, s20
  s_sub_u32 s31, s31, 4
  s_cmp_ge_u32 s31, 910
  s_cbranch_scc1 k3_kernel_wn9
  s_mov_b32 s37, 4
  s_cmp_ge_u32 s31, 540
  s_cbranch_scc1 k3_kernel_sa19
  s_lshr_b32 s32, s31, 1
  s_mul_i32 s36, s32, 2428
  s_lshr_b32 s36, s36, 16
  s_mul_i32 s33, s36, 27
  s_sub_u32 s34, s32, s33
  s_mul_i32 s41, s34, 40
  s_add_u32 s41, s41, s36
  s_lshl_b32 s41, s41, 12
  s_add_u32 s41, s41, 16441344
  s_and_b32 s32, s31, 1
  s_lshl_b32 s33, s32, 8
  s_add_u32 s41, s41, s33
  s_mul_i32 s43, s34, 10240
  s_lshl_b32 s33, s36, 8
  s_add_u32 s43, s43, s33
  s_lshl_b32 s33, s32, 7
  s_add_u32 s43, s43, s33
  s_add_u32 s43, s43, 35639296
  s_cmp_eq_u32 s32, 0
  s_cselect_b32 s44, s10, s12
  s_cselect_b32 s45, s11, s13
  s_mov_b32 s46, 2211840
  v_and_b32 v122, 31, v2
  v_min_u32 v122, 1, v122
  v_lshlrev_b32 v122, 4, v122
  v_lshl_add_u32 v122, v121, 5, v122
  s_lshl_b32 s32, s36, 8
  s_add_u32 s32, s32, 49152
  buffer_load_dwordx4 v[164:167], v122, s[4:7], s32 offen offset:0
  buffer_load_dwordx4 v[168:171], v122, s[4:7], s32 offen offset:64
  buffer_load_dwordx4 v[172:175], v122, s[4:7], s32 offen offset:128
  buffer_load_dwordx4 v[176:179], v122, s[4:7], s32 offen offset:192
  s_lshl_b32 s36, s36, 6
  s_mov_b32 s35, 3456
  s_mov_b32 s38, 27648
  s_mov_b32 s39, 40960
  s_mov_b32 s40, 512
  s_mov_b32 s42, 55296
  s_branch k3_kernel_sgo21
k3_kernel_sa19:
  s_mov_b32 s35, 1280
  s_mov_b32 s38, 10240
  s_mov_b32 s40, 256
  s_cmp_ge_u32 s31, 810
  s_cbranch_scc1 k3_kernel_sb20
  s_sub_u32 s32, s31, 540
  s_mul_i32 s36, s32, 6554
  s_lshr_b32 s36, s36, 16
  s_mul_i32 s33, s36, 10
  s_sub_u32 s34, s32, s33
  s_mul_i32 s41, s34, 108
  s_add_u32 s41, s41, s36
  s_lshl_b32 s41, s41, 11
  s_add_u32 s41, s41, 20865024
  s_mov_b32 s44, s14
  s_mov_b32 s45, s15
  s_mov_b32 s46, 2211840
  s_mov_b32 s39, 55296
  s_lshl_b32 s36, s36, 6
  s_mov_b32 s42, 20480
  s_branch k3_kernel_sgo21
k3_kernel_sb20:
  s_sub_u32 s32, s31, 810
  s_mul_i32 s36, s32, 6554
  s_lshr_b32 s36, s36, 16
  s_mul_i32 s33, s36, 10
  s_sub_u32 s34, s32, s33
  s_mul_i32 s41, s34, 40
  s_add_u32 s41, s41, s36
  s_lshl_b32 s41, s41, 11
  s_add_u32 s41, s41, 15622144
  s_mov_b32 s44, s8
  s_mov_b32 s45, s9
  s_mov_b32 s46, 819200
  s_mov_b32 s39, 20480
  s_mul_i32 s32, s36, 80
  s_mul_i32 s33, s36, 320
  s_sub_u32 s33, s33, 2544
  s_mov_b32 s42, 25600
  s_cmp_ge_u32 s36, 8
  s_cselect_b32 s36, s33, s32
  s_cselect_b32 s37, 40, 4
  s_cselect_b32 s38, 25600, s38
  s_cselect_b32 s42, 102400, s42
k3_kernel_sgo21:
  v_mul_lo_u32 v122, v121, s37
  v_add_u32 v122, s36, v122
  v_mul_lo_u32 v122, v122, s35
  v_lshl_add_u32 v122, v120, 5, v122
  v_lshl_add_u32 v122, v119, 2, v122
  s_lshl_b32 s32, s34, 7
  v_add_u32 v122, s32, v122
  v_mul_lo_u32 v117, v120, s39
  v_mul_lo_u32 v156, v121, s40
  v_add_u32 v117, v117, v156
  v_lshl_add_u32 v117, v119, 5, v117
  s_lshl_b32 s39, s40, 1
  s_mov_b32 s48, s35
  s_lshl_b32 s49, s35, 1
  s_add_u32 s50, s49, s35
  s_mov_b32 s51, s38
  s_add_u32 s52, s38, s48
  s_add_u32 s53, s38, s49
  s_add_u32 s54, s38, s50
  buffer_load_dword v124, v122, s[44:47], 0 offen nt
  buffer_load_dword v125, v122, s[44:47], s48 offen nt
  buffer_load_dword v126, v122, s[44:47], s49 offen nt
  buffer_load_dword v127, v122, s[44:47], s50 offen nt
  buffer_load_dword v128, v122, s[44:47], s51 offen nt
  buffer_load_dword v129, v122, s[44:47], s52 offen nt
  buffer_load_dword v130, v122, s[44:47], s53 offen nt
  buffer_load_dword v131, v122, s[44:47], s54 offen nt
  v_add_u32 v122, s42, v122
  buffer_load_dword v132, v122, s[44:47], 0 offen nt
  buffer_load_dword v133, v122, s[44:47], s48 offen nt
  buffer_load_dword v134, v122, s[44:47], s49 offen nt
  buffer_load_dword v135, v122, s[44:47], s50 offen nt
  buffer_load_dword v136, v122, s[44:47], s51 offen nt
  buffer_load_dword v137, v122, s[44:47], s52 offen nt
  buffer_load_dword v138, v122, s[44:47], s53 offen nt
  buffer_load_dword v139, v122, s[44:47], s54 offen nt
  v_add_u32 v122, s42, v122
  s_branch k3_kernel_wn9
k3_kernel_e14:
  s_cmp_lg_u32 s27, 2
  s_cbranch_scc1 k3_kernel_e15
  s_cmp_ge_u32 s31, 910
  s_cbranch_scc1 k3_kernel_wn9
  buffer_load_dword v140, v122, s[44:47], 0 offen nt
  buffer_load_dword v141, v122, s[44:47], s48 offen nt
  buffer_load_dword v142, v122, s[44:47], s49 offen nt
  buffer_load_dword v143, v122, s[44:47], s50 offen nt
  buffer_load_dword v144, v122, s[44:47], s51 offen nt
  buffer_load_dword v145, v122, s[44:47], s52 offen nt
  buffer_load_dword v146, v122, s[44:47], s53 offen nt
  buffer_load_dword v147, v122, s[44:47], s54 offen nt
  v_add_u32 v122, s42, v122
  buffer_load_dword v148, v122, s[44:47], 0 offen nt
  buffer_load_dword v149, v122, s[44:47], s48 offen nt
  buffer_load_dword v150, v122, s[44:47], s49 offen nt
  buffer_load_dword v151, v122, s[44:47], s50 offen nt
  buffer_load_dword v152, v122, s[44:47], s51 offen nt
  buffer_load_dword v153, v122, s[44:47], s52 offen nt
  buffer_load_dword v154, v122, s[44:47], s53 offen nt
  buffer_load_dword v155, v122, s[44:47], s54 offen nt
  s_branch k3_kernel_wn9
k3_kernel_e15:
  s_cmp_lg_u32 s27, 4
  s_cbranch_scc1 k3_kernel_wn9
  s_cmp_ge_u32 s31, 910
  s_cbranch_scc1 k3_kernel_wn9
  s_mov_b32 s32, 0x05040100
  s_mov_b32 s33, 0x07060302
  s_waitcnt vmcnt(0)
  v_perm_b32 v156, v125, v124, s32
  v_perm_b32 v157, v127, v126, s32
  v_perm_b32 v158, v129, v128, s32
  v_perm_b32 v159, v131, v130, s32
  v_perm_b32 v160, v125, v124, s33
  v_perm_b32 v161, v127, v126, s33
  v_perm_b32 v162, v129, v128, s33
  v_perm_b32 v163, v131, v130, s33
  buffer_store_dwordx4 v[156:159], v117, s[4:7], s41 offen
  buffer_store_dwordx4 v[160:163], v117, s[4:7], s41 offen offset:16
  v_mfma_f32_32x32x16_bf16 v[180:195], v[164:167], v[156:159], 0
  v_mfma_f32_32x32x16_bf16 v[196:211], v[164:167], v[160:163], 0
  s_add_u32 s41, s41, s39
  v_perm_b32 v156, v133, v132, s32
  v_perm_b32 v157, v135, v134, s32
  v_perm_b32 v158, v137, v136, s32
  v_perm_b32 v159, v139, v138, s32
  v_perm_b32 v160, v133, v132, s33
  v_perm_b32 v161, v135, v134, s33
  v_perm_b32 v162, v137, v136, s33
  v_perm_b32 v163, v139, v138, s33
  buffer_store_dwordx4 v[156:159], v117, s[4:7], s41 offen
  buffer_store_dwordx4 v[160:163], v117, s[4:7], s41 offen offset:16
  v_mfma_f32_32x32x16_bf16 v[180:195], v[168:171], v[156:159], v[180:195]
  v_mfma_f32_32x32x16_bf16 v[196:211], v[168:171], v[160:163], v[196:211]
  s_add_u32 s41, s41, s39
  v_perm_b32 v156, v141, v140, s32
  v_perm_b32 v157, v143, v142, s32
  v_perm_b32 v158, v145, v144, s32
  v_perm_b32 v159, v147, v146, s32
  v_perm_b32 v160, v141, v140, s33
  v_perm_b32 v161, v143, v142, s33
  v_perm_b32 v162, v145, v144, s33
  v_perm_b32 v163, v147, v146, s33
  buffer_store_dwordx4 v[156:159], v117, s[4:7], s41 offen
  buffer_store_dwordx4 v[160:163], v117, s[4:7], s41 offen offset:16
  v_mfma_f32_32x32x16_bf16 v[180:195], v[172:175], v[156:159], v[180:195]
  v_mfma_f32_32x32x16_bf16 v[196:211], v[172:175], v[160:163], v[196:211]
  s_add_u32 s41, s41, s39
  v_perm_b32 v156, v149, v148, s32
  v_perm_b32 v157, v151, v150, s32
  v_perm_b32 v158, v153, v152, s32
  v_perm_b32 v159, v155, v154, s32
  v_perm_b32 v160, v149, v148, s33
  v_perm_b32 v161, v151, v150, s33
  v_perm_b32 v162, v153, v152, s33
  v_perm_b32 v163, v155, v154, s33
  buffer_store_dwordx4 v[156:159], v117, s[4:7], s41 offen
  buffer_store_dwordx4 v[160:163], v117, s[4:7], s41 offen offset:16
  v_mfma_f32_32x32x16_bf16 v[180:195], v[176:179], v[156:159], v[180:195]
  v_mfma_f32_32x32x16_bf16 v[196:211], v[176:179], v[160:163], v[196:211]
  s_add_u32 s41, s41, s39
  s_cmp_ge_u32 s31, 540
  s_cbranch_scc1 k3_kernel_wn9
  v_mul_u32_u24 v120, 2560, v120
  v_lshl_add_u32 v119, v119, 3, v120
  s_nop 6
  v_mov_b32 v156, v180
  v_mov_b32 v157, v196
  v_mov_b32 v158, v181
  v_mov_b32 v159, v197
  s_mov_b64 exec, 0xffffffff
  buffer_store_dwordx2 v[156:157], v119, s[4:7], s43 offen offset:0
  buffer_store_dwordx2 v[158:159], v119, s[4:7], s43 offen offset:64
  s_mov_b64 exec, -1
  s_branch k3_kernel_wn9
k3_kernel_fallback11:
  s_mov_b32 s28, 8
  s_mov_b32 s27, 0
  v_mov_b32 v212, 0xff800000
  buffer_load_dwordx4 v[24:27], v8, s[4:7], s30 offen
  buffer_load_dwordx2 v[32:33], v9, s[4:7], s30 offen offset:1024
  s_waitcnt vmcnt(0)
k3_kernel_fl22:
  v_mfma_f32_32x32x16_bf16 v[52:67], v[24:27], v[16:19], 0
  v_mfma_f32_32x32x8bf16_1k v[52:67], v[32:33], v[20:21], v[52:67]
  ds_read_b128 v[24:27], v3 offset:1536
  ds_read_b64 v[32:33], v4 offset:1536
  s_nop 9
  v_max3_f32 v52, v52, v53, v54
  v_max3_f32 v55, v55, v56, v57
  v_max3_f32 v58, v58, v59, v60
  v_max3_f32 v61, v61, v62, v63
  v_max3_f32 v64, v64, v65, v66
  v_max3_f32 v52, v52, v55, v58
  v_max3_f32 v61, v61, v64, v67
  v_max3_f32 v212, v212, v52, v61
  s_waitcnt lgkmcnt(0)
  v_mfma_f32_32x32x16_bf16 v[52:67], v[24:27], v[16:19], 0
  v_mfma_f32_32x32x8bf16_1k v[52:67], v[32:33], v[20:21], v[52:67]
  ds_read_b128 v[24:27], v3 offset:4112
  ds_read_b64 v[32:33], v4 offset:4112
  s_nop 9
  v_max3_f32 v52, v52, v53, v54
  v_max3_f32 v55, v55, v56, v57
  v_max3_f32 v58, v58, v59, v60
  v_max3_f32 v61, v61, v62, v63
  v_max3_f32 v64, v64, v65, v66
  v_max3_f32 v52, v52, v55, v58
  v_max3_f32 v61, v61, v64, v67
  v_max3_f32 v212, v212, v52, v61
  s_waitcnt lgkmcnt(0)
  v_add_u32 v3, 5136, v3
  v_add_u32 v4, 5136, v4
  s_add_u32 s27, s27, 1
  s_cmp_lt_u32 s27, 32
  s_cbranch_scc1 k3_kernel_fl22
  buffer_load_dwordx4 v[24:27], v8, s[4:7], s30 offen
  buffer_load_dwordx2 v[32:33], v9, s[4:7], s30 offen offset:1024
  v_subrev_u32 v3, 164352, v3
  v_subrev_u32 v4, 164352, v4
  v_mov_b32 v7, v212
  s_nop 1
  v_permlane32_swap_b32 v212, v7
  v_max_f32 v212, v212, v7
  v_sub_f32 v84, 0, v212
  v_sub_f32 v85, 0, v212
  v_sub_f32 v86, 0, v212
  v_sub_f32 v87, 0, v212
  v_sub_f32 v88, 0, v212
  v_sub_f32 v89, 0, v212
  v_sub_f32 v90, 0, v212
  v_sub_f32 v91, 0, v212
  v_sub_f32 v92, 0, v212
  v_sub_f32 v93, 0, v212
  v_sub_f32 v94, 0, v212
  v_sub_f32 v95, 0, v212
  v_sub_f32 v96, 0, v212
  v_sub_f32 v97, 0, v212
  v_sub_f32 v98, 0, v212
  v_sub_f32 v99, 0, v212
  s_waitcnt vmcnt(0)
  s_branch k3_kernel_main5
.globl k456_kernel
.p2align 8
.type k456_kernel,@function
k456_kernel:
  s_cmp_ge_u32 s2, 256
  s_cbranch_scc1 k456_kernel_end1
  s_load_dwordx2 s[4:5], s[0:1], 88
  s_mov_b32 s6, 35930112
  s_mov_b32 s7, 0x20000
  s_load_dwordx2 s[8:9], s[0:1], 0
  s_mov_b32 s10, 2621440
  s_mov_b32 s11, 0x20000
  s_load_dwordx2 s[12:13], s[0:1], 72
  s_mov_b32 s14, 2621440
  s_mov_b32 s15, 0x20000
  v_lshrrev_b32 v1, 6, v0
  v_and_b32 v2, 63, v0
  v_readfirstlane_b32 s16, v1
  s_bfe_u32 s17, s2, 0x20001
  s_lshl_b32 s17, s17, 2
  s_bfe_u32 s21, s2, 0x20003
  s_add_u32 s17, s17, s21
  s_and_b32 s18, s2, 1
  s_lshl_b32 s18, s18, 3
  s_lshr_b32 s21, s2, 5
  s_add_u32 s18, s18, s21
  s_lshl_b32 s19, s17, 1
  s_and_b32 s21, s18, 1
  s_add_u32 s19, s19, s21
  s_lshr_b32 s20, s18, 1
  v_and_b32 v3, 15, v2
  v_lshrrev_b32 v4, 4, v2
  v_lshlrev_b32 v10, 4, v2
  v_lshrrev_b32 v5, 1, v4
  v_lshlrev_b32 v6, 10, v5
  v_and_b32 v5, 1, v4
  v_lshl_add_u32 v6, v5, 9, v6
  v_lshl_add_u32 v6, v3, 4, v6
  s_lshl_b32 s27, s19, 1
  s_lshr_b32 s22, s16, 1
  s_add_u32 s27, s27, s22
  s_mul_i32 s23, s27, 40960
  s_and_b32 s21, s16, 1
  s_lshl_b32 s21, s21, 8
  s_add_u32 s23, s23, s21
  s_add_u32 s23, s23, 13000704
  v_add_u32 v14, 0, v10
  v_add_u32 v15, 20480, v10
  v_add_u32 v16, 40960, v10
  v_add_u32 v17, 61440, v10
  v_add_u32 v18, 81920, v10
  s_mul_i32 s24, s20, 102400
  s_lshl_b32 s21, s16, 10
  s_add_u32 s24, s24, s21
  s_add_u32 s24, s24, 15622144
  s_mul_i32 s25, s16, 5120
  s_lshl_b32 s26, s16, 10
  s_waitcnt lgkmcnt(0)
  s_add_u32 m0, s25, 0
  s_nop 0
  buffer_load_dwordx4 v14, s[4:7], s24 offen lds
  buffer_load_dwordx4 a[0:3], v6, s[4:7], s23 offen offset:0
  s_add_u32 m0, s25, 1024
  s_nop 0
  buffer_load_dwordx4 v15, s[4:7], s24 offen lds
  buffer_load_dwordx4 a[4:7], v6, s[4:7], s23 offen offset:2048
  s_add_u32 s23, s23, 4096
  s_add_u32 m0, s25, 2048
  s_nop 0
  buffer_load_dwordx4 v16, s[4:7], s24 offen lds
  buffer_load_dwordx4 a[8:11], v6, s[4:7], s23 offen offset:0
  s_add_u32 m0, s25, 3072
  s_nop 0
  buffer_load_dwordx4 v17, s[4:7], s24 offen lds
  buffer_load_dwordx4 a[12:15], v6, s[4:7], s23 offen offset:2048
  s_add_u32 s23, s23, 4096
  s_add_u32 m0, s25, 4096
  s_nop 0
  buffer_load_dwordx4 v18, s[4:7], s24 offen lds
  s_add_u32 s24, s24, 4096
  v_add_u32 v11, 0x10000, v10
  v_add_u32 v12, 0x20000, v10
  s_mul_i32 s21, s20, 320
  s_add_u32 s21, s21, 37888
  v_mov_b32 v8, v10
  v_cmp_lt_u32 vcc, 19, v2
  v_add_u32 v5, 4800, v10
  s_mov_b32 m0, 155648
  v_cndmask_b32 v8, v8, v5, vcc
  v_cmp_lt_u32 vcc, 39, v2
  v_add_u32 v5, 7040, v10
  s_cmp_lg_u32 s16, 0
  v_cndmask_b32 v8, v8, v5, vcc
  s_cbranch_scc1 k456_kernel_nt2
  buffer_load_dwordx4 v8, s[4:7], s21 offen lds
k456_kernel_nt2:
  s_add_u32 m0, s25, 20480
  s_nop 0
  buffer_load_dwordx4 v14, s[4:7], s24 offen lds
  buffer_load_dwordx4 a[16:19], v6, s[4:7], s23 offen offset:0
  s_add_u32 m0, s25, 21504
  s_nop 0
  buffer_load_dwordx4 v15, s[4:7], s24 offen lds
  buffer_load_dwordx4 a[20:23], v6, s[4:7], s23 offen offset:2048
  s_add_u32 s23, s23, 4096
  s_add_u32 m0, s25, 22528
  s_nop 0
  buffer_load_dwordx4 v16, s[4:7], s24 offen lds
  buffer_load_dwordx4 a[24:27], v6, s[4:7], s23 offen offset:0
  s_add_u32 m0, s25, 23552
  s_nop 0
  buffer_load_dwordx4 v17, s[4:7], s24 offen lds
  buffer_load_dwordx4 a[28:31], v6, s[4:7], s23 offen offset:2048
  s_add_u32 s23, s23, 4096
  s_add_u32 m0, s25, 24576
  s_nop 0
  buffer_load_dwordx4 v18, s[4:7], s24 offen lds
  s_add_u32 s24, s24, 4096
  s_mul_i32 s21, s19, 81920
  s_mul_i32 s22, s20, 160
  s_add_u32 s21, s21, s22
  s_mul_i32 s22, s16, 192
  s_mul_i32 s31, s16, 3072
  v_add_u32 v8, s22, v2
  v_min_u32 v8, 639, v8
  v_mul_u32_u24 v5, 6554, v8
  v_lshrrev_b32 v5, 16, v5
  v_mul_u32_u24 v5, 1120, v5
  s_add_u32 m0, s31, 143360
  v_lshl_add_u32 v8, v8, 4, v5
  buffer_load_dwordx4 v8, s[8:11], s21 offen lds
  v_add_u32 v8, s22, v2
  v_add_u32 v8, 64, v8
  v_min_u32 v8, 639, v8
  v_mul_u32_u24 v5, 6554, v8
  v_lshrrev_b32 v5, 16, v5
  v_mul_u32_u24 v5, 1120, v5
  s_add_u32 m0, s31, 144384
  v_lshl_add_u32 v8, v8, 4, v5
  buffer_load_dwordx4 v8, s[8:11], s21 offen lds
  v_add_u32 v8, s22, v2
  v_add_u32 v8, 128, v8
  v_min_u32 v8, 639, v8
  v_mul_u32_u24 v5, 6554, v8
  v_lshrrev_b32 v5, 16, v5
  v_mul_u32_u24 v5, 1120, v5
  s_add_u32 m0, s31, 145408
  v_lshl_add_u32 v8, v8, 4, v5
  buffer_load_dwordx4 v8, s[8:11], s21 offen lds
  s_mul_i32 s21, s16, 2560
  s_add_u32 s21, s21, 143360
  v_mul_u32_u24 v8, 160, v3
  v_lshl_add_u32 v8, v4, 3, v8
  v_add_u32 v8, s21, v8
  v_lshlrev_b32 v7, 4, v4
  v_add_u32 v7, 155648, v7
  s_mul_i32 s28, s18, 101
  s_add_u32 s28, s28, 7
  s_mul_i32 s28, s28, 4370
  s_lshr_b32 s28, s28, 16
  s_mul_i32 s21, s28, 40960
  s_add_u32 s21, s21, 16441344
  s_mul_i32 s22, s16, 40960
  s_add_u32 s22, s22, s21
  v_add_u32 v19, s22, v10
  s_add_u32 s22, s21, s26
  v_add_u32 v20, s22, v10
  s_lshl_b32 s31, s17, 2
  s_add_u32 s31, s31, s16
  s_mul_i32 s22, s31, 40960
  s_add_u32 s22, s22, 23076864
  v_add_u32 v21, s22, v10
  s_mul_i32 s30, s31, 108
  s_add_u32 s30, s30, s28
  s_lshl_b32 s30, s30, 10
  s_add_u32 s30, s30, 28561408
  s_waitcnt vmcnt(12)
  s_barrier
  ds_read_b128 v[32:35], v10 offset:0
  ds_read_b128 v[36:39], v10 offset:1024
  ds_read_b128 v[40:43], v10 offset:2048
  ds_read_b128 v[44:47], v10 offset:3072
  ds_read_b128 v[48:51], v10 offset:4096
  s_waitcnt lgkmcnt(4)
  v_mfma_f32_16x16x32_bf16 v[72:75], v[32:35], a[0:3], 0
  ds_read_b128 v[52:55], v10 offset:5120
  s_add_u32 m0, s25, 40960
  s_nop 0
  s_waitcnt lgkmcnt(4)
  v_mfma_f32_16x16x32_bf16 v[76:79], v[36:39], a[0:3], 0
  ds_read_b128 v[56:59], v10 offset:6144
  buffer_load_dwordx4 v14, s[4:7], s24 offen lds
  buffer_load_dwordx4 a[32:35], v6, s[4:7], s23 offen offset:0
  s_waitcnt lgkmcnt(4)
  v_mfma_f32_16x16x32_bf16 v[80:83], v[40:43], a[0:3], 0
  ds_read_b128 v[60:63], v10 offset:7168
  s_add_u32 m0, s25, 41984
  s_nop 0
  s_waitcnt lgkmcnt(4)
  v_mfma_f32_16x16x32_bf16 v[84:87], v[44:47], a[0:3], 0
  ds_read_b128 v[64:67], v10 offset:8192
  buffer_load_dwordx4 v15, s[4:7], s24 offen lds
  buffer_load_dwordx4 a[36:39], v6, s[4:7], s23 offen offset:2048
  s_waitcnt lgkmcnt(4)
  v_mfma_f32_16x16x32_bf16 v[88:91], v[48:51], a[0:3], 0
  ds_read_b128 v[68:71], v10 offset:9216
  s_add_u32 s23, s23, 4096
  s_add_u32 m0, s25, 43008
  s_waitcnt lgkmcnt(4)
  v_mfma_f32_16x16x32_bf16 v[72:75], v[52:55], a[4:7], v[72:75]
  ds_read_b128 v[32:35], v10 offset:10240
  s_nop 0
  buffer_load_dwordx4 v16, s[4:7], s24 offen lds
  s_waitcnt lgkmcnt(4)
  v_mfma_f32_16x16x32_bf16 v[76:79], v[56:59], a[4:7], v[76:79]
  ds_read_b128 v[36:39], v10 offset:11264
  buffer_load_dwordx4 a[40:43], v6, s[4:7], s23 offen offset:0
  s_add_u32 m0, s25, 44032
  s_waitcnt lgkmcnt(4)
  v_mfma_f32_16x16x32_bf16 v[80:83], v[60:63], a[4:7], v[80:83]
  ds_read_b128 v[40:43], v10 offset:12288
  s_nop 0
  buffer_load_dwordx4 v17, s[4:7], s24 offen lds
  s_waitcnt lgkmcnt(4)
  v_mfma_f32_16x16x32_bf16 v[84:87], v[64:67], a[4:7], v[84:87]
  ds_read_b128 v[44:47], v10 offset:13312
  buffer_load_dwordx4 a[44:47], v6, s[4:7], s23 offen offset:2048
  s_add_u32 s23, s23, 4096
  s_waitcnt lgkmcnt(4)
  v_mfma_f32_16x16x32_bf16 v[88:91], v[68:71], a[4:7], v[88:91]
  ds_read_b128 v[48:51], v10 offset:14336
  s_add_u32 m0, s25, 45056
  s_nop 0
  s_waitcnt lgkmcnt(4)
  v_mfma_f32_16x16x32_bf16 v[72:75], v[32:35], a[8:11], v[72:75]
  ds_read_b128 v[52:55], v10 offset:15360
  buffer_load_dwordx4 v18, s[4:7], s24 offen lds
  s_add_u32 s24, s24, 4096
  s_waitcnt lgkmcnt(4)
  v_mfma_f32_16x16x32_bf16 v[76:79], v[36:39], a[8:11], v[76:79]
  ds_read_b128 v[56:59], v10 offset:16384
  s_waitcnt lgkmcnt(4)
  v_mfma_f32_16x16x32_bf16 v[80:83], v[40:43], a[8:11], v[80:83]
  ds_read_b128 v[60:63], v10 offset:17408
  s_waitcnt lgkmcnt(4)
  v_mfma_f32_16x16x32_bf16 v[84:87], v[44:47], a[8:11], v[84:87]
  ds_read_b128 v[64:67], v10 offset:18432
  s_waitcnt lgkmcnt(4)
  v_mfma_f32_16x16x32_bf16 v[88:91], v[48:51], a[8:11], v[88:91]
  ds_read_b128 v[68:71], v10 offset:19456
  s_waitcnt vmcnt(12)
  s_waitcnt lgkmcnt(0)
  s_barrier
  v_mfma_f32_16x16x32_bf16 v[72:75], v[52:55], a[12:15], v[72:75]
  ds_read_b128 v[32:35], v10 offset:20480
  v_mfma_f32_16x16x32_bf16 v[76:79], v[56:59], a[12:15], v[76:79]
  ds_read_b128 v[36:39], v10 offset:21504
  v_mfma_f32_16x16x32_bf16 v[80:83], v[60:63], a[12:15], v[80:83]
  ds_read_b128 v[40:43], v10 offset:22528
  v_mfma_f32_16x16x32_bf16 v[84:87], v[64:67], a[12:15], v[84:87]
  ds_read_b128 v[44:47], v10 offset:23552
  v_mfma_f32_16x16x32_bf16 v[88:91], v[68:71], a[12:15], v[88:91]
  ds_read_b128 v[48:51], v10 offset:24576
  s_waitcnt lgkmcnt(4)
  v_mfma_f32_16x16x32_bf16 v[72:75], v[32:35], a[16:19], v[72:75]
  ds_read_b128 v[52:55], v10 offset:25600
  s_add_u32 m0, s25, 61440
  s_nop 0
  s_waitcnt lgkmcnt(4)
  v_mfma_f32_16x16x32_bf16 v[76:79], v[36:39], a[16:19], v[76:79]
  ds_read_b128 v[56:59], v10 offset:26624
  buffer_load_dwordx4 v14, s[4:7], s24 offen lds
  buffer_load_dwordx4 a[48:51], v6, s[4:7], s23 offen offset:0
  s_waitcnt lgkmcnt(4)
  v_mfma_f32_16x16x32_bf16 v[80:83], v[40:43], a[16:19], v[80:83]
  ds_read_b128 v[60:63], v10 offset:27648
  s_add_u32 m0, s25, 62464
  s_nop 0
  s_waitcnt lgkmcnt(4)
  v_mfma_f32_16x16x32_bf16 v[84:87], v[44:47], a[16:19], v[84:87]
  ds_read_b128 v[64:67], v10 offset:28672
  buffer_load_dwordx4 v15, s[4:7], s24 offen lds
  buffer_load_dwordx4 a[52:55], v6, s[4:7], s23 offen offset:2048
  s_waitcnt lgkmcnt(4)
  v_mfma_f32_16x16x32_bf16 v[88:91], v[48:51], a[16:19], v[88:91]
  ds_read_b128 v[68:71], v10 offset:29696
  s_add_u32 s23, s23, 4096
  s_add_u32 m0, s25, 63488
  s_waitcnt lgkmcnt(4)
  v_mfma_f32_16x16x32_bf16 v[72:75], v[52:55], a[20:23], v[72:75]
  ds_read_b128 v[32:35], v10 offset:30720
  s_nop 0
  buffer_load_dwordx4 v16, s[4:7], s24 offen lds
  s_waitcnt lgkmcnt(4)
  v_mfma_f32_16x16x32_bf16 v[76:79], v[56:59], a[20:23], v[76:79]
  ds_read_b128 v[36:39], v10 offset:31744
  buffer_load_dwordx4 a[56:59], v6, s[4:7], s23 offen offset:0
  s_add_u32 m0, s25, 64512
  s_waitcnt lgkmcnt(4)
  v_mfma_f32_16x16x32_bf16 v[80:83], v[60:63], a[20:23], v[80:83]
  ds_read_b128 v[40:43], v10 offset:32768
  s_nop 0
  buffer_load_dwordx4 v17, s[4:7], s24 offen lds
  s_waitcnt lgkmcnt(4)
  v_mfma_f32_16x16x32_bf16 v[84:87], v[64:67], a[20:23], v[84:87]
  ds_read_b128 v[44:47], v10 offset:33792
  buffer_load_dwordx4 a[60:63], v6, s[4:7], s23 offen offset:2048
  s_add_u32 s23, s23, 4096
  s_waitcnt lgkmcnt(4)
  v_mfma_f32_16x16x32_bf16 v[88:91], v[68:71], a[20:23], v[88:91]
  ds_read_b128 v[48:51], v10 offset:34816
  s_add_u32 m0, s25, 65536
  s_nop 0
  s_waitcnt lgkmcnt(4)
  v_mfma_f32_16x16x32_bf16 v[72:75], v[32:35], a[24:27], v[72:75]
  ds_read_b128 v[52:55], v10 offset:35840
  buffer_load_dwordx4 v18, s[4:7], s24 offen lds
  s_add_u32 s24, s24, 4096
  s_waitcnt lgkmcnt(4)
  v_mfma_f32_16x16x32_bf16 v[76:79], v[36:39], a[24:27], v[76:79]
  ds_read_b128 v[56:59], v10 offset:36864
  s_waitcnt lgkmcnt(4)
  v_mfma_f32_16x16x32_bf16 v[80:83], v[40:43], a[24:27], v[80:83]
  ds_read_b128 v[60:63], v10 offset:37888
  s_waitcnt lgkmcnt(4)
  v_mfma_f32_16x16x32_bf16 v[84:87], v[44:47], a[24:27], v[84:87]
  ds_read_b128 v[64:67], v10 offset:38912
  s_waitcnt lgkmcnt(4)
  v_mfma_f32_16x16x32_bf16 v[88:91], v[48:51], a[24:27], v[88:91]
  ds_read_b128 v[68:71], v10 offset:39936
  s_waitcnt vmcnt(9)
  s_waitcnt lgkmcnt(0)
  s_barrier
  v_mfma_f32_16x16x32_bf16 v[72:75], v[52:55], a[28:31], v[72:75]
  ds_read_b128 v[32:35], v10 offset:40960
  v_mfma_f32_16x16x32_bf16 v[76:79], v[56:59], a[28:31], v[76:79]
  ds_read_b128 v[36:39], v10 offset:41984
  v_mfma_f32_16x16x32_bf16 v[80:83], v[60:63], a[28:31], v[80:83]
  ds_read_b128 v[40:43], v10 offset:43008
  v_mfma_f32_16x16x32_bf16 v[84:87], v[64:67], a[28:31], v[84:87]
  ds_read_b128 v[44:47], v10 offset:44032
  v_mfma_f32_16x16x32_bf16 v[88:91], v[68:71], a[28:31], v[88:91]
  ds_read_b128 v[48:51], v10 offset:45056
  s_waitcnt lgkmcnt(4)
  v_mfma_f32_16x16x32_bf16 v[72:75], v[32:35], a[32:35], v[72:75]
  ds_read_b128 v[52:55], v10 offset:46080
  s_add_u32 m0, s25, 81920
  s_nop 0
  s_waitcnt lgkmcnt(4)
  v_mfma_f32_16x16x32_bf16 v[76:79], v[36:39], a[32:35], v[76:79]
  ds_read_b128 v[56:59], v10 offset:47104
  buffer_load_dwordx4 v14, s[4:7], s24 offen lds
  buffer_load_dwordx4 a[64:67], v6, s[4:7], s23 offen offset:0
  s_waitcnt lgkmcnt(4)
  v_mfma_f32_16x16x32_bf16 v[80:83], v[40:43], a[32:35], v[80:83]
  ds_read_b128 v[60:63], v10 offset:48128
  s_add_u32 m0, s25, 82944
  s_nop 0
  s_waitcnt lgkmcnt(4)
  v_mfma_f32_16x16x32_bf16 v[84:87], v[44:47], a[32:35], v[84:87]
  ds_read_b128 v[64:67], v10 offset:49152
  buffer_load_dwordx4 v15, s[4:7], s24 offen lds
  buffer_load_dwordx4 a[68:71], v6, s[4:7], s23 offen offset:2048
  s_waitcnt lgkmcnt(4)
  v_mfma_f32_16x16x32_bf16 v[88:91], v[48:51], a[32:35], v[88:91]
  ds_read_b128 v[68:71], v10 offset:50176
  s_add_u32 s23, s23, 4096
  s_add_u32 m0, s25, 83968
  s_waitcnt lgkmcnt(4)
  v_mfma_f32_16x16x32_bf16 v[72:75], v[52:55], a[36:39], v[72:75]
  ds_read_b128 v[32:35], v10 offset:51200
  s_nop 0
  buffer_load_dwordx4 v16, s[4:7], s24 offen lds
  s_waitcnt lgkmcnt(4)
  v_mfma_f32_16x16x32_bf16 v[76:79], v[56:59], a[36:39], v[76:79]
  ds_read_b128 v[36:39], v10 offset:52224
  buffer_load_dwordx4 a[72:75], v6, s[4:7], s23 offen offset:0
  s_add_u32 m0, s25, 84992
  s_waitcnt lgkmcnt(4)
  v_mfma_f32_16x16x32_bf16 v[80:83], v[60:63], a[36:39], v[80:83]
  ds_read_b128 v[40:43], v10 offset:53248
  s_nop 0
  buffer_load_dwordx4 v17, s[4:7], s24 offen lds
  s_waitcnt lgkmcnt(4)
  v_mfma_f32_16x16x32_bf16 v[84:87], v[64:67], a[36:39], v[84:87]
  ds_read_b128 v[44:47], v10 offset:54272
  buffer_load_dwordx4 a[76:79], v6, s[4:7], s23 offen offset:2048
  s_add_u32 s23, s23, 4096
  s_waitcnt lgkmcnt(4)
  v_mfma_f32_16x16x32_bf16 v[88:91], v[68:71], a[36:39], v[88:91]
  ds_read_b128 v[48:51], v10 offset:55296
  s_add_u32 m0, s25, 86016
  s_nop 0
  s_waitcnt lgkmcnt(4)
  v_mfma_f32_16x16x32_bf16 v[72:75], v[32:35], a[40:43], v[72:75]
  ds_read_b128 v[52:55], v10 offset:56320
  buffer_load_dwordx4 v18, s[4:7], s24 offen lds
  s_add_u32 s24, s24, 4096
  s_waitcnt lgkmcnt(4)
  v_mfma_f32_16x16x32_bf16 v[76:79], v[36:39], a[40:43], v[76:79]
  ds_read_b128 v[56:59], v10 offset:57344
  s_waitcnt lgkmcnt(4)
  v_mfma_f32_16x16x32_bf16 v[80:83], v[40:43], a[40:43], v[80:83]
  ds_read_b128 v[60:63], v10 offset:58368
  s_waitcnt lgkmcnt(4)
  v_mfma_f32_16x16x32_bf16 v[84:87], v[44:47], a[40:43], v[84:87]
  ds_read_b128 v[64:67], v10 offset:59392
  s_waitcnt lgkmcnt(4)
  v_mfma_f32_16x16x32_bf16 v[88:91], v[48:51], a[40:43], v[88:91]
  ds_read_b128 v[68:71], v10 offset:60416
  s_waitcnt vmcnt(9)
  s_waitcnt lgkmcnt(0)
  s_barrier
  v_mfma_f32_16x16x32_bf16 v[72:75], v[52:55], a[44:47], v[72:75]
  ds_read_b128 v[32:35], v10 offset:61440
  v_mfma_f32_16x16x32_bf16 v[76:79], v[56:59], a[44:47], v[76:79]
  ds_read_b128 v[36:39], v10 offset:62464
  v_mfma_f32_16x16x32_bf16 v[80:83], v[60:63], a[44:47], v[80:83]
  ds_read_b128 v[40:43], v10 offset:63488
  v_mfma_f32_16x16x32_bf16 v[84:87], v[64:67], a[44:47], v[84:87]
  ds_read_b128 v[44:47], v10 offset:64512
  v_mfma_f32_16x16x32_bf16 v[88:91], v[68:71], a[44:47], v[88:91]
  ds_read_b128 v[48:51], v11 offset:0
  ds_read_b64 v[22:23], v8 offset:0
  ds_read_b64 v[24:25], v8 offset:32
  ds_read_b64 v[26:27], v8 offset:64
  ds_read_b64 v[28:29], v8 offset:96
  ds_read_b64 v[30:31], v8 offset:128
  ds_read_b128 v[92:95], v7 offset:0
  ds_read_b128 v[96:99], v7 offset:64
  ds_read_b128 v[100:103], v7 offset:128
  ds_read_b128 v[104:107], v7 offset:192
  ds_read_b128 v[108:111], v7 offset:256
  ds_read_b128 v[112:115], v7 offset:320
  ds_read_b128 v[116:119], v7 offset:384
  ds_read_b128 v[120:123], v7 offset:448
  ds_read_b128 v[124:127], v7 offset:512
  ds_read_b128 v[128:131], v7 offset:576
  s_waitcnt lgkmcnt(10)
  v_lshlrev_b32 v132, 16, v22
  v_and_b32 v133, 0xffff0000, v22
  v_lshlrev_b32 v134, 16, v23
  v_and_b32 v135, 0xffff0000, v23
  v_lshlrev_b32 v136, 16, v24
  v_and_b32 v137, 0xffff0000, v24
  v_lshlrev_b32 v138, 16, v25
  v_and_b32 v139, 0xffff0000, v25
  v_lshlrev_b32 v140, 16, v26
  v_and_b32 v141, 0xffff0000, v26
  v_lshlrev_b32 v142, 16, v27
  v_and_b32 v143, 0xffff0000, v27
  v_lshlrev_b32 v144, 16, v28
  v_and_b32 v145, 0xffff0000, v28
  v_lshlrev_b32 v146, 16, v29
  v_and_b32 v147, 0xffff0000, v29
  v_lshlrev_b32 v148, 16, v30
  v_and_b32 v149, 0xffff0000, v30
  v_lshlrev_b32 v150, 16, v31
  v_and_b32 v151, 0xffff0000, v31
  v_mfma_f32_16x16x32_bf16 v[72:75], v[32:35], a[48:51], v[72:75]
  ds_read_b128 v[52:55], v11 offset:1024
  v_mfma_f32_16x16x32_bf16 v[76:79], v[36:39], a[48:51], v[76:79]
  ds_read_b128 v[56:59], v11 offset:2048
  v_mfma_f32_16x16x32_bf16 v[80:83], v[40:43], a[48:51], v[80:83]
  ds_read_b128 v[60:63], v11 offset:3072
  v_mfma_f32_16x16x32_bf16 v[84:87], v[44:47], a[48:51], v[84:87]
  ds_read_b128 v[64:67], v11 offset:4096
  v_mfma_f32_16x16x32_bf16 v[88:91], v[48:51], a[48:51], v[88:91]
  ds_read_b128 v[68:71], v11 offset:5120
  s_waitcnt lgkmcnt(4)
  v_mfma_f32_16x16x32_bf16 v[72:75], v[52:55], a[52:55], v[72:75]
  ds_read_b128 v[32:35], v11 offset:6144
  s_waitcnt lgkmcnt(4)
  v_mfma_f32_16x16x32_bf16 v[76:79], v[56:59], a[52:55], v[76:79]
  ds_read_b128 v[36:39], v11 offset:7168
  s_waitcnt lgkmcnt(4)
  v_mfma_f32_16x16x32_bf16 v[80:83], v[60:63], a[52:55], v[80:83]
  ds_read_b128 v[40:43], v11 offset:8192
  s_waitcnt lgkmcnt(4)
  v_mfma_f32_16x16x32_bf16 v[84:87], v[64:67], a[52:55], v[84:87]
  ds_read_b128 v[44:47], v11 offset:9216
  s_waitcnt lgkmcnt(4)
  v_mfma_f32_16x16x32_bf16 v[88:91], v[68:71], a[52:55], v[88:91]
  ds_read_b128 v[48:51], v11 offset:10240
  s_waitcnt lgkmcnt(4)
  v_mfma_f32_16x16x32_bf16 v[72:75], v[32:35], a[56:59], v[72:75]
  ds_read_b128 v[52:55], v11 offset:11264
  s_waitcnt lgkmcnt(4)
  v_mfma_f32_16x16x32_bf16 v[76:79], v[36:39], a[56:59], v[76:79]
  ds_read_b128 v[56:59], v11 offset:12288
  s_waitcnt lgkmcnt(4)
  v_mfma_f32_16x16x32_bf16 v[80:83], v[40:43], a[56:59], v[80:83]
  ds_read_b128 v[60:63], v11 offset:13312
  s_waitcnt lgkmcnt(4)
  v_mfma_f32_16x16x32_bf16 v[84:87], v[44:47], a[56:59], v[84:87]
  ds_read_b128 v[64:67], v11 offset:14336
  s_waitcnt lgkmcnt(4)
  v_mfma_f32_16x16x32_bf16 v[88:91], v[48:51], a[56:59], v[88:91]
  ds_read_b128 v[68:71], v11 offset:15360
  s_waitcnt vmcnt(0)
  s_waitcnt lgkmcnt(0)
  s_barrier
  v_mfma_f32_16x16x32_bf16 v[72:75], v[52:55], a[60:63], v[72:75]
  ds_read_b128 v[32:35], v11 offset:16384
  v_mfma_f32_16x16x32_bf16 v[76:79], v[56:59], a[60:63], v[76:79]
  ds_read_b128 v[36:39], v11 offset:17408
  v_mfma_f32_16x16x32_bf16 v[80:83], v[60:63], a[60:63], v[80:83]
  ds_read_b128 v[40:43], v11 offset:18432
  v_mfma_f32_16x16x32_bf16 v[84:87], v[64:67], a[60:63], v[84:87]
  ds_read_b128 v[44:47], v11 offset:19456
  v_mfma_f32_16x16x32_bf16 v[88:91], v[68:71], a[60:63], v[88:91]
  ds_read_b128 v[48:51], v11 offset:20480
  s_waitcnt lgkmcnt(4)
  v_mfma_f32_16x16x32_bf16 v[72:75], v[32:35], a[64:67], v[72:75]
  ds_read_b128 v[52:55], v11 offset:21504
  s_add_u32 m0, s26, 102400
  s_mov_b32 s29, 0
  s_waitcnt lgkmcnt(4)
  v_mfma_f32_16x16x32_bf16 v[76:79], v[36:39], a[64:67], v[76:79]
  ds_read_b128 v[56:59], v11 offset:22528
  buffer_load_dwordx4 v19, s[4:7], s29 offen lds
  s_add_u32 m0, s26, 106496
  s_waitcnt lgkmcnt(4)
  v_mfma_f32_16x16x32_bf16 v[80:83], v[40:43], a[64:67], v[80:83]
  ds_read_b128 v[60:63], v11 offset:23552
  s_mov_b32 s29, 1024
  buffer_load_dwordx4 v19, s[4:7], s29 offen lds
  s_waitcnt lgkmcnt(4)
  v_mfma_f32_16x16x32_bf16 v[84:87], v[44:47], a[64:67], v[84:87]
  ds_read_b128 v[64:67], v11 offset:24576
  s_add_u32 m0, s26, 110592
  s_mov_b32 s29, 2048
  s_waitcnt lgkmcnt(4)
  v_mfma_f32_16x16x32_bf16 v[88:91], v[48:51], a[64:67], v[88:91]
  ds_read_b128 v[68:71], v11 offset:25600
  buffer_load_dwordx4 v19, s[4:7], s29 offen lds
  s_add_u32 m0, s26, 114688
  s_waitcnt lgkmcnt(4)
  v_mfma_f32_16x16x32_bf16 v[72:75], v[52:55], a[68:71], v[72:75]
  ds_read_b128 v[32:35], v11 offset:26624
  s_mov_b32 s29, 3072
  buffer_load_dwordx4 v19, s[4:7], s29 offen lds
  s_waitcnt lgkmcnt(4)
  v_mfma_f32_16x16x32_bf16 v[76:79], v[56:59], a[68:71], v[76:79]
  ds_read_b128 v[36:39], v11 offset:27648
  s_add_u32 m0, s26, 118784
  s_mov_b32 s29, 4096
  s_waitcnt lgkmcnt(4)
  v_mfma_f32_16x16x32_bf16 v[80:83], v[60:63], a[68:71], v[80:83]
  ds_read_b128 v[40:43], v11 offset:28672
  buffer_load_dwordx4 v19, s[4:7], s29 offen lds
  s_waitcnt lgkmcnt(4)
  v_mfma_f32_16x16x32_bf16 v[84:87], v[64:67], a[68:71], v[84:87]
  ds_read_b128 v[44:47], v11 offset:29696
  s_waitcnt lgkmcnt(4)
  v_mfma_f32_16x16x32_bf16 v[88:91], v[68:71], a[68:71], v[88:91]
  ds_read_b128 v[48:51], v11 offset:30720
  s_waitcnt lgkmcnt(4)
  v_mfma_f32_16x16x32_bf16 v[72:75], v[32:35], a[72:75], v[72:75]
  ds_read_b128 v[52:55], v11 offset:31744
  s_waitcnt lgkmcnt(4)
  v_mfma_f32_16x16x32_bf16 v[76:79], v[36:39], a[72:75], v[76:79]
  ds_read_b128 v[56:59], v11 offset:32768
  s_waitcnt lgkmcnt(4)
  v_mfma_f32_16x16x32_bf16 v[80:83], v[40:43], a[72:75], v[80:83]
  ds_read_b128 v[60:63], v11 offset:33792
  s_waitcnt lgkmcnt(4)
  v_mfma_f32_16x16x32_bf16 v[84:87], v[44:47], a[72:75], v[84:87]
  ds_read_b128 v[64:67], v11 offset:34816
  s_waitcnt lgkmcnt(4)
  v_mfma_f32_16x16x32_bf16 v[88:91], v[48:51], a[72:75], v[88:91]
  ds_read_b128 v[68:71], v11 offset:35840
  s_waitcnt lgkmcnt(4)
  v_mfma_f32_16x16x32_bf16 v[72:75], v[52:55], a[76:79], v[72:75]
  s_waitcnt lgkmcnt(3)
  v_mfma_f32_16x16x32_bf16 v[76:79], v[56:59], a[76:79], v[76:79]
  s_waitcnt lgkmcnt(2)
  v_mfma_f32_16x16x32_bf16 v[80:83], v[60:63], a[76:79], v[80:83]
  s_waitcnt lgkmcnt(1)
  v_mfma_f32_16x16x32_bf16 v[84:87], v[64:67], a[76:79], v[84:87]
  s_waitcnt lgkmcnt(0)
  v_mfma_f32_16x16x32_bf16 v[88:91], v[68:71], a[76:79], v[88:91]
  v_and_b32 v14, 1, v4
  v_lshl_add_u32 v14, v14, 5, v3
  v_lshlrev_b32 v14, 4, v14
  v_lshrrev_b32 v5, 1, v4
  v_lshl_add_u32 v14, v5, 3, v14
  s_mul_i32 s21, s27, 40
  s_mul_i32 s22, s20, 5
  s_add_u32 s21, s21, s22
  s_lshl_b32 s21, s21, 10
  s_and_b32 s22, s16, 1
  s_lshl_b32 s23, s22, 8
  s_add_u32 s21, s21, s23
  s_add_u32 s21, s21, 23076864
  s_add_u32 s22, s21, 4096
  s_waitcnt lgkmcnt(0)
  v_fmac_f32 v132, v92, v72
  v_fmac_f32 v133, v93, v73
  v_fmac_f32 v134, v94, v74
  v_fmac_f32 v135, v95, v75
  v_fmac_f32 v136, v96, v76
  v_fmac_f32 v137, v97, v77
  v_fmac_f32 v138, v98, v78
  v_fmac_f32 v139, v99, v79
  v_fmac_f32 v140, v100, v80
  v_fmac_f32 v141, v101, v81
  v_fmac_f32 v142, v102, v82
  v_fmac_f32 v143, v103, v83
  v_fmac_f32 v144, v104, v84
  v_fmac_f32 v145, v105, v85
  v_fmac_f32 v146, v106, v86
  v_fmac_f32 v147, v107, v87
  v_fmac_f32 v148, v108, v88
  v_fmac_f32 v149, v109, v89
  v_fmac_f32 v150, v110, v90
  v_fmac_f32 v151, v111, v91
  v_mul_f32 v112, v112, v132
  v_mul_f32 v113, v113, v133
  v_mul_f32 v114, v114, v134
  v_mul_f32 v115, v115, v135
  v_mul_f32 v116, v116, v136
  v_mul_f32 v117, v117, v137
  v_mul_f32 v118, v118, v138
  v_mul_f32 v119, v119, v139
  v_mul_f32 v120, v120, v140
  v_mul_f32 v121, v121, v141
  v_mul_f32 v122, v122, v142
  v_mul_f32 v123, v123, v143
  v_mul_f32 v124, v124, v144
  v_mul_f32 v125, v125, v145
  v_mul_f32 v126, v126, v146
  v_mul_f32 v127, v127, v147
  v_mul_f32 v128, v128, v148
  v_mul_f32 v129, v129, v149
  v_mul_f32 v130, v130, v150
  v_mul_f32 v131, v131, v151
  v_cvt_pk_bf16_f32 v92, v112, v113
  v_cvt_pk_bf16_f32 v93, v114, v115
  buffer_store_dwordx2 v[92:93], v14, s[4:7], s21 offen offset:0 sc1
  v_cvt_pk_bf16_f32 v94, v116, v117
  v_cvt_pk_bf16_f32 v95, v118, v119
  buffer_store_dwordx2 v[94:95], v14, s[4:7], s21 offen offset:1024 sc1
  v_cvt_pk_bf16_f32 v96, v120, v121
  v_cvt_pk_bf16_f32 v97, v122, v123
  buffer_store_dwordx2 v[96:97], v14, s[4:7], s21 offen offset:2048 sc1
  v_cvt_pk_bf16_f32 v98, v124, v125
  v_cvt_pk_bf16_f32 v99, v126, v127
  buffer_store_dwordx2 v[98:99], v14, s[4:7], s21 offen offset:3072 sc1
  v_cvt_pk_bf16_f32 v100, v128, v129
  v_cvt_pk_bf16_f32 v101, v130, v131
  buffer_store_dwordx2 v[100:101], v14, s[4:7], s22 offen offset:0 sc1
  v_add_f32 v72, v132, v133
  v_mul_f32 v73, v132, v132
  v_add_f32 v74, v134, v135
  v_mul_f32 v75, v133, v133
  v_add_f32 v72, v72, v136
  v_add_f32 v74, v74, v137
  v_add_f32 v72, v72, v138
  v_add_f32 v74, v74, v139
  v_add_f32 v72, v72, v140
  v_add_f32 v74, v74, v141
  v_add_f32 v72, v72, v142
  v_add_f32 v74, v74, v143
  v_add_f32 v72, v72, v144
  v_add_f32 v74, v74, v145
  v_add_f32 v72, v72, v146
  v_add_f32 v74, v74, v147
  v_add_f32 v72, v72, v148
  v_add_f32 v74, v74, v149
  v_add_f32 v72, v72, v150
  v_add_f32 v74, v74, v151
  v_fmac_f32 v73, v134, v134
  v_fmac_f32 v75, v135, v135
  v_fmac_f32 v73, v136, v136
  v_fmac_f32 v75, v137, v137
  v_fmac_f32 v73, v138, v138
  v_fmac_f32 v75, v139, v139
  v_fmac_f32 v73, v140, v140
  v_fmac_f32 v75, v141, v141
  v_fmac_f32 v73, v142, v142
  v_fmac_f32 v75, v143, v143
  v_fmac_f32 v73, v144, v144
  v_fmac_f32 v75, v145, v145
  v_fmac_f32 v73, v146, v146
  v_fmac_f32 v75, v147, v147
  v_fmac_f32 v73, v148, v148
  v_fmac_f32 v75, v149, v149
  v_fmac_f32 v73, v150, v150
  v_fmac_f32 v75, v151, v151
  v_add_f32 v72, v72, v74
  v_add_f32 v73, v73, v75
  s_lshl_b32 s21, s27, 11
  s_lshl_b32 s22, s20, 8
  v_mov_b32 v74, v72
  v_mov_b32 v75, v73
  s_add_u32 s21, s21, s22
  s_lshr_b32 s23, s23, 1
  v_permlane16_swap_b32 v72, v74
  v_permlane16_swap_b32 v73, v75
  v_add_f32 v72, v72, v74
  v_add_f32 v73, v73, v75
  v_mov_b32 v74, v72
  v_mov_b32 v75, v73
  s_add_u32 s21, s21, s23
  s_add_u32 s21, s21, 28319744
  v_permlane32_swap_b32 v72, v74
  v_permlane32_swap_b32 v73, v75
  v_add_f32 v72, v72, v74
  v_add_f32 v73, v73, v75
  v_lshlrev_b32 v5, 3, v2
  s_mov_b64 exec, 0xffff
  buffer_store_dwordx2 v[72:73], v5, s[4:7], s21 offen sc1
  s_mov_b64 exec, -1
  v_cvt_pk_bf16_f32 v22, v132, v133
  v_cvt_pk_bf16_f32 v23, v134, v135
  v_cvt_pk_bf16_f32 v24, v136, v137
  v_cvt_pk_bf16_f32 v25, v138, v139
  v_cvt_pk_bf16_f32 v26, v140, v141
  v_cvt_pk_bf16_f32 v27, v142, v143
  v_cvt_pk_bf16_f32 v28, v144, v145
  v_cvt_pk_bf16_f32 v29, v146, v147
  v_cvt_pk_bf16_f32 v30, v148, v149
  v_cvt_pk_bf16_f32 v31, v150, v151
  v_bfe_u32 v176, v2, 4, 1
  v_lshlrev_b32 v176, 7, v176
  v_lshrrev_b32 v152, 5, v2
  v_lshl_add_u32 v176, v152, 6, v176
  v_lshl_add_u32 v176, v3, 2, v176
  s_add_u32 s21, s16, 0
  s_min_u32 s21, s21, 6
  s_add_u32 s21, s21, s28
  s_mul_i32 s21, s21, 2560
  s_add_u32 s21, s21, 35639296
  buffer_load_dword v152, v176, s[4:7], s21 offen offset:0
  buffer_load_dword v153, v176, s[4:7], s21 offen offset:256
  buffer_load_dword v154, v176, s[4:7], s21 offen offset:512
  buffer_load_dword v155, v176, s[4:7], s21 offen offset:768
  buffer_load_dword v156, v176, s[4:7], s21 offen offset:1024
  buffer_load_dword v157, v176, s[4:7], s21 offen offset:1280
  buffer_load_dword v158, v176, s[4:7], s21 offen offset:1536
  buffer_load_dword v159, v176, s[4:7], s21 offen offset:1792
  buffer_load_dword v160, v176, s[4:7], s21 offen offset:2048
  buffer_load_dword v161, v176, s[4:7], s21 offen offset:2304
  s_add_u32 s21, s16, 4
  s_min_u32 s21, s21, 6
  s_add_u32 s21, s21, s28
  s_mul_i32 s21, s21, 2560
  s_add_u32 s21, s21, 35639296
  buffer_load_dword v164, v176, s[4:7], s21 offen offset:0
  buffer_load_dword v165, v176, s[4:7], s21 offen offset:256
  buffer_load_dword v166, v176, s[4:7], s21 offen offset:512
  buffer_load_dword v167, v176, s[4:7], s21 offen offset:768
  buffer_load_dword v168, v176, s[4:7], s21 offen offset:1024
  buffer_load_dword v169, v176, s[4:7], s21 offen offset:1280
  buffer_load_dword v170, v176, s[4:7], s21 offen offset:1536
  buffer_load_dword v171, v176, s[4:7], s21 offen offset:1792
  buffer_load_dword v172, v176, s[4:7], s21 offen offset:2048
  buffer_load_dword v173, v176, s[4:7], s21 offen offset:2304
  s_add_u32 m0, s26, 122880
  s_mov_b32 s29, 5120
  buffer_load_dwordx4 v19, s[4:7], s29 offen lds
  s_add_u32 m0, s26, 126976
  s_mov_b32 s29, 6144
  buffer_load_dwordx4 v19, s[4:7], s29 offen lds
  s_add_u32 m0, s26, 131072
  s_mov_b32 s29, 7168
  buffer_load_dwordx4 v19, s[4:7], s29 offen lds
  s_add_u32 m0, s26, 135168
  s_mov_b32 s29, 8192
  buffer_load_dwordx4 v19, s[4:7], s29 offen lds
  s_add_u32 m0, s26, 139264
  s_mov_b32 s29, 9216
  buffer_load_dwordx4 v19, s[4:7], s29 offen lds
  s_waitcnt vmcnt(25)
  s_barrier
  s_lshl_b32 s22, s17, 8
  s_add_u32 s22, s22, 35921920
  v_mov_b32 v5, 0
  s_cmp_lg_u32 s16, 0
  s_cbranch_scc1 k456_kernel_arr3
  v_mov_b32 v8, 1
  s_mov_b64 exec, 1
  buffer_atomic_add v8, v5, s[4:7], s22 offen sc1
  s_mov_b64 exec, -1
k456_kernel_arr3:
  s_add_u32 m0, s26, 0
  s_mov_b32 s29, 10240
  buffer_load_dwordx4 v19, s[4:7], s29 offen lds
  s_add_u32 m0, s26, 4096
  s_mov_b32 s29, 11264
  buffer_load_dwordx4 v19, s[4:7], s29 offen lds
  s_add_u32 m0, s26, 8192
  s_mov_b32 s29, 12288
  buffer_load_dwordx4 v19, s[4:7], s29 offen lds
  s_add_u32 m0, s26, 12288
  s_mov_b32 s29, 13312
  buffer_load_dwordx4 v19, s[4:7], s29 offen lds
  s_add_u32 m0, s26, 16384
  s_mov_b32 s29, 14336
  buffer_load_dwordx4 v19, s[4:7], s29 offen lds
  s_add_u32 m0, s26, 20480
  s_mov_b32 s29, 15360
  buffer_load_dwordx4 v19, s[4:7], s29 offen lds
  s_add_u32 m0, s26, 24576
  s_mov_b32 s29, 16384
  buffer_load_dwordx4 v19, s[4:7], s29 offen lds
  s_add_u32 m0, s26, 28672
  s_mov_b32 s29, 17408
  buffer_load_dwordx4 v19, s[4:7], s29 offen lds
  s_add_u32 m0, s26, 32768
  s_mov_b32 s29, 18432
  buffer_load_dwordx4 v19, s[4:7], s29 offen lds
  s_add_u32 m0, s26, 36864
  s_mov_b32 s29, 19456
  buffer_load_dwordx4 v19, s[4:7], s29 offen lds
  s_waitcnt vmcnt(15)
  v_add_f32 v152, v152, v157
  v_add_f32 v153, v153, v158
  v_add_f32 v154, v154, v159
  v_add_f32 v155, v155, v160
  v_add_f32 v156, v156, v161
  v_add_f32 v152, v152, v153
  v_add_f32 v154, v154, v155
  v_add_f32 v152, v152, v156
  v_add_f32 v152, v152, v154
  v_mov_b32 v153, v152
  s_add_u32 s21, s16, 0
  s_min_u32 s21, s21, 6
  v_permlane32_swap_b32 v152, v153
  s_lshl_b32 s21, s21, 10
  s_add_u32 s21, s21, 156672
  v_cvt_pk_bf16_f32 v163, v152, v153
  v_lshlrev_b32 v156, 16, v163
  v_and_b32 v157, 0xffff0000, v163
  v_sub_f32 v158, v152, v156
  v_sub_f32 v159, v153, v157
  v_cvt_pk_bf16_f32 v160, v156, v158
  v_mov_b32 v161, v163
  v_cvt_pk_bf16_f32 v162, v159, v157
  v_mov_b32 v163, 0
  s_mov_b32 exec_lo, 0
  v_mov_b32 v160, 0
  v_mov_b32 v161, 0
  v_mov_b32 v162, 0
  s_mov_b64 exec, -1
  v_add_u32 v176, s21, v10
  ds_write_b128 v176, v[160:163]
  v_add_f32 v164, v164, v169
  v_add_f32 v165, v165, v170
  v_add_f32 v166, v166, v171
  v_add_f32 v167, v167, v172
  v_add_f32 v168, v168, v173
  v_add_f32 v164, v164, v165
  v_add_f32 v166, v166, v167
  v_add_f32 v164, v164, v168
  v_add_f32 v164, v164, v166
  v_mov_b32 v165, v164
  s_add_u32 s21, s16, 4
  s_min_u32 s21, s21, 6
  v_permlane32_swap_b32 v164, v165
  s_lshl_b32 s21, s21, 10
  s_add_u32 s21, s21, 156672
  v_cvt_pk_bf16_f32 v175, v164, v165
  v_lshlrev_b32 v168, 16, v175
  v_and_b32 v169, 0xffff0000, v175
  v_sub_f32 v170, v164, v168
  v_sub_f32 v171, v165, v169
  v_cvt_pk_bf16_f32 v172, v168, v170
  v_mov_b32 v173, v175
  v_cvt_pk_bf16_f32 v174, v171, v169
  v_mov_b32 v175, 0
  s_mov_b32 exec_lo, 0
  v_mov_b32 v172, 0
  v_mov_b32 v173, 0
  v_mov_b32 v174, 0
  s_mov_b64 exec, -1
  v_add_u32 v176, s21, v10
  ds_write_b128 v176, v[172:175]
  s_waitcnt lgkmcnt(0)
  s_cmp_lg_u32 s16, 0
  s_cbranch_scc1 k456_kernel_got5
  s_mov_b32 s29, 0
k456_kernel_poll4:
  buffer_load_dword v8, v5, s[4:7], s22 offen sc1
  s_add_u32 s29, s29, 1
  s_cmp_gt_u32 s29, 0x80000
  s_cbranch_scc1 k456_kernel_got5
  s_waitcnt vmcnt(0)
  v_readfirstlane_b32 s21, v8
  s_cmp_lt_u32 s21, 16
  s_cbranch_scc1 k456_kernel_poll4
k456_kernel_got5:
  s_barrier
  s_mov_b32 s23, 0
  buffer_load_dwordx4 a[0:3], v21, s[4:7], s23 offen offset:0 sc1
  buffer_load_dwordx4 a[4:7], v21, s[4:7], s23 offen offset:1024 sc1
  buffer_load_dwordx4 a[8:11], v21, s[4:7], s23 offen offset:2048 sc1
  buffer_load_dwordx4 a[12:15], v21, s[4:7], s23 offen offset:3072 sc1
  s_mov_b32 s23, 4096
  buffer_load_dwordx4 a[16:19], v21, s[4:7], s23 offen offset:0 sc1
  buffer_load_dwordx4 a[20:23], v21, s[4:7], s23 offen offset:1024 sc1
  s_barrier
  ds_read_b128 v[144:147], v11 offset:36864
  ds_read_b128 v[148:151], v11 offset:37888
  ds_read_b128 v[152:155], v11 offset:38912
  ds_read_b128 v[156:159], v11 offset:39936
  v_mov_b32 v197, 0xc0135761
  v_mov_b32 v198, 0xbdd2d3e8
  v_add_u32 v199, 156672, v10
  v_and_b32 v5, 31, v2
  v_lshlrev_b32 v5, 3, v5
  v_lshrrev_b32 v8, 5, v2
  v_lshl_add_u32 v5, v8, 8, v5
  s_waitcnt vmcnt(5)
  s_waitcnt lgkmcnt(3)
  v_mfma_f32_32x32x16_bf16 v[32:47], v[144:147], a[0:3], 0
  ds_read_b128 v[144:147], v11 offset:40960
  buffer_load_dwordx4 a[24:27], v21, s[4:7], s23 offen offset:2048 sc1
  buffer_load_dwordx4 a[28:31], v21, s[4:7], s23 offen offset:3072 sc1
  s_waitcnt lgkmcnt(3)
  v_mfma_f32_32x32x16_bf16 v[48:63], v[148:151], a[0:3], 0
  ds_read_b128 v[148:151], v11 offset:41984
  s_waitcnt lgkmcnt(3)
  v_mfma_f32_32x32x16_bf16 v[64:79], v[152:155], a[0:3], 0
  ds_read_b128 v[152:155], v11 offset:43008
  s_waitcnt lgkmcnt(3)
  v_mfma_f32_32x32x16_bf16 v[80:95], v[156:159], a[0:3], 0
  ds_read_b128 v[156:159], v11 offset:44032
  s_waitcnt vmcnt(6)
  s_waitcnt lgkmcnt(3)
  v_mfma_f32_32x32x16_bf16 v[32:47], v[144:147], a[4:7], v[32:47]
  ds_read_b128 v[144:147], v11 offset:45056
  s_mov_b32 s23, 8192
  buffer_load_dwordx4 a[32:35], v21, s[4:7], s23 offen offset:0 sc1
  s_waitcnt lgkmcnt(3)
  v_mfma_f32_32x32x16_bf16 v[48:63], v[148:151], a[4:7], v[48:63]
  ds_read_b128 v[148:151], v11 offset:46080
  buffer_load_dwordx4 a[36:39], v21, s[4:7], s23 offen offset:1024 sc1
  s_waitcnt lgkmcnt(3)
  v_mfma_f32_32x32x16_bf16 v[64:79], v[152:155], a[4:7], v[64:79]
  ds_read_b128 v[152:155], v11 offset:47104
  s_waitcnt lgkmcnt(3)
  v_mfma_f32_32x32x16_bf16 v[80:95], v[156:159], a[4:7], v[80:95]
  ds_read_b128 v[156:159], v11 offset:48128
  s_waitcnt vmcnt(7)
  s_waitcnt lgkmcnt(3)
  v_mfma_f32_32x32x16_bf16 v[32:47], v[144:147], a[8:11], v[32:47]
  ds_read_b128 v[144:147], v11 offset:49152
  buffer_load_dwordx4 a[40:43], v21, s[4:7], s23 offen offset:2048 sc1
  buffer_load_dwordx4 a[44:47], v21, s[4:7], s23 offen offset:3072 sc1
  s_waitcnt lgkmcnt(3)
  v_mfma_f32_32x32x16_bf16 v[48:63], v[148:151], a[8:11], v[48:63]
  ds_read_b128 v[148:151], v11 offset:50176
  s_waitcnt lgkmcnt(3)
  v_mfma_f32_32x32x16_bf16 v[64:79], v[152:155], a[8:11], v[64:79]
  ds_read_b128 v[152:155], v11 offset:51200
  s_waitcnt lgkmcnt(3)
  v_mfma_f32_32x32x16_bf16 v[80:95], v[156:159], a[8:11], v[80:95]
  ds_read_b128 v[156:159], v11 offset:52224
  s_waitcnt vmcnt(8)
  s_waitcnt lgkmcnt(3)
  v_mfma_f32_32x32x16_bf16 v[32:47], v[144:147], a[12:15], v[32:47]
  ds_read_b128 v[144:147], v11 offset:53248
  s_mov_b32 s23, 12288
  buffer_load_dwordx4 a[48:51], v21, s[4:7], s23 offen offset:0 sc1
  s_waitcnt lgkmcnt(3)
  v_mfma_f32_32x32x16_bf16 v[48:63], v[148:151], a[12:15], v[48:63]
  ds_read_b128 v[148:151], v11 offset:54272
  buffer_load_dwordx4 a[52:55], v21, s[4:7], s23 offen offset:1024 sc1
  s_waitcnt lgkmcnt(3)
  v_mfma_f32_32x32x16_bf16 v[64:79], v[152:155], a[12:15], v[64:79]
  ds_read_b128 v[152:155], v11 offset:55296
  s_waitcnt lgkmcnt(3)
  v_mfma_f32_32x32x16_bf16 v[80:95], v[156:159], a[12:15], v[80:95]
  ds_read_b128 v[156:159], v11 offset:56320
  s_barrier
  s_waitcnt vmcnt(9)
  s_waitcnt lgkmcnt(3)
  v_mfma_f32_32x32x16_bf16 v[32:47], v[144:147], a[16:19], v[32:47]
  ds_read_b128 v[144:147], v11 offset:57344
  buffer_load_dwordx4 a[56:59], v21, s[4:7], s23 offen offset:2048 sc1
  buffer_load_dwordx4 a[60:63], v21, s[4:7], s23 offen offset:3072 sc1
  s_waitcnt lgkmcnt(3)
  v_mfma_f32_32x32x16_bf16 v[48:63], v[148:151], a[16:19], v[48:63]
  ds_read_b128 v[148:151], v11 offset:58368
  s_waitcnt lgkmcnt(3)
  v_mfma_f32_32x32x16_bf16 v[64:79], v[152:155], a[16:19], v[64:79]
  ds_read_b128 v[152:155], v11 offset:59392
  s_waitcnt lgkmcnt(3)
  v_mfma_f32_32x32x16_bf16 v[80:95], v[156:159], a[16:19], v[80:95]
  ds_read_b128 v[156:159], v11 offset:60416
  s_waitcnt vmcnt(10)
  s_waitcnt lgkmcnt(3)
  v_mfma_f32_32x32x16_bf16 v[32:47], v[144:147], a[20:23], v[32:47]
  ds_read_b128 v[144:147], v11 offset:61440
  s_mov_b32 s23, 16384
  buffer_load_dwordx4 a[64:67], v21, s[4:7], s23 offen offset:0 sc1
  s_waitcnt lgkmcnt(3)
  v_mfma_f32_32x32x16_bf16 v[48:63], v[148:151], a[20:23], v[48:63]
  ds_read_b128 v[148:151], v11 offset:62464
  buffer_load_dwordx4 a[68:71], v21, s[4:7], s23 offen offset:1024 sc1
  s_waitcnt lgkmcnt(3)
  v_mfma_f32_32x32x16_bf16 v[64:79], v[152:155], a[20:23], v[64:79]
  ds_read_b128 v[152:155], v11 offset:63488
  s_waitcnt lgkmcnt(3)
  v_mfma_f32_32x32x16_bf16 v[80:95], v[156:159], a[20:23], v[80:95]
  ds_read_b128 v[156:159], v11 offset:64512
  s_waitcnt vmcnt(11)
  s_waitcnt lgkmcnt(3)
  v_mfma_f32_32x32x16_bf16 v[32:47], v[144:147], a[24:27], v[32:47]
  ds_read_b128 v[144:147], v12 offset:0
  buffer_load_dwordx4 a[72:75], v21, s[4:7], s23 offen offset:2048 sc1
  s_waitcnt lgkmcnt(3)
  v_mfma_f32_32x32x16_bf16 v[48:63], v[148:151], a[24:27], v[48:63]
  ds_read_b128 v[148:151], v12 offset:1024
  s_waitcnt lgkmcnt(3)
  v_mfma_f32_32x32x16_bf16 v[64:79], v[152:155], a[24:27], v[64:79]
  ds_read_b128 v[152:155], v12 offset:2048
  s_waitcnt lgkmcnt(3)
  v_mfma_f32_32x32x16_bf16 v[80:95], v[156:159], a[24:27], v[80:95]
  ds_read_b128 v[156:159], v12 offset:3072
  s_waitcnt vmcnt(11)
  s_waitcnt lgkmcnt(3)
  v_mfma_f32_32x32x16_bf16 v[32:47], v[144:147], a[28:31], v[32:47]
  ds_read_b128 v[144:147], v12 offset:4096
  buffer_load_dwordx4 a[76:79], v21, s[4:7], s23 offen offset:3072 sc1
  s_waitcnt lgkmcnt(3)
  v_mfma_f32_32x32x16_bf16 v[48:63], v[148:151], a[28:31], v[48:63]
  ds_read_b128 v[148:151], v12 offset:5120
  s_waitcnt lgkmcnt(3)
  v_mfma_f32_32x32x16_bf16 v[64:79], v[152:155], a[28:31], v[64:79]
  ds_read_b128 v[152:155], v12 offset:6144
  s_waitcnt lgkmcnt(3)
  v_mfma_f32_32x32x16_bf16 v[80:95], v[156:159], a[28:31], v[80:95]
  ds_read_b128 v[156:159], v12 offset:7168
  s_waitcnt vmcnt(11)
  s_waitcnt lgkmcnt(3)
  v_mfma_f32_32x32x16_bf16 v[32:47], v[144:147], a[32:35], v[32:47]
  ds_read_b128 v[144:147], v12 offset:8192
  s_mov_b32 s23, 20480
  buffer_load_dwordx4 a[80:83], v21, s[4:7], s23 offen offset:0 sc1
  s_waitcnt lgkmcnt(3)
  v_mfma_f32_32x32x16_bf16 v[48:63], v[148:151], a[32:35], v[48:63]
  ds_read_b128 v[148:151], v12 offset:9216
  s_lshl_b32 s21, s31, 11
  s_add_u32 s21, s21, 28319744
  s_waitcnt lgkmcnt(3)
  v_mfma_f32_32x32x16_bf16 v[64:79], v[152:155], a[32:35], v[64:79]
  ds_read_b128 v[152:155], v12 offset:10240
  buffer_load_dwordx2 v[168:169], v5, s[4:7], s21 offen offset:0 sc1
  buffer_load_dwordx2 v[170:171], v5, s[4:7], s21 offen offset:512 sc1
  s_waitcnt lgkmcnt(3)
  v_mfma_f32_32x32x16_bf16 v[80:95], v[156:159], a[32:35], v[80:95]
  ds_read_b128 v[156:159], v12 offset:11264
  buffer_load_dwordx2 v[172:173], v5, s[4:7], s21 offen offset:1024 sc1
  buffer_load_dwordx2 v[174:175], v5, s[4:7], s21 offen offset:1536 sc1
  s_barrier
  s_waitcnt vmcnt(15)
  s_waitcnt lgkmcnt(3)
  v_mfma_f32_32x32x16_bf16 v[32:47], v[144:147], a[36:39], v[32:47]
  ds_read_b128 v[144:147], v10 offset:0
  buffer_load_dwordx4 a[84:87], v21, s[4:7], s23 offen offset:1024 sc1
  s_waitcnt lgkmcnt(3)
  v_mfma_f32_32x32x16_bf16 v[48:63], v[148:151], a[36:39], v[48:63]
  ds_read_b128 v[148:151], v10 offset:1024
  s_waitcnt lgkmcnt(3)
  v_mfma_f32_32x32x16_bf16 v[64:79], v[152:155], a[36:39], v[64:79]
  ds_read_b128 v[152:155], v10 offset:2048
  s_waitcnt lgkmcnt(3)
  v_mfma_f32_32x32x16_bf16 v[80:95], v[156:159], a[36:39], v[80:95]
  ds_read_b128 v[156:159], v10 offset:3072
  s_waitcnt vmcnt(15)
  s_waitcnt lgkmcnt(3)
  v_mfma_f32_32x32x16_bf16 v[32:47], v[144:147], a[40:43], v[32:47]
  ds_read_b128 v[144:147], v10 offset:4096
  buffer_load_dwordx4 a[88:91], v21, s[4:7], s23 offen offset:2048 sc1
  s_waitcnt lgkmcnt(3)
  v_mfma_f32_32x32x16_bf16 v[48:63], v[148:151], a[40:43], v[48:63]
  ds_read_b128 v[148:151], v10 offset:5120
  s_waitcnt lgkmcnt(3)
  v_mfma_f32_32x32x16_bf16 v[64:79], v[152:155], a[40:43], v[64:79]
  ds_read_b128 v[152:155], v10 offset:6144
  s_add_u32 m0, s26, 40960
  s_mov_b32 s29, 20480
  buffer_load_dwordx4 v19, s[4:7], s29 offen lds
  s_waitcnt lgkmcnt(3)
  v_mfma_f32_32x32x16_bf16 v[80:95], v[156:159], a[40:43], v[80:95]
  ds_read_b128 v[156:159], v10 offset:7168
  s_waitcnt vmcnt(16)
  s_waitcnt lgkmcnt(3)
  v_mfma_f32_32x32x16_bf16 v[32:47], v[144:147], a[44:47], v[32:47]
  ds_read_b128 v[144:147], v10 offset:8192
  buffer_load_dwordx4 a[92:95], v21, s[4:7], s23 offen offset:3072 sc1
  s_waitcnt lgkmcnt(3)
  v_mfma_f32_32x32x16_bf16 v[48:63], v[148:151], a[44:47], v[48:63]
  ds_read_b128 v[148:151], v10 offset:9216
  s_add_u32 m0, s26, 45056
  s_mov_b32 s29, 21504
  buffer_load_dwordx4 v19, s[4:7], s29 offen lds
  s_waitcnt lgkmcnt(3)
  v_mfma_f32_32x32x16_bf16 v[64:79], v[152:155], a[44:47], v[64:79]
  ds_read_b128 v[152:155], v10 offset:10240
  s_waitcnt lgkmcnt(3)
  v_mfma_f32_32x32x16_bf16 v[80:95], v[156:159], a[44:47], v[80:95]
  ds_read_b128 v[156:159], v10 offset:11264
  s_waitcnt vmcnt(17)
  s_waitcnt lgkmcnt(3)
  v_mfma_f32_32x32x16_bf16 v[32:47], v[144:147], a[48:51], v[32:47]
  ds_read_b128 v[144:147], v10 offset:12288
  s_mov_b32 s23, 24576
  buffer_load_dwordx4 a[96:99], v21, s[4:7], s23 offen offset:0 sc1
  s_waitcnt lgkmcnt(3)
  v_mfma_f32_32x32x16_bf16 v[48:63], v[148:151], a[48:51], v[48:63]
  ds_read_b128 v[148:151], v10 offset:13312
  s_waitcnt lgkmcnt(3)
  v_mfma_f32_32x32x16_bf16 v[64:79], v[152:155], a[48:51], v[64:79]
  ds_read_b128 v[152:155], v10 offset:14336
  s_waitcnt lgkmcnt(3)
  v_mfma_f32_32x32x16_bf16 v[80:95], v[156:159], a[48:51], v[80:95]
  ds_read_b128 v[156:159], v10 offset:15360
  s_add_u32 m0, s26, 49152
  s_mov_b32 s29, 22528
  buffer_load_dwordx4 v19, s[4:7], s29 offen lds
  s_waitcnt vmcnt(18)
  s_waitcnt lgkmcnt(3)
  v_mfma_f32_32x32x16_bf16 v[32:47], v[144:147], a[52:55], v[32:47]
  ds_read_b128 v[144:147], v10 offset:16384
  buffer_load_dwordx4 a[100:103], v21, s[4:7], s23 offen offset:1024 sc1
  s_waitcnt lgkmcnt(3)
  v_mfma_f32_32x32x16_bf16 v[48:63], v[148:151], a[52:55], v[48:63]
  ds_read_b128 v[148:151], v10 offset:17408
  s_waitcnt lgkmcnt(3)
  v_mfma_f32_32x32x16_bf16 v[64:79], v[152:155], a[52:55], v[64:79]
  ds_read_b128 v[152:155], v10 offset:18432
  s_add_u32 m0, s26, 53248
  s_mov_b32 s29, 23552
  buffer_load_dwordx4 v19, s[4:7], s29 offen lds
  s_waitcnt lgkmcnt(3)
  v_mfma_f32_32x32x16_bf16 v[80:95], v[156:159], a[52:55], v[80:95]
  ds_read_b128 v[156:159], v10 offset:19456
  s_barrier
  s_waitcnt vmcnt(19)
  s_waitcnt lgkmcnt(3)
  v_mfma_f32_32x32x16_bf16 v[32:47], v[144:147], a[56:59], v[32:47]
  ds_read_b128 v[144:147], v10 offset:20480
  buffer_load_dwordx4 a[104:107], v21, s[4:7], s23 offen offset:2048 sc1
  s_waitcnt lgkmcnt(3)
  v_mfma_f32_32x32x16_bf16 v[48:63], v[148:151], a[56:59], v[48:63]
  ds_read_b128 v[148:151], v10 offset:21504
  s_add_u32 m0, s26, 57344
  s_mov_b32 s29, 24576
  buffer_load_dwordx4 v19, s[4:7], s29 offen lds
  s_waitcnt lgkmcnt(3)
  v_mfma_f32_32x32x16_bf16 v[64:79], v[152:155], a[56:59], v[64:79]
  ds_read_b128 v[152:155], v10 offset:22528
  s_waitcnt lgkmcnt(3)
  v_mfma_f32_32x32x16_bf16 v[80:95], v[156:159], a[56:59], v[80:95]
  ds_read_b128 v[156:159], v10 offset:23552
  s_waitcnt vmcnt(20)
  s_waitcnt lgkmcnt(3)
  v_mfma_f32_32x32x16_bf16 v[32:47], v[144:147], a[60:63], v[32:47]
  ds_read_b128 v[144:147], v10 offset:24576
  buffer_load_dwordx4 a[108:111], v21, s[4:7], s23 offen offset:3072 sc1
  s_waitcnt lgkmcnt(3)
  v_mfma_f32_32x32x16_bf16 v[48:63], v[148:151], a[60:63], v[48:63]
  ds_read_b128 v[148:151], v10 offset:25600
  s_waitcnt lgkmcnt(3)
  v_mfma_f32_32x32x16_bf16 v[64:79], v[152:155], a[60:63], v[64:79]
  ds_read_b128 v[152:155], v10 offset:26624
  s_waitcnt lgkmcnt(3)
  v_mfma_f32_32x32x16_bf16 v[80:95], v[156:159], a[60:63], v[80:95]
  ds_read_b128 v[156:159], v10 offset:27648
  s_add_u32 m0, s26, 61440
  s_mov_b32 s29, 25600
  buffer_load_dwordx4 v19, s[4:7], s29 offen lds
  s_waitcnt vmcnt(21)
  s_waitcnt lgkmcnt(3)
  v_mfma_f32_32x32x16_bf16 v[32:47], v[144:147], a[64:67], v[32:47]
  ds_read_b128 v[144:147], v10 offset:28672
  s_mov_b32 s23, 28672
  buffer_load_dwordx4 a[112:115], v21, s[4:7], s23 offen offset:0 sc1
  s_waitcnt lgkmcnt(3)
  v_mfma_f32_32x32x16_bf16 v[48:63], v[148:151], a[64:67], v[48:63]
  ds_read_b128 v[148:151], v10 offset:29696
  s_waitcnt lgkmcnt(3)
  v_mfma_f32_32x32x16_bf16 v[64:79], v[152:155], a[64:67], v[64:79]
  ds_read_b128 v[152:155], v10 offset:30720
  s_add_u32 m0, s26, 65536
  s_mov_b32 s29, 26624
  buffer_load_dwordx4 v19, s[4:7], s29 offen lds
  s_waitcnt lgkmcnt(3)
  v_mfma_f32_32x32x16_bf16 v[80:95], v[156:159], a[64:67], v[80:95]
  ds_read_b128 v[156:159], v10 offset:31744
  s_waitcnt vmcnt(22)
  s_waitcnt lgkmcnt(3)
  v_mfma_f32_32x32x16_bf16 v[32:47], v[144:147], a[68:71], v[32:47]
  ds_read_b128 v[144:147], v10 offset:32768
  buffer_load_dwordx4 a[116:119], v21, s[4:7], s23 offen offset:1024 sc1
  s_waitcnt lgkmcnt(3)
  v_mfma_f32_32x32x16_bf16 v[48:63], v[148:151], a[68:71], v[48:63]
  ds_read_b128 v[148:151], v10 offset:33792
  s_add_u32 m0, s26, 69632
  s_mov_b32 s29, 27648
  buffer_load_dwordx4 v19, s[4:7], s29 offen lds
  s_waitcnt lgkmcnt(3)
  v_mfma_f32_32x32x16_bf16 v[64:79], v[152:155], a[68:71], v[64:79]
  ds_read_b128 v[152:155], v10 offset:34816
  s_waitcnt lgkmcnt(3)
  v_mfma_f32_32x32x16_bf16 v[80:95], v[156:159], a[68:71], v[80:95]
  ds_read_b128 v[156:159], v10 offset:35840
  s_waitcnt vmcnt(23)
  s_waitcnt lgkmcnt(3)
  v_mfma_f32_32x32x16_bf16 v[32:47], v[144:147], a[72:75], v[32:47]
  ds_read_b128 v[144:147], v10 offset:36864
  buffer_load_dwordx4 a[120:123], v21, s[4:7], s23 offen offset:2048 sc1
  s_waitcnt vmcnt(18)
  v_add_f32 v168, v168, v172
  v_add_f32 v169, v169, v173
  s_waitcnt lgkmcnt(3)
  v_mfma_f32_32x32x16_bf16 v[48:63], v[148:151], a[72:75], v[48:63]
  ds_read_b128 v[148:151], v10 offset:37888
  v_add_f32 v170, v170, v174
  v_add_f32 v171, v171, v175
  v_add_f32 v168, v168, v170
  v_add_f32 v169, v169, v171
  s_waitcnt lgkmcnt(3)
  v_mfma_f32_32x32x16_bf16 v[64:79], v[152:155], a[72:75], v[64:79]
  ds_read_b128 v[152:155], v10 offset:38912
  v_mov_b32 v170, v168
  v_mov_b32 v171, v169
  s_nop 1
  v_permlane32_swap_b32 v168, v170
  s_waitcnt lgkmcnt(3)
  v_mfma_f32_32x32x16_bf16 v[80:95], v[156:159], a[72:75], v[80:95]
  ds_read_b128 v[156:159], v10 offset:39936
  s_add_u32 m0, s26, 73728
  s_mov_b32 s29, 28672
  buffer_load_dwordx4 v19, s[4:7], s29 offen lds
  s_waitcnt vmcnt(8)
  s_barrier
  s_waitcnt lgkmcnt(3)
  v_mfma_f32_32x32x16_bf16 v[32:47], v[144:147], a[76:79], v[32:47]
  ds_read_b128 v[144:147], v10 offset:40960
  buffer_load_dwordx4 a[124:127], v21, s[4:7], s23 offen offset:3072 sc1
  v_permlane32_swap_b32 v169, v171
  v_add_f32 v168, v168, v170
  s_waitcnt lgkmcnt(3)
  v_mfma_f32_32x32x16_bf16 v[48:63], v[148:151], a[76:79], v[48:63]
  ds_read_b128 v[148:151], v10 offset:41984
  v_add_f32 v169, v169, v171
  v_mul_f32 v168, 0xbacccccd, v168
  v_mul_f32 v169, 0x3acccccd, v169
  v_fma_f32 v169, -v168, v168, v169
  s_waitcnt lgkmcnt(3)
  v_mfma_f32_32x32x16_bf16 v[64:79], v[152:155], a[76:79], v[64:79]
  ds_read_b128 v[152:155], v10 offset:43008
  s_add_u32 m0, s26, 77824
  s_mov_b32 s29, 29696
  buffer_load_dwordx4 v19, s[4:7], s29 offen lds
  s_waitcnt lgkmcnt(3)
  v_mfma_f32_32x32x16_bf16 v[80:95], v[156:159], a[76:79], v[80:95]
  ds_read_b128 v[156:159], v10 offset:44032
  v_max_f32 v169, 0, v169
  v_add_f32 v169, 0x3727c5ac, v169
  v_rsq_f32 v170, v169
  v_mov_b32 v196, v169
  s_waitcnt lgkmcnt(3)
  v_mfma_f32_32x32x16_bf16 v[32:47], v[144:147], a[80:83], v[32:47]
  ds_read_b128 v[144:147], v10 offset:45056
  s_mov_b32 s23, 32768
  buffer_load_dwordx4 a[128:131], v21, s[4:7], s23 offen offset:0 sc1
  v_mul_f32 v169, v169, v170
  v_mul_f32 v197, v197, v170
  s_waitcnt lgkmcnt(3)
  v_mfma_f32_32x32x16_bf16 v[48:63], v[148:151], a[80:83], v[48:63]
  ds_read_b128 v[148:151], v10 offset:46080
  s_add_u32 m0, s26, 81920
  s_mov_b32 s29, 30720
  buffer_load_dwordx4 v19, s[4:7], s29 offen lds
  s_waitcnt lgkmcnt(3)
  v_mfma_f32_32x32x16_bf16 v[64:79], v[152:155], a[80:83], v[64:79]
  ds_read_b128 v[152:155], v10 offset:47104
  v_mul_f32 v198, v198, v170
  v_mul_f32 v170, v170, v170
  v_mul_f32 v198, v198, v170
  v_cvt_pk_bf16_f32 v167, v168, v169
  s_waitcnt lgkmcnt(3)
  v_mfma_f32_32x32x16_bf16 v[80:95], v[156:159], a[80:83], v[80:95]
  ds_read_b128 v[156:159], v10 offset:48128
  v_lshlrev_b32 v172, 16, v167
  v_and_b32 v173, 0xffff0000, v167
  v_sub_f32 v174, v168, v172
  v_sub_f32 v175, v169, v173
  s_waitcnt lgkmcnt(3)
  v_mfma_f32_32x32x16_bf16 v[32:47], v[144:147], a[84:87], v[32:47]
  ds_read_b128 v[144:147], v10 offset:49152
  buffer_load_dwordx4 a[132:135], v21, s[4:7], s23 offen offset:1024 sc1
  v_cvt_pk_bf16_f32 v164, v172, v172
  v_cvt_pk_bf16_f32 v165, v174, v173
  s_waitcnt lgkmcnt(3)
  v_mfma_f32_32x32x16_bf16 v[48:63], v[148:151], a[84:87], v[48:63]
  ds_read_b128 v[148:151], v10 offset:50176
  v_cvt_pk_bf16_f32 v166, v173, v175
  v_mov_b32 v167, 0
  s_waitcnt lgkmcnt(3)
  v_mfma_f32_32x32x16_bf16 v[64:79], v[152:155], a[84:87], v[64:79]
  ds_read_b128 v[152:155], v10 offset:51200
  s_waitcnt lgkmcnt(3)
  v_mfma_f32_32x32x16_bf16 v[80:95], v[156:159], a[84:87], v[80:95]
  ds_read_b128 v[156:159], v10 offset:52224
  s_add_u32 m0, s26, 86016
  s_mov_b32 s29, 31744
  buffer_load_dwordx4 v19, s[4:7], s29 offen lds
  s_waitcnt lgkmcnt(3)
  v_mfma_f32_32x32x16_bf16 v[32:47], v[144:147], a[88:91], v[32:47]
  ds_read_b128 v[144:147], v10 offset:53248
  buffer_load_dwordx4 a[136:139], v21, s[4:7], s23 offen offset:2048 sc1
  s_waitcnt lgkmcnt(3)
  v_mfma_f32_32x32x16_bf16 v[48:63], v[148:151], a[88:91], v[48:63]
  ds_read_b128 v[148:151], v10 offset:54272
  s_waitcnt lgkmcnt(3)
  v_mfma_f32_32x32x16_bf16 v[64:79], v[152:155], a[88:91], v[64:79]
  ds_read_b128 v[152:155], v10 offset:55296
  s_add_u32 m0, s26, 90112
  s_mov_b32 s29, 32768
  buffer_load_dwordx4 v19, s[4:7], s29 offen lds
  s_waitcnt lgkmcnt(3)
  v_mfma_f32_32x32x16_bf16 v[80:95], v[156:159], a[88:91], v[80:95]
  ds_read_b128 v[156:159], v10 offset:56320
  s_waitcnt lgkmcnt(3)
  v_mfma_f32_32x32x16_bf16 v[32:47], v[144:147], a[92:95], v[32:47]
  ds_read_b128 v[144:147], v10 offset:57344
  buffer_load_dwordx4 a[140:143], v21, s[4:7], s23 offen offset:3072 sc1
  s_waitcnt lgkmcnt(3)
  v_mfma_f32_32x32x16_bf16 v[48:63], v[148:151], a[92:95], v[48:63]
  ds_read_b128 v[148:151], v10 offset:58368
  s_add_u32 m0, s26, 94208
  s_mov_b32 s29, 33792
  buffer_load_dwordx4 v19, s[4:7], s29 offen lds
  s_waitcnt lgkmcnt(3)
  v_mfma_f32_32x32x16_bf16 v[64:79], v[152:155], a[92:95], v[64:79]
  ds_read_b128 v[152:155], v10 offset:59392
  s_waitcnt lgkmcnt(3)
  v_mfma_f32_32x32x16_bf16 v[80:95], v[156:159], a[92:95], v[80:95]
  ds_read_b128 v[156:159], v10 offset:60416
  s_waitcnt vmcnt(8)
  s_barrier
  s_waitcnt lgkmcnt(3)
  v_mfma_f32_32x32x16_bf16 v[32:47], v[144:147], a[96:99], v[32:47]
  ds_read_b128 v[144:147], v10 offset:61440
  s_mov_b32 s23, 36864
  buffer_load_dwordx4 a[144:147], v21, s[4:7], s23 offen offset:0 sc1
  s_waitcnt lgkmcnt(3)
  v_mfma_f32_32x32x16_bf16 v[48:63], v[148:151], a[96:99], v[48:63]
  ds_read_b128 v[148:151], v10 offset:62464
  s_waitcnt lgkmcnt(3)
  v_mfma_f32_32x32x16_bf16 v[64:79], v[152:155], a[96:99], v[64:79]
  ds_read_b128 v[152:155], v10 offset:63488
  s_waitcnt lgkmcnt(3)
  v_mfma_f32_32x32x16_bf16 v[80:95], v[156:159], a[96:99], v[80:95]
  ds_read_b128 v[156:159], v10 offset:64512
  s_add_u32 m0, s26, 98304
  s_mov_b32 s29, 34816
  buffer_load_dwordx4 v19, s[4:7], s29 offen lds
  s_waitcnt lgkmcnt(3)
  v_mfma_f32_32x32x16_bf16 v[32:47], v[144:147], a[100:103], v[32:47]
  ds_read_b128 v[144:147], v11 offset:0
  buffer_load_dwordx4 a[148:151], v21, s[4:7], s23 offen offset:1024 sc1
  s_waitcnt lgkmcnt(3)
  v_mfma_f32_32x32x16_bf16 v[48:63], v[148:151], a[100:103], v[48:63]
  ds_read_b128 v[148:151], v11 offset:1024
  s_waitcnt lgkmcnt(3)
  v_mfma_f32_32x32x16_bf16 v[64:79], v[152:155], a[100:103], v[64:79]
  ds_read_b128 v[152:155], v11 offset:2048
  s_add_u32 m0, s26, 102400
  s_mov_b32 s29, 35840
  buffer_load_dwordx4 v19, s[4:7], s29 offen lds
  s_waitcnt lgkmcnt(3)
  v_mfma_f32_32x32x16_bf16 v[80:95], v[156:159], a[100:103], v[80:95]
  ds_read_b128 v[156:159], v11 offset:3072
  s_waitcnt lgkmcnt(3)
  v_mfma_f32_32x32x16_bf16 v[32:47], v[144:147], a[104:107], v[32:47]
  ds_read_b128 v[144:147], v11 offset:4096
  buffer_load_dwordx4 a[152:155], v21, s[4:7], s23 offen offset:2048 sc1
  s_waitcnt lgkmcnt(3)
  v_mfma_f32_32x32x16_bf16 v[48:63], v[148:151], a[104:107], v[48:63]
  ds_read_b128 v[148:151], v11 offset:5120
  s_add_u32 m0, s26, 106496
  s_mov_b32 s29, 36864
  buffer_load_dwordx4 v19, s[4:7], s29 offen lds
  s_waitcnt lgkmcnt(3)
  v_mfma_f32_32x32x16_bf16 v[64:79], v[152:155], a[104:107], v[64:79]
  ds_read_b128 v[152:155], v11 offset:6144
  s_waitcnt lgkmcnt(3)
  v_mfma_f32_32x32x16_bf16 v[80:95], v[156:159], a[104:107], v[80:95]
  ds_read_b128 v[156:159], v11 offset:7168
  s_waitcnt lgkmcnt(3)
  v_mfma_f32_32x32x16_bf16 v[32:47], v[144:147], a[108:111], v[32:47]
  ds_read_b128 v[144:147], v11 offset:8192
  buffer_load_dwordx4 a[156:159], v21, s[4:7], s23 offen offset:3072 sc1
  s_waitcnt lgkmcnt(3)
  v_mfma_f32_32x32x16_bf16 v[48:63], v[148:151], a[108:111], v[48:63]
  ds_read_b128 v[148:151], v11 offset:9216
  s_waitcnt lgkmcnt(3)
  v_mfma_f32_32x32x16_bf16 v[64:79], v[152:155], a[108:111], v[64:79]
  ds_read_b128 v[152:155], v11 offset:10240
  s_waitcnt lgkmcnt(3)
  v_mfma_f32_32x32x16_bf16 v[80:95], v[156:159], a[108:111], v[80:95]
  ds_read_b128 v[156:159], v11 offset:11264
  s_add_u32 m0, s26, 110592
  s_mov_b32 s29, 37888
  buffer_load_dwordx4 v19, s[4:7], s29 offen lds
  s_waitcnt lgkmcnt(3)
  v_mfma_f32_32x32x16_bf16 v[32:47], v[144:147], a[112:115], v[32:47]
  ds_read_b128 v[144:147], v11 offset:12288
  ds_read_b128 v[160:163], v199 offset:0
  s_waitcnt lgkmcnt(4)
  v_mfma_f32_32x32x16_bf16 v[48:63], v[148:151], a[112:115], v[48:63]
  ds_read_b128 v[148:151], v11 offset:13312
  s_waitcnt lgkmcnt(4)
  v_mfma_f32_32x32x16_bf16 v[64:79], v[152:155], a[112:115], v[64:79]
  ds_read_b128 v[152:155], v11 offset:14336
  s_add_u32 m0, s26, 114688
  s_mov_b32 s29, 38912
  buffer_load_dwordx4 v19, s[4:7], s29 offen lds
  s_waitcnt lgkmcnt(4)
  v_mfma_f32_32x32x16_bf16 v[80:95], v[156:159], a[112:115], v[80:95]
  ds_read_b128 v[156:159], v11 offset:15360
  s_waitcnt lgkmcnt(3)
  v_mfma_f32_32x32x16_bf16 v[32:47], v[160:163], v[164:167], v[32:47]
  s_waitcnt vmcnt(7)
  s_barrier
  v_mfma_f32_32x32x16_bf16 v[32:47], v[144:147], a[116:119], v[32:47]
  ds_read_b128 v[144:147], v11 offset:16384
  ds_read_b128 v[160:163], v199 offset:1024
  s_waitcnt lgkmcnt(4)
  v_mfma_f32_32x32x16_bf16 v[48:63], v[148:151], a[116:119], v[48:63]
  ds_read_b128 v[148:151], v11 offset:17408
  s_add_u32 m0, s26, 118784
  s_mov_b32 s29, 39936
  buffer_load_dwordx4 v19, s[4:7], s29 offen lds
  s_waitcnt lgkmcnt(4)
  v_mfma_f32_32x32x16_bf16 v[64:79], v[152:155], a[116:119], v[64:79]
  ds_read_b128 v[152:155], v11 offset:18432
  s_waitcnt lgkmcnt(4)
  v_mfma_f32_32x32x16_bf16 v[80:95], v[156:159], a[116:119], v[80:95]
  ds_read_b128 v[156:159], v11 offset:19456
  s_waitcnt lgkmcnt(3)
  v_mfma_f32_32x32x16_bf16 v[48:63], v[160:163], v[164:167], v[48:63]
  v_mfma_f32_32x32x16_bf16 v[32:47], v[144:147], a[120:123], v[32:47]
  ds_read_b128 v[144:147], v11 offset:20480
  ds_read_b128 v[160:163], v199 offset:2048
  s_add_u32 m0, s26, 122880
  s_mov_b32 s29, 163840
  buffer_load_dwordx4 v20, s[4:7], s29 offen lds
  s_waitcnt lgkmcnt(4)
  v_mfma_f32_32x32x16_bf16 v[48:63], v[148:151], a[120:123], v[48:63]
  ds_read_b128 v[148:151], v11 offset:21504
  s_waitcnt lgkmcnt(4)
  v_mfma_f32_32x32x16_bf16 v[64:79], v[152:155], a[120:123], v[64:79]
  ds_read_b128 v[152:155], v11 offset:22528
  s_waitcnt lgkmcnt(4)
  v_mfma_f32_32x32x16_bf16 v[80:95], v[156:159], a[120:123], v[80:95]
  ds_read_b128 v[156:159], v11 offset:23552
  s_waitcnt lgkmcnt(3)
  v_mfma_f32_32x32x16_bf16 v[64:79], v[160:163], v[164:167], v[64:79]
  s_add_u32 m0, s26, 126976
  s_mov_b32 s29, 167936
  buffer_load_dwordx4 v20, s[4:7], s29 offen lds
  v_mfma_f32_32x32x16_bf16 v[32:47], v[144:147], a[124:127], v[32:47]
  ds_read_b128 v[144:147], v11 offset:24576
  ds_read_b128 v[160:163], v199 offset:3072
  s_waitcnt lgkmcnt(4)
  v_mfma_f32_32x32x16_bf16 v[48:63], v[148:151], a[124:127], v[48:63]
  ds_read_b128 v[148:151], v11 offset:25600
  s_waitcnt lgkmcnt(4)
  v_mfma_f32_32x32x16_bf16 v[64:79], v[152:155], a[124:127], v[64:79]
  ds_read_b128 v[152:155], v11 offset:26624
  s_add_u32 m0, s26, 131072
  s_mov_b32 s29, 172032
  buffer_load_dwordx4 v20, s[4:7], s29 offen lds
  s_waitcnt lgkmcnt(4)
  v_mfma_f32_32x32x16_bf16 v[80:95], v[156:159], a[124:127], v[80:95]
  ds_read_b128 v[156:159], v11 offset:27648
  s_waitcnt lgkmcnt(3)
  v_mfma_f32_32x32x16_bf16 v[80:95], v[160:163], v[164:167], v[80:95]
  v_mfma_f32_32x32x16_bf16 v[32:47], v[144:147], a[128:131], v[32:47]
  ds_read_b128 v[144:147], v11 offset:28672
  s_waitcnt lgkmcnt(3)
  v_mfma_f32_32x32x16_bf16 v[48:63], v[148:151], a[128:131], v[48:63]
  ds_read_b128 v[148:151], v11 offset:29696
  s_add_u32 m0, s26, 135168
  s_mov_b32 s29, 176128
  buffer_load_dwordx4 v20, s[4:7], s29 offen lds
  s_waitcnt lgkmcnt(3)
  v_mfma_f32_32x32x16_bf16 v[64:79], v[152:155], a[128:131], v[64:79]
  ds_read_b128 v[152:155], v11 offset:30720
  s_waitcnt lgkmcnt(3)
  v_mfma_f32_32x32x16_bf16 v[80:95], v[156:159], a[128:131], v[80:95]
  ds_read_b128 v[156:159], v11 offset:31744
  s_waitcnt lgkmcnt(3)
  v_mfma_f32_32x32x16_bf16 v[32:47], v[144:147], a[132:135], v[32:47]
  ds_read_b128 v[144:147], v11 offset:32768
  s_add_u32 m0, s26, 139264
  s_mov_b32 s29, 180224
  buffer_load_dwordx4 v20, s[4:7], s29 offen lds
  s_waitcnt lgkmcnt(3)
  v_mfma_f32_32x32x16_bf16 v[48:63], v[148:151], a[132:135], v[48:63]
  ds_read_b128 v[148:151], v11 offset:33792
  s_waitcnt lgkmcnt(3)
  v_mfma_f32_32x32x16_bf16 v[64:79], v[152:155], a[132:135], v[64:79]
  ds_read_b128 v[152:155], v11 offset:34816
  s_waitcnt lgkmcnt(3)
  v_mfma_f32_32x32x16_bf16 v[80:95], v[156:159], a[132:135], v[80:95]
  ds_read_b128 v[156:159], v11 offset:35840
  s_add_u32 m0, s26, 0
  s_mov_b32 s29, 184320
  buffer_load_dwordx4 v20, s[4:7], s29 offen lds
  s_waitcnt vmcnt(6)
  s_barrier
  s_waitcnt lgkmcnt(3)
  v_mfma_f32_32x32x16_bf16 v[32:47], v[144:147], a[136:139], v[32:47]
  ds_read_b128 v[144:147], v11 offset:36864
  s_waitcnt lgkmcnt(3)
  v_mfma_f32_32x32x16_bf16 v[48:63], v[148:151], a[136:139], v[48:63]
  ds_read_b128 v[148:151], v11 offset:37888
  s_waitcnt lgkmcnt(3)
  v_mfma_f32_32x32x16_bf16 v[64:79], v[152:155], a[136:139], v[64:79]
  ds_read_b128 v[152:155], v11 offset:38912
  s_add_u32 m0, s26, 4096
  s_mov_b32 s29, 188416
  buffer_load_dwordx4 v20, s[4:7], s29 offen lds
  s_waitcnt lgkmcnt(3)
  v_mfma_f32_32x32x16_bf16 v[80:95], v[156:159], a[136:139], v[80:95]
  ds_read_b128 v[156:159], v11 offset:39936
  s_waitcnt lgkmcnt(3)
  v_mfma_f32_32x32x16_bf16 v[32:47], v[144:147], a[140:143], v[32:47]
  ds_read_b128 v[144:147], v11 offset:40960
  s_waitcnt lgkmcnt(3)
  v_mfma_f32_32x32x16_bf16 v[48:63], v[148:151], a[140:143], v[48:63]
  ds_read_b128 v[148:151], v11 offset:41984
  s_add_u32 m0, s26, 8192
  s_mov_b32 s29, 192512
  buffer_load_dwordx4 v20, s[4:7], s29 offen lds
  s_waitcnt lgkmcnt(3)
  v_mfma_f32_32x32x16_bf16 v[64:79], v[152:155], a[140:143], v[64:79]
  ds_read_b128 v[152:155], v11 offset:43008
  s_waitcnt lgkmcnt(3)
  v_mfma_f32_32x32x16_bf16 v[80:95], v[156:159], a[140:143], v[80:95]
  ds_read_b128 v[156:159], v11 offset:44032
  s_waitcnt lgkmcnt(3)
  v_mfma_f32_32x32x16_bf16 v[32:47], v[144:147], a[144:147], v[32:47]
  ds_read_b128 v[144:147], v11 offset:45056
  s_add_u32 m0, s26, 12288
  s_mov_b32 s29, 196608
  buffer_load_dwordx4 v20, s[4:7], s29 offen lds
  s_waitcnt lgkmcnt(3)
  v_mfma_f32_32x32x16_bf16 v[48:63], v[148:151], a[144:147], v[48:63]
  ds_read_b128 v[148:151], v11 offset:46080
  s_waitcnt lgkmcnt(3)
  v_mfma_f32_32x32x16_bf16 v[64:79], v[152:155], a[144:147], v[64:79]
  ds_read_b128 v[152:155], v11 offset:47104
  s_waitcnt lgkmcnt(3)
  v_mfma_f32_32x32x16_bf16 v[80:95], v[156:159], a[144:147], v[80:95]
  ds_read_b128 v[156:159], v11 offset:48128
  s_add_u32 m0, s26, 16384
  s_mov_b32 s29, 200704
  buffer_load_dwordx4 v20, s[4:7], s29 offen lds
  s_waitcnt lgkmcnt(3)
  v_mfma_f32_32x32x16_bf16 v[32:47], v[144:147], a[148:151], v[32:47]
  ds_read_b128 v[144:147], v11 offset:49152
  s_waitcnt lgkmcnt(3)
  v_mfma_f32_32x32x16_bf16 v[48:63], v[148:151], a[148:151], v[48:63]
  ds_read_b128 v[148:151], v11 offset:50176
  s_waitcnt lgkmcnt(3)
  v_mfma_f32_32x32x16_bf16 v[64:79], v[152:155], a[148:151], v[64:79]
  ds_read_b128 v[152:155], v11 offset:51200
  s_add_u32 m0, s26, 20480
  s_mov_b32 s29, 204800
  buffer_load_dwordx4 v20, s[4:7], s29 offen lds
  s_waitcnt lgkmcnt(3)
  v_mfma_f32_32x32x16_bf16 v[80:95], v[156:159], a[148:151], v[80:95]
  ds_read_b128 v[156:159], v11 offset:52224
  s_waitcnt lgkmcnt(3)
  v_mfma_f32_32x32x16_bf16 v[32:47], v[144:147], a[152:155], v[32:47]
  ds_read_b128 v[144:147], v11 offset:53248
  s_waitcnt lgkmcnt(3)
  v_mfma_f32_32x32x16_bf16 v[48:63], v[148:151], a[152:155], v[48:63]
  ds_read_b128 v[148:151], v11 offset:54272
  s_add_u32 m0, s26, 24576
  s_mov_b32 s29, 208896
  buffer_load_dwordx4 v20, s[4:7], s29 offen lds
  s_waitcnt lgkmcnt(3)
  v_mfma_f32_32x32x16_bf16 v[64:79], v[152:155], a[152:155], v[64:79]
  ds_read_b128 v[152:155], v11 offset:55296
  s_waitcnt lgkmcnt(3)
  v_mfma_f32_32x32x16_bf16 v[80:95], v[156:159], a[152:155], v[80:95]
  ds_read_b128 v[156:159], v11 offset:56320
  s_waitcnt vmcnt(7)
  s_barrier
  s_waitcnt lgkmcnt(3)
  v_mfma_f32_32x32x16_bf16 v[32:47], v[144:147], a[156:159], v[32:47]
  ds_read_b128 v[144:147], v11 offset:57344
  s_add_u32 m0, s26, 28672
  s_mov_b32 s29, 212992
  buffer_load_dwordx4 v20, s[4:7], s29 offen lds
  s_waitcnt lgkmcnt(3)
  v_mfma_f32_32x32x16_bf16 v[48:63], v[148:151], a[156:159], v[48:63]
  ds_read_b128 v[148:151], v11 offset:58368
  s_waitcnt lgkmcnt(3)
  v_mfma_f32_32x32x16_bf16 v[64:79], v[152:155], a[156:159], v[64:79]
  ds_read_b128 v[152:155], v11 offset:59392
  s_waitcnt lgkmcnt(3)
  v_mfma_f32_32x32x16_bf16 v[80:95], v[156:159], a[156:159], v[80:95]
  ds_read_b128 v[156:159], v11 offset:60416
  s_add_u32 m0, s26, 32768
  s_mov_b32 s29, 217088
  buffer_load_dwordx4 v20, s[4:7], s29 offen lds
  s_waitcnt lgkmcnt(3)
  v_mfma_f32_32x32x16_bf16 v[96:111], v[144:147], a[0:3], 0
  ds_read_b128 v[144:147], v11 offset:61440
  s_waitcnt lgkmcnt(3)
  v_mfma_f32_32x32x16_bf16 v[96:111], v[148:151], a[4:7], v[96:111]
  ds_read_b128 v[148:151], v11 offset:62464
  v_mul_f32 v168, v32, v32
  v_mul_f32 v169, v33, v33
  v_mul_f32 v170, v34, v34
  v_mul_f32 v171, v35, v35
  s_waitcnt lgkmcnt(3)
  v_mfma_f32_32x32x16_bf16 v[96:111], v[152:155], a[8:11], v[96:111]
  ds_read_b128 v[152:155], v11 offset:63488
  s_add_u32 m0, s26, 36864
  s_mov_b32 s29, 221184
  buffer_load_dwordx4 v20, s[4:7], s29 offen lds
  s_waitcnt lgkmcnt(3)
  v_mfma_f32_32x32x16_bf16 v[96:111], v[156:159], a[12:15], v[96:111]
  ds_read_b128 v[156:159], v11 offset:64512
  v_mul_f32 v172, v36, v36
  v_mul_f32 v173, v37, v37
  v_mul_f32 v174, v38, v38
  v_mul_f32 v175, v39, v39
  s_waitcnt lgkmcnt(3)
  v_mfma_f32_32x32x16_bf16 v[96:111], v[144:147], a[16:19], v[96:111]
  ds_read_b128 v[144:147], v12 offset:0
  v_fma_f32 v168, v168, v198, v197
  v_fma_f32 v169, v169, v198, v197
  v_fma_f32 v170, v170, v198, v197
  v_fma_f32 v171, v171, v198, v197
  s_waitcnt lgkmcnt(3)
  v_mfma_f32_32x32x16_bf16 v[96:111], v[148:151], a[20:23], v[96:111]
  ds_read_b128 v[148:151], v12 offset:1024
  s_add_u32 m0, s26, 40960
  s_mov_b32 s29, 225280
  buffer_load_dwordx4 v20, s[4:7], s29 offen lds
  s_waitcnt lgkmcnt(3)
  v_mfma_f32_32x32x16_bf16 v[96:111], v[152:155], a[24:27], v[96:111]
  ds_read_b128 v[152:155], v12 offset:2048
  v_fma_f32 v172, v172, v198, v197
  v_fma_f32 v173, v173, v198, v197
  v_fma_f32 v174, v174, v198, v197
  v_fma_f32 v175, v175, v198, v197
  s_waitcnt lgkmcnt(3)
  v_mfma_f32_32x32x16_bf16 v[96:111], v[156:159], a[28:31], v[96:111]
  ds_read_b128 v[156:159], v12 offset:3072
  v_mul_f32 v168, v168, v32
  v_mul_f32 v169, v169, v33
  v_mul_f32 v170, v170, v34
  v_mul_f32 v171, v171, v35
  s_waitcnt lgkmcnt(3)
  v_mfma_f32_32x32x16_bf16 v[96:111], v[144:147], a[32:35], v[96:111]
  ds_read_b128 v[144:147], v12 offset:4096
  s_add_u32 m0, s26, 45056
  s_mov_b32 s29, 229376
  buffer_load_dwordx4 v20, s[4:7], s29 offen lds
  s_waitcnt lgkmcnt(3)
  v_mfma_f32_32x32x16_bf16 v[96:111], v[148:151], a[36:39], v[96:111]
  ds_read_b128 v[148:151], v12 offset:5120
  v_mul_f32 v172, v172, v36
  v_mul_f32 v173, v173, v37
  v_mul_f32 v174, v174, v38
  v_mul_f32 v175, v175, v39
  s_waitcnt lgkmcnt(3)
  v_mfma_f32_32x32x16_bf16 v[96:111], v[152:155], a[40:43], v[96:111]
  ds_read_b128 v[152:155], v12 offset:6144
  v_exp_f32 v168, v168
  v_exp_f32 v169, v169
  s_waitcnt lgkmcnt(3)
  v_mfma_f32_32x32x16_bf16 v[96:111], v[156:159], a[44:47], v[96:111]
  ds_read_b128 v[156:159], v12 offset:7168
  s_add_u32 m0, s26, 49152
  s_mov_b32 s29, 233472
  buffer_load_dwordx4 v20, s[4:7], s29 offen lds
  s_waitcnt lgkmcnt(3)
  v_mfma_f32_32x32x16_bf16 v[96:111], v[144:147], a[48:51], v[96:111]
  ds_read_b128 v[144:147], v12 offset:8192
  v_exp_f32 v170, v170
  v_exp_f32 v171, v171
  s_waitcnt lgkmcnt(3)
  v_mfma_f32_32x32x16_bf16 v[96:111], v[148:151], a[52:55], v[96:111]
  ds_read_b128 v[148:151], v12 offset:9216
  v_exp_f32 v172, v172
  v_exp_f32 v173, v173
  s_waitcnt lgkmcnt(3)
  v_mfma_f32_32x32x16_bf16 v[96:111], v[152:155], a[56:59], v[96:111]
  ds_read_b128 v[152:155], v12 offset:10240
  s_add_u32 m0, s26, 53248
  s_mov_b32 s29, 237568
  buffer_load_dwordx4 v20, s[4:7], s29 offen lds
  s_waitcnt lgkmcnt(3)
  v_mfma_f32_32x32x16_bf16 v[96:111], v[156:159], a[60:63], v[96:111]
  ds_read_b128 v[156:159], v12 offset:11264
  v_exp_f32 v174, v174
  v_exp_f32 v175, v175
  s_waitcnt vmcnt(9)
  s_barrier
  s_waitcnt lgkmcnt(3)
  v_mfma_f32_32x32x16_bf16 v[96:111], v[144:147], a[64:67], v[96:111]
  ds_read_b128 v[144:147], v10 offset:0
  v_mul_f32 v184, v32, v40
  v_mul_f32 v185, v33, v41
  v_mul_f32 v186, v34, v42
  v_mul_f32 v187, v35, v43
  s_waitcnt lgkmcnt(3)
  v_mfma_f32_32x32x16_bf16 v[96:111], v[148:151], a[68:71], v[96:111]
  ds_read_b128 v[148:151], v10 offset:1024
  s_add_u32 m0, s26, 57344
  s_mov_b32 s29, 241664
  buffer_load_dwordx4 v20, s[4:7], s29 offen lds
  s_waitcnt lgkmcnt(3)
  v_mfma_f32_32x32x16_bf16 v[96:111], v[152:155], a[72:75], v[96:111]
  ds_read_b128 v[152:155], v10 offset:2048
  v_mul_f32 v188, v36, v44
  v_mul_f32 v189, v37, v45
  v_mul_f32 v190, v38, v46
  v_mul_f32 v191, v39, v47
  s_waitcnt lgkmcnt(3)
  v_mfma_f32_32x32x16_bf16 v[96:111], v[156:159], a[76:79], v[96:111]
  ds_read_b128 v[156:159], v10 offset:3072
  v_fma_f32 v168, v168, v196, v196
  v_fma_f32 v169, v169, v196, v196
  v_fma_f32 v170, v170, v196, v196
  v_fma_f32 v171, v171, v196, v196
  s_waitcnt lgkmcnt(3)
  v_mfma_f32_32x32x16_bf16 v[96:111], v[144:147], a[80:83], v[96:111]
  ds_read_b128 v[144:147], v10 offset:4096
  s_add_u32 m0, s26, 61440
  s_mov_b32 s29, 245760
  buffer_load_dwordx4 v20, s[4:7], s29 offen lds
  s_waitcnt lgkmcnt(3)
  v_mfma_f32_32x32x16_bf16 v[96:111], v[148:151], a[84:87], v[96:111]
  ds_read_b128 v[148:151], v10 offset:5120
  v_fma_f32 v172, v172, v196, v196
  v_fma_f32 v173, v173, v196, v196
  v_fma_f32 v174, v174, v196, v196
  v_fma_f32 v175, v175, v196, v196
  s_waitcnt lgkmcnt(3)
  v_mfma_f32_32x32x16_bf16 v[96:111], v[152:155], a[88:91], v[96:111]
  ds_read_b128 v[152:155], v10 offset:6144
  v_rcp_f32 v168, v168
  v_rcp_f32 v169, v169
  s_waitcnt lgkmcnt(3)
  v_mfma_f32_32x32x16_bf16 v[96:111], v[156:159], a[92:95], v[96:111]
  ds_read_b128 v[156:159], v10 offset:7168
  s_add_u32 m0, s26, 65536
  s_mov_b32 s29, 249856
  buffer_load_dwordx4 v20, s[4:7], s29 offen lds
  s_waitcnt lgkmcnt(3)
  v_mfma_f32_32x32x16_bf16 v[96:111], v[144:147], a[96:99], v[96:111]
  ds_read_b128 v[144:147], v10 offset:8192
  v_rcp_f32 v170, v170
  v_rcp_f32 v171, v171
  s_waitcnt lgkmcnt(3)
  v_mfma_f32_32x32x16_bf16 v[96:111], v[148:151], a[100:103], v[96:111]
  ds_read_b128 v[148:151], v10 offset:9216
  v_rcp_f32 v172, v172
  v_rcp_f32 v173, v173
  s_waitcnt lgkmcnt(3)
  v_mfma_f32_32x32x16_bf16 v[96:111], v[152:155], a[104:107], v[96:111]
  ds_read_b128 v[152:155], v10 offset:10240
  s_add_u32 m0, s26, 69632
  s_mov_b32 s29, 253952
  buffer_load_dwordx4 v20, s[4:7], s29 offen lds
  s_waitcnt lgkmcnt(3)
  v_mfma_f32_32x32x16_bf16 v[96:111], v[156:159], a[108:111], v[96:111]
  ds_read_b128 v[156:159], v10 offset:11264
  v_rcp_f32 v174, v174
  v_rcp_f32 v175, v175
  s_waitcnt lgkmcnt(3)
  v_mfma_f32_32x32x16_bf16 v[96:111], v[144:147], a[112:115], v[96:111]
  ds_read_b128 v[144:147], v10 offset:12288
  s_add_u32 s22, s30, 0
  v_mul_f32 v168, v168, v184
  v_mul_f32 v169, v169, v185
  v_mul_f32 v170, v170, v186
  s_waitcnt lgkmcnt(3)
  v_mfma_f32_32x32x16_bf16 v[96:111], v[148:151], a[116:119], v[96:111]
  ds_read_b128 v[148:151], v10 offset:13312
  s_add_u32 m0, s26, 73728
  s_mov_b32 s29, 258048
  buffer_load_dwordx4 v20, s[4:7], s29 offen lds
  s_waitcnt lgkmcnt(3)
  v_mfma_f32_32x32x16_bf16 v[96:111], v[152:155], a[120:123], v[96:111]
  ds_read_b128 v[152:155], v10 offset:14336
  v_mul_f32 v171, v171, v187
  v_mul_f32 v172, v172, v188
  v_mul_f32 v173, v173, v189
  v_mul_f32 v174, v174, v190
  s_waitcnt lgkmcnt(3)
  v_mfma_f32_32x32x16_bf16 v[96:111], v[156:159], a[124:127], v[96:111]
  ds_read_b128 v[156:159], v10 offset:15360
  v_mul_f32 v175, v175, v191
  v_cvt_pk_bf16_f32 v192, v168, v169
  v_cvt_pk_bf16_f32 v193, v170, v171
  v_cvt_pk_bf16_f32 v194, v172, v173
  s_waitcnt lgkmcnt(3)
  v_mfma_f32_32x32x16_bf16 v[96:111], v[144:147], a[128:131], v[96:111]
  ds_read_b128 v[144:147], v10 offset:16384
  s_add_u32 m0, s26, 77824
  s_mov_b32 s29, 262144
  buffer_load_dwordx4 v20, s[4:7], s29 offen lds
  s_waitcnt lgkmcnt(3)
  v_mfma_f32_32x32x16_bf16 v[96:111], v[148:151], a[132:135], v[96:111]
  ds_read_b128 v[148:151], v10 offset:17408
  v_cvt_pk_bf16_f32 v195, v174, v175
  buffer_store_dwordx4 v[192:195], v10, s[4:7], s22 offen sc1
  v_mul_f32 v168, v48, v48
  v_mul_f32 v169, v49, v49
  s_waitcnt lgkmcnt(3)
  v_mfma_f32_32x32x16_bf16 v[96:111], v[152:155], a[136:139], v[96:111]
  ds_read_b128 v[152:155], v10 offset:18432
  v_mul_f32 v170, v50, v50
  v_mul_f32 v171, v51, v51
  v_mul_f32 v172, v52, v52
  v_mul_f32 v173, v53, v53
  s_waitcnt lgkmcnt(3)
  v_mfma_f32_32x32x16_bf16 v[96:111], v[156:159], a[140:143], v[96:111]
  ds_read_b128 v[156:159], v10 offset:19456
  s_add_u32 m0, s26, 81920
  s_mov_b32 s29, 266240
  buffer_load_dwordx4 v20, s[4:7], s29 offen lds
  s_waitcnt vmcnt(12)
  s_barrier
  s_waitcnt lgkmcnt(3)
  v_mfma_f32_32x32x16_bf16 v[96:111], v[144:147], a[144:147], v[96:111]
  ds_read_b128 v[144:147], v10 offset:20480
  v_mul_f32 v174, v54, v54
  v_mul_f32 v175, v55, v55
  v_fma_f32 v168, v168, v198, v197
  v_fma_f32 v169, v169, v198, v197
  s_waitcnt lgkmcnt(3)
  v_mfma_f32_32x32x16_bf16 v[96:111], v[148:151], a[148:151], v[96:111]
  ds_read_b128 v[148:151], v10 offset:21504
  v_fma_f32 v170, v170, v198, v197
  v_fma_f32 v171, v171, v198, v197
  v_fma_f32 v172, v172, v198, v197
  v_fma_f32 v173, v173, v198, v197
  ds_read_b128 v[160:163], v199 offset:4096
  s_waitcnt lgkmcnt(4)
  v_mfma_f32_32x32x16_bf16 v[96:111], v[152:155], a[152:155], v[96:111]
  ds_read_b128 v[152:155], v10 offset:22528
  s_add_u32 m0, s26, 86016
  s_mov_b32 s29, 270336
  buffer_load_dwordx4 v20, s[4:7], s29 offen lds
  s_waitcnt lgkmcnt(4)
  v_mfma_f32_32x32x16_bf16 v[96:111], v[156:159], a[156:159], v[96:111]
  ds_read_b128 v[156:159], v10 offset:23552
  s_waitcnt lgkmcnt(2)
  v_mfma_f32_32x32x16_bf16 v[96:111], v[160:163], v[164:167], v[96:111]
  v_fma_f32 v174, v174, v198, v197
  v_fma_f32 v175, v175, v198, v197
  v_mul_f32 v168, v168, v48
  v_mul_f32 v169, v169, v49
  v_mfma_f32_32x32x16_bf16 v[112:127], v[144:147], a[0:3], 0
  ds_read_b128 v[144:147], v10 offset:24576
  v_mul_f32 v170, v170, v50
  v_mul_f32 v171, v171, v51
  v_mul_f32 v172, v172, v52
  v_mul_f32 v173, v173, v53
  v_mfma_f32_32x32x16_bf16 v[112:127], v[148:151], a[4:7], v[112:127]
  ds_read_b128 v[148:151], v10 offset:25600
  s_add_u32 m0, s26, 90112
  s_mov_b32 s29, 274432
  buffer_load_dwordx4 v20, s[4:7], s29 offen lds
  s_waitcnt lgkmcnt(3)
  v_mfma_f32_32x32x16_bf16 v[112:127], v[152:155], a[8:11], v[112:127]
  ds_read_b128 v[152:155], v10 offset:26624
  v_mul_f32 v174, v174, v54
  v_mul_f32 v175, v175, v55
  v_exp_f32 v168, v168
  s_waitcnt lgkmcnt(3)
  v_mfma_f32_32x32x16_bf16 v[112:127], v[156:159], a[12:15], v[112:127]
  ds_read_b128 v[156:159], v10 offset:27648
  v_exp_f32 v169, v169
  v_exp_f32 v170, v170
  s_waitcnt lgkmcnt(3)
  v_mfma_f32_32x32x16_bf16 v[112:127], v[144:147], a[16:19], v[112:127]
  ds_read_b128 v[144:147], v10 offset:28672
  s_add_u32 m0, s26, 94208
  s_mov_b32 s29, 278528
  buffer_load_dwordx4 v20, s[4:7], s29 offen lds
  s_waitcnt lgkmcnt(3)
  v_mfma_f32_32x32x16_bf16 v[112:127], v[148:151], a[20:23], v[112:127]
  ds_read_b128 v[148:151], v10 offset:29696
  v_exp_f32 v171, v171
  v_exp_f32 v172, v172
  s_waitcnt lgkmcnt(3)
  v_mfma_f32_32x32x16_bf16 v[112:127], v[152:155], a[24:27], v[112:127]
  ds_read_b128 v[152:155], v10 offset:30720
  v_exp_f32 v173, v173
  v_exp_f32 v174, v174
  s_waitcnt lgkmcnt(3)
  v_mfma_f32_32x32x16_bf16 v[112:127], v[156:159], a[28:31], v[112:127]
  ds_read_b128 v[156:159], v10 offset:31744
  s_add_u32 m0, s26, 98304
  s_mov_b32 s29, 282624
  buffer_load_dwordx4 v20, s[4:7], s29 offen lds
  s_waitcnt lgkmcnt(3)
  v_mfma_f32_32x32x16_bf16 v[112:127], v[144:147], a[32:35], v[112:127]
  ds_read_b128 v[144:147], v10 offset:32768
  v_exp_f32 v175, v175
  v_mul_f32 v184, v48, v56
  v_mul_f32 v185, v49, v57
  s_waitcnt lgkmcnt(3)
  v_mfma_f32_32x32x16_bf16 v[112:127], v[148:151], a[36:39], v[112:127]
  ds_read_b128 v[148:151], v10 offset:33792
  v_mul_f32 v186, v50, v58
  v_mul_f32 v187, v51, v59
  v_mul_f32 v188, v52, v60
  v_mul_f32 v189, v53, v61
  s_waitcnt lgkmcnt(3)
  v_mfma_f32_32x32x16_bf16 v[112:127], v[152:155], a[40:43], v[112:127]
  ds_read_b128 v[152:155], v10 offset:34816
  v_add_u32 v14, 0, v10
  v_add_u32 v15, 55296, v10
  v_add_u32 v16, 110592, v10
  s_waitcnt lgkmcnt(3)
  v_mfma_f32_32x32x16_bf16 v[112:127], v[156:159], a[44:47], v[112:127]
  ds_read_b128 v[156:159], v10 offset:35840
  v_mul_f32 v190, v54, v62
  v_mul_f32 v191, v55, v63
  v_fma_f32 v168, v168, v196, v196
  v_fma_f32 v169, v169, v196, v196
  s_waitcnt lgkmcnt(3)
  v_mfma_f32_32x32x16_bf16 v[112:127], v[144:147], a[48:51], v[112:127]
  ds_read_b128 v[144:147], v10 offset:36864
  v_fma_f32 v170, v170, v196, v196
  v_fma_f32 v171, v171, v196, v196
  v_fma_f32 v172, v172, v196, v196
  v_fma_f32 v173, v173, v196, v196
  s_waitcnt lgkmcnt(3)
  v_mfma_f32_32x32x16_bf16 v[112:127], v[148:151], a[52:55], v[112:127]
  ds_read_b128 v[148:151], v10 offset:37888
  v_add_u32 v17, 165888, v10
  v_add_u32 v18, 221184, v10
  s_mul_i32 s24, s20, 276480
  s_waitcnt lgkmcnt(3)
  v_mfma_f32_32x32x16_bf16 v[112:127], v[152:155], a[56:59], v[112:127]
  ds_read_b128 v[152:155], v10 offset:38912
  v_fma_f32 v174, v174, v196, v196
  v_fma_f32 v175, v175, v196, v196
  v_rcp_f32 v168, v168
  s_waitcnt lgkmcnt(3)
  v_mfma_f32_32x32x16_bf16 v[112:127], v[156:159], a[60:63], v[112:127]
  ds_read_b128 v[156:159], v10 offset:39936
  v_rcp_f32 v169, v169
  v_rcp_f32 v170, v170
  s_waitcnt vmcnt(11)
  s_barrier
  s_waitcnt lgkmcnt(3)
  v_mfma_f32_32x32x16_bf16 v[112:127], v[144:147], a[64:67], v[112:127]
  ds_read_b128 v[144:147], v10 offset:40960
  s_lshl_b32 s21, s16, 10
  s_add_u32 s24, s24, s21
  s_add_u32 s24, s24, 20865024
  s_waitcnt lgkmcnt(3)
  v_mfma_f32_32x32x16_bf16 v[112:127], v[148:151], a[68:71], v[112:127]
  ds_read_b128 v[148:151], v10 offset:41984
  v_rcp_f32 v171, v171
  v_rcp_f32 v172, v172
  s_waitcnt lgkmcnt(3)
  v_mfma_f32_32x32x16_bf16 v[112:127], v[152:155], a[72:75], v[112:127]
  ds_read_b128 v[152:155], v10 offset:43008
  v_rcp_f32 v173, v173
  v_rcp_f32 v174, v174
  s_waitcnt lgkmcnt(3)
  v_mfma_f32_32x32x16_bf16 v[112:127], v[156:159], a[76:79], v[112:127]
  ds_read_b128 v[156:159], v10 offset:44032
  s_add_u32 m0, s25, 102400
  s_nop 0
  buffer_load_dwordx4 v14, s[4:7], s24 offen lds
  s_waitcnt lgkmcnt(3)
  v_mfma_f32_32x32x16_bf16 v[112:127], v[144:147], a[80:83], v[112:127]
  ds_read_b128 v[144:147], v10 offset:45056
  v_rcp_f32 v175, v175
  s_add_u32 s22, s30, 1024
  v_mul_f32 v168, v168, v184
  s_waitcnt lgkmcnt(3)
  v_mfma_f32_32x32x16_bf16 v[112:127], v[148:151], a[84:87], v[112:127]
  ds_read_b128 v[148:151], v10 offset:46080
  v_mul_f32 v169, v169, v185
  v_mul_f32 v170, v170, v186
  v_mul_f32 v171, v171, v187
  v_mul_f32 v172, v172, v188
  s_waitcnt lgkmcnt(3)
  v_mfma_f32_32x32x16_bf16 v[112:127], v[152:155], a[88:91], v[112:127]
  ds_read_b128 v[152:155], v10 offset:47104
  s_add_u32 m0, s25, 103424
  s_nop 0
  buffer_load_dwordx4 v15, s[4:7], s24 offen lds
  s_waitcnt lgkmcnt(3)
  v_mfma_f32_32x32x16_bf16 v[112:127], v[156:159], a[92:95], v[112:127]
  ds_read_b128 v[156:159], v10 offset:48128
  v_mul_f32 v173, v173, v189
  v_mul_f32 v174, v174, v190
  v_mul_f32 v175, v175, v191
  v_cvt_pk_bf16_f32 v192, v168, v169
  s_waitcnt lgkmcnt(3)
  v_mfma_f32_32x32x16_bf16 v[112:127], v[144:147], a[96:99], v[112:127]
  ds_read_b128 v[144:147], v10 offset:49152
  v_cvt_pk_bf16_f32 v193, v170, v171
  v_cvt_pk_bf16_f32 v194, v172, v173
  v_cvt_pk_bf16_f32 v195, v174, v175
  buffer_store_dwordx4 v[192:195], v10, s[4:7], s22 offen sc1
  s_waitcnt lgkmcnt(3)
  v_mfma_f32_32x32x16_bf16 v[112:127], v[148:151], a[100:103], v[112:127]
  ds_read_b128 v[148:151], v10 offset:50176
  s_add_u32 m0, s25, 104448
  s_nop 0
  buffer_load_dwordx4 v16, s[4:7], s24 offen lds
  s_waitcnt lgkmcnt(3)
  v_mfma_f32_32x32x16_bf16 v[112:127], v[152:155], a[104:107], v[112:127]
  ds_read_b128 v[152:155], v10 offset:51200
  v_mul_f32 v168, v64, v64
  v_mul_f32 v169, v65, v65
  v_mul_f32 v170, v66, v66
  v_mul_f32 v171, v67, v67
  s_waitcnt lgkmcnt(3)
  v_mfma_f32_32x32x16_bf16 v[112:127], v[156:159], a[108:111], v[112:127]
  ds_read_b128 v[156:159], v10 offset:52224
  v_mul_f32 v172, v68, v68
  v_mul_f32 v173, v69, v69
  v_mul_f32 v174, v70, v70
  v_mul_f32 v175, v71, v71
  s_waitcnt lgkmcnt(3)
  v_mfma_f32_32x32x16_bf16 v[112:127], v[144:147], a[112:115], v[112:127]
  ds_read_b128 v[144:147], v10 offset:53248
  s_add_u32 m0, s25, 105472
  s_nop 0
  buffer_load_dwordx4 v17, s[4:7], s24 offen lds
  s_waitcnt lgkmcnt(3)
  v_mfma_f32_32x32x16_bf16 v[112:127], v[148:151], a[116:119], v[112:127]
  ds_read_b128 v[148:151], v10 offset:54272
  v_fma_f32 v168, v168, v198, v197
  v_fma_f32 v169, v169, v198, v197
  v_fma_f32 v170, v170, v198, v197
  v_fma_f32 v171, v171, v198, v197
  s_waitcnt lgkmcnt(3)
  v_mfma_f32_32x32x16_bf16 v[112:127], v[152:155], a[120:123], v[112:127]
  ds_read_b128 v[152:155], v10 offset:55296
  v_fma_f32 v172, v172, v198, v197
  v_fma_f32 v173, v173, v198, v197
  v_fma_f32 v174, v174, v198, v197
  v_fma_f32 v175, v175, v198, v197
  s_waitcnt lgkmcnt(3)
  v_mfma_f32_32x32x16_bf16 v[112:127], v[156:159], a[124:127], v[112:127]
  ds_read_b128 v[156:159], v10 offset:56320
  s_add_u32 m0, s25, 106496
  s_nop 0
  buffer_load_dwordx4 v18, s[4:7], s24 offen lds
  s_waitcnt lgkmcnt(3)
  v_mfma_f32_32x32x16_bf16 v[112:127], v[144:147], a[128:131], v[112:127]
  ds_read_b128 v[144:147], v10 offset:57344
  v_mul_f32 v168, v168, v64
  v_mul_f32 v169, v169, v65
  v_mul_f32 v170, v170, v66
  v_mul_f32 v171, v171, v67
  s_waitcnt lgkmcnt(3)
  v_mfma_f32_32x32x16_bf16 v[112:127], v[148:151], a[132:135], v[112:127]
  ds_read_b128 v[148:151], v10 offset:58368
  v_mul_f32 v172, v172, v68
  v_mul_f32 v173, v173, v69
  v_mul_f32 v174, v174, v70
  v_mul_f32 v175, v175, v71
  s_waitcnt lgkmcnt(3)
  v_mfma_f32_32x32x16_bf16 v[112:127], v[152:155], a[136:139], v[112:127]
  ds_read_b128 v[152:155], v10 offset:59392
  s_add_u32 s24, s24, 4096
  s_add_u32 m0, s25, 122880
  s_nop 0
  s_waitcnt lgkmcnt(3)
  v_mfma_f32_32x32x16_bf16 v[112:127], v[156:159], a[140:143], v[112:127]
  ds_read_b128 v[156:159], v10 offset:60416
  v_exp_f32 v168, v168
  v_exp_f32 v169, v169
  s_waitcnt vmcnt(12)
  s_barrier
  s_waitcnt lgkmcnt(3)
  v_mfma_f32_32x32x16_bf16 v[112:127], v[144:147], a[144:147], v[112:127]
  ds_read_b128 v[144:147], v10 offset:61440
  v_exp_f32 v170, v170
  v_exp_f32 v171, v171
  s_waitcnt lgkmcnt(3)
  v_mfma_f32_32x32x16_bf16 v[112:127], v[148:151], a[148:151], v[112:127]
  ds_read_b128 v[148:151], v10 offset:62464
  buffer_load_dwordx4 v14, s[4:7], s24 offen lds
  s_add_u32 m0, s25, 123904
  s_nop 0
  ds_read_b128 v[160:163], v199 offset:5120
  s_waitcnt lgkmcnt(4)
  v_mfma_f32_32x32x16_bf16 v[112:127], v[152:155], a[152:155], v[112:127]
  ds_read_b128 v[152:155], v10 offset:63488
  v_exp_f32 v172, v172
  v_exp_f32 v173, v173
  s_waitcnt lgkmcnt(4)
  v_mfma_f32_32x32x16_bf16 v[112:127], v[156:159], a[156:159], v[112:127]
  ds_read_b128 v[156:159], v10 offset:64512
  s_waitcnt lgkmcnt(2)
  v_mfma_f32_32x32x16_bf16 v[112:127], v[160:163], v[164:167], v[112:127]
  v_exp_f32 v174, v174
  v_exp_f32 v175, v175
  v_mfma_f32_32x32x16_bf16 v[128:143], v[144:147], a[0:3], 0
  ds_read_b128 v[144:147], v11 offset:0
  buffer_load_dwordx4 v15, s[4:7], s24 offen lds
  s_add_u32 m0, s25, 124928
  s_nop 0
  v_mfma_f32_32x32x16_bf16 v[128:143], v[148:151], a[4:7], v[128:143]
  ds_read_b128 v[148:151], v11 offset:1024
  v_mul_f32 v184, v64, v72
  v_mul_f32 v185, v65, v73
  v_mul_f32 v186, v66, v74
  v_mul_f32 v187, v67, v75
  s_waitcnt lgkmcnt(3)
  v_mfma_f32_32x32x16_bf16 v[128:143], v[152:155], a[8:11], v[128:143]
  ds_read_b128 v[152:155], v11 offset:2048
  v_mul_f32 v188, v68, v76
  v_mul_f32 v189, v69, v77
  v_mul_f32 v190, v70, v78
  v_mul_f32 v191, v71, v79
  s_waitcnt lgkmcnt(3)
  v_mfma_f32_32x32x16_bf16 v[128:143], v[156:159], a[12:15], v[128:143]
  ds_read_b128 v[156:159], v11 offset:3072
  buffer_load_dwordx4 v16, s[4:7], s24 offen lds
  s_add_u32 m0, s25, 125952
  s_nop 0
  s_waitcnt lgkmcnt(3)
  v_mfma_f32_32x32x16_bf16 v[128:143], v[144:147], a[16:19], v[128:143]
  ds_read_b128 v[144:147], v11 offset:4096
  v_fma_f32 v168, v168, v196, v196
  v_fma_f32 v169, v169, v196, v196
  v_fma_f32 v170, v170, v196, v196
  v_fma_f32 v171, v171, v196, v196
  s_waitcnt lgkmcnt(3)
  v_mfma_f32_32x32x16_bf16 v[128:143], v[148:151], a[20:23], v[128:143]
  ds_read_b128 v[148:151], v11 offset:5120
  v_fma_f32 v172, v172, v196, v196
  v_fma_f32 v173, v173, v196, v196
  v_fma_f32 v174, v174, v196, v196
  v_fma_f32 v175, v175, v196, v196
  s_waitcnt lgkmcnt(3)
  v_mfma_f32_32x32x16_bf16 v[128:143], v[152:155], a[24:27], v[128:143]
  ds_read_b128 v[152:155], v11 offset:6144
  buffer_load_dwordx4 v17, s[4:7], s24 offen lds
  s_add_u32 m0, s25, 126976
  s_nop 0
  s_waitcnt lgkmcnt(3)
  v_mfma_f32_32x32x16_bf16 v[128:143], v[156:159], a[28:31], v[128:143]
  ds_read_b128 v[156:159], v11 offset:7168
  v_rcp_f32 v168, v168
  v_rcp_f32 v169, v169
  s_waitcnt lgkmcnt(3)
  v_mfma_f32_32x32x16_bf16 v[128:143], v[144:147], a[32:35], v[128:143]
  ds_read_b128 v[144:147], v11 offset:8192
  v_rcp_f32 v170, v170
  v_rcp_f32 v171, v171
  s_waitcnt lgkmcnt(3)
  v_mfma_f32_32x32x16_bf16 v[128:143], v[148:151], a[36:39], v[128:143]
  ds_read_b128 v[148:151], v11 offset:9216
  buffer_load_dwordx4 v18, s[4:7], s24 offen lds
  s_add_u32 s24, s24, 4096
  s_add_u32 m0, s25, 0
  s_waitcnt lgkmcnt(3)
  v_mfma_f32_32x32x16_bf16 v[128:143], v[152:155], a[40:43], v[128:143]
  ds_read_b128 v[152:155], v11 offset:10240
  v_rcp_f32 v172, v172
  v_rcp_f32 v173, v173
  s_waitcnt lgkmcnt(3)
  v_mfma_f32_32x32x16_bf16 v[128:143], v[156:159], a[44:47], v[128:143]
  ds_read_b128 v[156:159], v11 offset:11264
  v_rcp_f32 v174, v174
  v_rcp_f32 v175, v175
  s_waitcnt lgkmcnt(3)
  v_mfma_f32_32x32x16_bf16 v[128:143], v[144:147], a[48:51], v[128:143]
  ds_read_b128 v[144:147], v11 offset:12288
  s_nop 0
  buffer_load_dwordx4 v14, s[4:7], s24 offen lds
  s_add_u32 m0, s25, 1024
  s_waitcnt lgkmcnt(3)
  v_mfma_f32_32x32x16_bf16 v[128:143], v[148:151], a[52:55], v[128:143]
  ds_read_b128 v[148:151], v11 offset:13312
  s_add_u32 s22, s30, 2048
  v_mul_f32 v168, v168, v184
  v_mul_f32 v169, v169, v185
  v_mul_f32 v170, v170, v186
  s_waitcnt lgkmcnt(3)
  v_mfma_f32_32x32x16_bf16 v[128:143], v[152:155], a[56:59], v[128:143]
  ds_read_b128 v[152:155], v11 offset:14336
  v_mul_f32 v171, v171, v187
  v_mul_f32 v172, v172, v188
  v_mul_f32 v173, v173, v189
  v_mul_f32 v174, v174, v190
  s_waitcnt lgkmcnt(3)
  v_mfma_f32_32x32x16_bf16 v[128:143], v[156:159], a[60:63], v[128:143]
  ds_read_b128 v[156:159], v11 offset:15360
  s_nop 0
  buffer_load_dwordx4 v15, s[4:7], s24 offen lds
  s_add_u32 m0, s25, 2048
  s_waitcnt vmcnt(13)
  s_barrier
  s_waitcnt lgkmcnt(3)
  v_mfma_f32_32x32x16_bf16 v[128:143], v[144:147], a[64:67], v[128:143]
  ds_read_b128 v[144:147], v11 offset:16384
  v_mul_f32 v175, v175, v191
  v_cvt_pk_bf16_f32 v192, v168, v169
  v_cvt_pk_bf16_f32 v193, v170, v171
  v_cvt_pk_bf16_f32 v194, v172, v173
  s_waitcnt lgkmcnt(3)
  v_mfma_f32_32x32x16_bf16 v[128:143], v[148:151], a[68:71], v[128:143]
  ds_read_b128 v[148:151], v11 offset:17408
  v_cvt_pk_bf16_f32 v195, v174, v175
  buffer_store_dwordx4 v[192:195], v10, s[4:7], s22 offen sc1
  v_mul_f32 v168, v80, v80
  v_mul_f32 v169, v81, v81
  s_waitcnt lgkmcnt(3)
  v_mfma_f32_32x32x16_bf16 v[128:143], v[152:155], a[72:75], v[128:143]
  ds_read_b128 v[152:155], v11 offset:18432
  s_nop 0
  buffer_load_dwordx4 v16, s[4:7], s24 offen lds
  s_add_u32 m0, s25, 3072
  s_waitcnt lgkmcnt(3)
  v_mfma_f32_32x32x16_bf16 v[128:143], v[156:159], a[76:79], v[128:143]
  ds_read_b128 v[156:159], v11 offset:19456
  v_mul_f32 v170, v82, v82
  v_mul_f32 v171, v83, v83
  v_mul_f32 v172, v84, v84
  v_mul_f32 v173, v85, v85
  s_waitcnt lgkmcnt(3)
  v_mfma_f32_32x32x16_bf16 v[128:143], v[144:147], a[80:83], v[128:143]
  ds_read_b128 v[144:147], v11 offset:20480
  v_mul_f32 v174, v86, v86
  v_mul_f32 v175, v87, v87
  v_fma_f32 v168, v168, v198, v197
  v_fma_f32 v169, v169, v198, v197
  s_waitcnt lgkmcnt(3)
  v_mfma_f32_32x32x16_bf16 v[128:143], v[148:151], a[84:87], v[128:143]
  ds_read_b128 v[148:151], v11 offset:21504
  s_nop 0
  buffer_load_dwordx4 v17, s[4:7], s24 offen lds
  s_add_u32 m0, s25, 4096
  s_waitcnt lgkmcnt(3)
  v_mfma_f32_32x32x16_bf16 v[128:143], v[152:155], a[88:91], v[128:143]
  ds_read_b128 v[152:155], v11 offset:22528
  v_fma_f32 v170, v170, v198, v197
  v_fma_f32 v171, v171, v198, v197
  v_fma_f32 v172, v172, v198, v197
  v_fma_f32 v173, v173, v198, v197
  s_waitcnt lgkmcnt(3)
  v_mfma_f32_32x32x16_bf16 v[128:143], v[156:159], a[92:95], v[128:143]
  ds_read_b128 v[156:159], v11 offset:23552
  v_fma_f32 v174, v174, v198, v197
  v_fma_f32 v175, v175, v198, v197
  v_mul_f32 v168, v168, v80
  v_mul_f32 v169, v169, v81
  s_waitcnt lgkmcnt(3)
  v_mfma_f32_32x32x16_bf16 v[128:143], v[144:147], a[96:99], v[128:143]
  ds_read_b128 v[144:147], v11 offset:24576
  s_nop 0
  buffer_load_dwordx4 v18, s[4:7], s24 offen lds
  s_add_u32 s24, s24, 4096
  s_waitcnt lgkmcnt(3)
  v_mfma_f32_32x32x16_bf16 v[128:143], v[148:151], a[100:103], v[128:143]
  ds_read_b128 v[148:151], v11 offset:25600
  v_mul_f32 v170, v170, v82
  v_mul_f32 v171, v171, v83
  v_mul_f32 v172, v172, v84
  v_mul_f32 v173, v173, v85
  s_waitcnt lgkmcnt(3)
  v_mfma_f32_32x32x16_bf16 v[128:143], v[152:155], a[104:107], v[128:143]
  ds_read_b128 v[152:155], v11 offset:26624
  v_mul_f32 v174, v174, v86
  v_mul_f32 v175, v175, v87
  v_exp_f32 v168, v168
  s_waitcnt lgkmcnt(3)
  v_mfma_f32_32x32x16_bf16 v[128:143], v[156:159], a[108:111], v[128:143]
  ds_read_b128 v[156:159], v11 offset:27648
  s_add_u32 m0, s25, 20480
  s_nop 0
  buffer_load_dwordx4 v14, s[4:7], s24 offen lds
  s_waitcnt lgkmcnt(3)
  v_mfma_f32_32x32x16_bf16 v[128:143], v[144:147], a[112:115], v[128:143]
  ds_read_b128 v[144:147], v11 offset:28672
  v_exp_f32 v169, v169
  v_exp_f32 v170, v170
  s_waitcnt lgkmcnt(3)
  v_mfma_f32_32x32x16_bf16 v[128:143], v[148:151], a[116:119], v[128:143]
  ds_read_b128 v[148:151], v11 offset:29696
  v_exp_f32 v171, v171
  v_exp_f32 v172, v172
  s_waitcnt lgkmcnt(3)
  v_mfma_f32_32x32x16_bf16 v[128:143], v[152:155], a[120:123], v[128:143]
  ds_read_b128 v[152:155], v11 offset:30720
  s_add_u32 m0, s25, 21504
  s_nop 0
  buffer_load_dwordx4 v15, s[4:7], s24 offen lds
  s_waitcnt lgkmcnt(3)
  v_mfma_f32_32x32x16_bf16 v[128:143], v[156:159], a[124:127], v[128:143]
  ds_read_b128 v[156:159], v11 offset:31744
  v_exp_f32 v173, v173
  v_exp_f32 v174, v174
  s_waitcnt lgkmcnt(3)
  v_mfma_f32_32x32x16_bf16 v[128:143], v[144:147], a[128:131], v[128:143]
  ds_read_b128 v[144:147], v11 offset:32768
  v_exp_f32 v175, v175
  v_mul_f32 v184, v80, v88
  v_mul_f32 v185, v81, v89
  s_waitcnt lgkmcnt(3)
  v_mfma_f32_32x32x16_bf16 v[128:143], v[148:151], a[132:135], v[128:143]
  ds_read_b128 v[148:151], v11 offset:33792
  s_add_u32 m0, s25, 22528
  s_nop 0
  buffer_load_dwordx4 v16, s[4:7], s24 offen lds
  s_waitcnt lgkmcnt(3)
  v_mfma_f32_32x32x16_bf16 v[128:143], v[152:155], a[136:139], v[128:143]
  ds_read_b128 v[152:155], v11 offset:34816
  v_mul_f32 v186, v82, v90
  v_mul_f32 v187, v83, v91
  v_mul_f32 v188, v84, v92
  v_mul_f32 v189, v85, v93
  s_waitcnt lgkmcnt(3)
  v_mfma_f32_32x32x16_bf16 v[128:143], v[156:159], a[140:143], v[128:143]
  ds_read_b128 v[156:159], v11 offset:35840
  v_mul_f32 v190, v86, v94
  v_mul_f32 v191, v87, v95
  v_fma_f32 v168, v168, v196, v196
  v_fma_f32 v169, v169, v196, v196
  s_barrier
  s_waitcnt lgkmcnt(3)
  v_mfma_f32_32x32x16_bf16 v[128:143], v[144:147], a[144:147], v[128:143]
  s_add_u32 m0, s25, 23552
  s_nop 0
  buffer_load_dwordx4 v17, s[4:7], s24 offen lds
  s_waitcnt lgkmcnt(2)
  v_mfma_f32_32x32x16_bf16 v[128:143], v[148:151], a[148:151], v[128:143]
  v_fma_f32 v170, v170, v196, v196
  v_fma_f32 v171, v171, v196, v196
  v_fma_f32 v172, v172, v196, v196
  v_fma_f32 v173, v173, v196, v196
  ds_read_b128 v[160:163], v199 offset:6144
  s_waitcnt lgkmcnt(2)
  v_mfma_f32_32x32x16_bf16 v[128:143], v[152:155], a[152:155], v[128:143]
  v_fma_f32 v174, v174, v196, v196
  v_fma_f32 v175, v175, v196, v196
  v_rcp_f32 v168, v168
  s_waitcnt lgkmcnt(1)
  v_mfma_f32_32x32x16_bf16 v[128:143], v[156:159], a[156:159], v[128:143]
  s_waitcnt lgkmcnt(0)
  v_mfma_f32_32x32x16_bf16 v[128:143], v[160:163], v[164:167], v[128:143]
  s_add_u32 m0, s25, 24576
  s_nop 0
  buffer_load_dwordx4 v18, s[4:7], s24 offen lds
  v_rcp_f32 v169, v169
  v_rcp_f32 v170, v170
  v_rcp_f32 v171, v171
  v_rcp_f32 v172, v172
  v_rcp_f32 v173, v173
  v_rcp_f32 v174, v174
  v_rcp_f32 v175, v175
  s_add_u32 s22, s30, 3072
  v_mul_f32 v168, v168, v184
  v_mul_f32 v169, v169, v185
  v_mul_f32 v170, v170, v186
  v_mul_f32 v171, v171, v187
  v_mul_f32 v172, v172, v188
  v_mul_f32 v173, v173, v189
  v_mul_f32 v174, v174, v190
  v_mul_f32 v175, v175, v191
  v_cvt_pk_bf16_f32 v192, v168, v169
  v_cvt_pk_bf16_f32 v193, v170, v171
  v_cvt_pk_bf16_f32 v194, v172, v173
  v_cvt_pk_bf16_f32 v195, v174, v175
  buffer_store_dwordx4 v[192:195], v10, s[4:7], s22 offen sc1
  v_mul_f32 v168, v96, v96
  v_mul_f32 v169, v97, v97
  v_mul_f32 v170, v98, v98
  v_mul_f32 v171, v99, v99
  v_mul_f32 v172, v100, v100
  v_mul_f32 v173, v101, v101
  v_mul_f32 v174, v102, v102
  v_mul_f32 v175, v103, v103
  v_fma_f32 v168, v168, v198, v197
  v_fma_f32 v169, v169, v198, v197
  v_fma_f32 v170, v170, v198, v197
  v_fma_f32 v171, v171, v198, v197
  v_fma_f32 v172, v172, v198, v197
  v_fma_f32 v173, v173, v198, v197
  v_fma_f32 v174, v174, v198, v197
  v_fma_f32 v175, v175, v198, v197
  v_mul_f32 v168, v168, v96
  v_mul_f32 v169, v169, v97
  v_mul_f32 v170, v170, v98
  v_mul_f32 v171, v171, v99
  v_mul_f32 v172, v172, v100
  v_mul_f32 v173, v173, v101
  v_mul_f32 v174, v174, v102
  v_mul_f32 v175, v175, v103
  v_exp_f32 v168, v168
  v_exp_f32 v169, v169
  v_exp_f32 v170, v170
  v_exp_f32 v171, v171
  v_exp_f32 v172, v172
  v_exp_f32 v173, v173
  v_exp_f32 v174, v174
  v_exp_f32 v175, v175
  v_mul_f32 v184, v96, v104
  v_mul_f32 v185, v97, v105
  v_mul_f32 v186, v98, v106
  v_mul_f32 v187, v99, v107
  v_mul_f32 v188, v100, v108
  v_mul_f32 v189, v101, v109
  v_mul_f32 v190, v102, v110
  v_mul_f32 v191, v103, v111
  v_fma_f32 v168, v168, v196, v196
  v_fma_f32 v169, v169, v196, v196
  v_fma_f32 v170, v170, v196, v196
  v_fma_f32 v171, v171, v196, v196
  v_fma_f32 v172, v172, v196, v196
  v_fma_f32 v173, v173, v196, v196
  v_fma_f32 v174, v174, v196, v196
  v_fma_f32 v175, v175, v196, v196
  v_rcp_f32 v168, v168
  v_rcp_f32 v169, v169
  v_rcp_f32 v170, v170
  v_rcp_f32 v171, v171
  v_rcp_f32 v172, v172
  v_rcp_f32 v173, v173
  v_rcp_f32 v174, v174
  v_rcp_f32 v175, v175
  s_add_u32 s22, s30, 4096
  v_mul_f32 v168, v168, v184
  v_mul_f32 v169, v169, v185
  v_mul_f32 v170, v170, v186
  v_mul_f32 v171, v171, v187
  v_mul_f32 v172, v172, v188
  v_mul_f32 v173, v173, v189
  v_mul_f32 v174, v174, v190
  v_mul_f32 v175, v175, v191
  v_cvt_pk_bf16_f32 v192, v168, v169
  v_cvt_pk_bf16_f32 v193, v170, v171
  v_cvt_pk_bf16_f32 v194, v172, v173
  v_cvt_pk_bf16_f32 v195, v174, v175
  buffer_store_dwordx4 v[192:195], v10, s[4:7], s22 offen sc1
  v_mul_f32 v168, v112, v112
  v_mul_f32 v169, v113, v113
  v_mul_f32 v170, v114, v114
  v_mul_f32 v171, v115, v115
  v_mul_f32 v172, v116, v116
  v_mul_f32 v173, v117, v117
  v_mul_f32 v174, v118, v118
  v_mul_f32 v175, v119, v119
  v_fma_f32 v168, v168, v198, v197
  v_fma_f32 v169, v169, v198, v197
  v_fma_f32 v170, v170, v198, v197
  v_fma_f32 v171, v171, v198, v197
  v_fma_f32 v172, v172, v198, v197
  v_fma_f32 v173, v173, v198, v197
  v_fma_f32 v174, v174, v198, v197
  v_fma_f32 v175, v175, v198, v197
  v_mul_f32 v168, v168, v112
  v_mul_f32 v169, v169, v113
  v_mul_f32 v170, v170, v114
  v_mul_f32 v171, v171, v115
  v_mul_f32 v172, v172, v116
  v_mul_f32 v173, v173, v117
  v_mul_f32 v174, v174, v118
  v_mul_f32 v175, v175, v119
  v_exp_f32 v168, v168
  v_exp_f32 v169, v169
  v_exp_f32 v170, v170
  v_exp_f32 v171, v171
  v_exp_f32 v172, v172
  v_exp_f32 v173, v173
  v_exp_f32 v174, v174
  v_exp_f32 v175, v175
  v_mul_f32 v184, v112, v120
  v_mul_f32 v185, v113, v121
  v_mul_f32 v186, v114, v122
  v_mul_f32 v187, v115, v123
  v_mul_f32 v188, v116, v124
  v_mul_f32 v189, v117, v125
  v_mul_f32 v190, v118, v126
  v_mul_f32 v191, v119, v127
  v_fma_f32 v168, v168, v196, v196
  v_fma_f32 v169, v169, v196, v196
  v_fma_f32 v170, v170, v196, v196
  v_fma_f32 v171, v171, v196, v196
  v_fma_f32 v172, v172, v196, v196
  v_fma_f32 v173, v173, v196, v196
  v_fma_f32 v174, v174, v196, v196
  v_fma_f32 v175, v175, v196, v196
  v_rcp_f32 v168, v168
  v_rcp_f32 v169, v169
  v_rcp_f32 v170, v170
  v_rcp_f32 v171, v171
  v_rcp_f32 v172, v172
  v_rcp_f32 v173, v173
  v_rcp_f32 v174, v174
  v_rcp_f32 v175, v175
  s_add_u32 s22, s30, 5120
  v_mul_f32 v168, v168, v184
  v_mul_f32 v169, v169, v185
  v_mul_f32 v170, v170, v186
  v_mul_f32 v171, v171, v187
  v_mul_f32 v172, v172, v188
  v_mul_f32 v173, v173, v189
  v_mul_f32 v174, v174, v190
  v_mul_f32 v175, v175, v191
  v_cvt_pk_bf16_f32 v192, v168, v169
  v_cvt_pk_bf16_f32 v193, v170, v171
  v_cvt_pk_bf16_f32 v194, v172, v173
  v_cvt_pk_bf16_f32 v195, v174, v175
  buffer_store_dwordx4 v[192:195], v10, s[4:7], s22 offen sc1
  s_nop 11
  v_mul_f32 v168, v128, v128
  v_mul_f32 v169, v129, v129
  v_mul_f32 v170, v130, v130
  v_mul_f32 v171, v131, v131
  v_mul_f32 v172, v132, v132
  v_mul_f32 v173, v133, v133
  v_mul_f32 v174, v134, v134
  v_mul_f32 v175, v135, v135
  v_fma_f32 v168, v168, v198, v197
  v_fma_f32 v169, v169, v198, v197
  v_fma_f32 v170, v170, v198, v197
  v_fma_f32 v171, v171, v198, v197
  v_fma_f32 v172, v172, v198, v197
  v_fma_f32 v173, v173, v198, v197
  v_fma_f32 v174, v174, v198, v197
  v_fma_f32 v175, v175, v198, v197
  v_mul_f32 v168, v168, v128
  v_mul_f32 v169, v169, v129
  v_mul_f32 v170, v170, v130
  v_mul_f32 v171, v171, v131
  v_mul_f32 v172, v172, v132
  v_mul_f32 v173, v173, v133
  v_mul_f32 v174, v174, v134
  v_mul_f32 v175, v175, v135
  v_exp_f32 v168, v168
  v_exp_f32 v169, v169
  v_exp_f32 v170, v170
  v_exp_f32 v171, v171
  v_exp_f32 v172, v172
  v_exp_f32 v173, v173
  v_exp_f32 v174, v174
  v_exp_f32 v175, v175
  v_mul_f32 v184, v128, v136
  v_mul_f32 v185, v129, v137
  v_mul_f32 v186, v130, v138
  v_mul_f32 v187, v131, v139
  v_mul_f32 v188, v132, v140
  v_mul_f32 v189, v133, v141
  v_mul_f32 v190, v134, v142
  v_mul_f32 v191, v135, v143
  v_fma_f32 v168, v168, v196, v196
  v_fma_f32 v169, v169, v196, v196
  v_fma_f32 v170, v170, v196, v196
  v_fma_f32 v171, v171, v196, v196
  v_fma_f32 v172, v172, v196, v196
  v_fma_f32 v173, v173, v196, v196
  v_fma_f32 v174, v174, v196, v196
  v_fma_f32 v175, v175, v196, v196
  v_rcp_f32 v168, v168
  v_rcp_f32 v169, v169
  v_rcp_f32 v170, v170
  v_rcp_f32 v171, v171
  v_rcp_f32 v172, v172
  v_rcp_f32 v173, v173
  v_rcp_f32 v174, v174
  v_rcp_f32 v175, v175
  s_add_u32 s22, s30, 6144
  v_mul_f32 v168, v168, v184
  v_mul_f32 v169, v169, v185
  v_mul_f32 v170, v170, v186
  v_mul_f32 v171, v171, v187
  v_mul_f32 v172, v172, v188
  v_mul_f32 v173, v173, v189
  v_mul_f32 v174, v174, v190
  v_mul_f32 v175, v175, v191
  v_cvt_pk_bf16_f32 v192, v168, v169
  v_cvt_pk_bf16_f32 v193, v170, v171
  v_cvt_pk_bf16_f32 v194, v172, v173
  v_cvt_pk_bf16_f32 v195, v174, v175
  buffer_store_dwordx4 v[192:195], v10, s[4:7], s22 offen sc1
  s_add_u32 s24, s24, 4096
  s_add_u32 m0, s25, 40960
  s_nop 0
  buffer_load_dwordx4 v14, s[4:7], s24 offen lds
  s_add_u32 m0, s25, 41984
  s_nop 0
  buffer_load_dwordx4 v15, s[4:7], s24 offen lds
  s_add_u32 m0, s25, 43008
  s_nop 0
  buffer_load_dwordx4 v16, s[4:7], s24 offen lds
  s_add_u32 m0, s25, 44032
  s_nop 0
  buffer_load_dwordx4 v17, s[4:7], s24 offen lds
  s_add_u32 m0, s25, 45056
  s_nop 0
  buffer_load_dwordx4 v18, s[4:7], s24 offen lds
  s_add_u32 s24, s24, 4096
  s_add_u32 m0, s25, 61440
  s_nop 0
  buffer_load_dwordx4 v14, s[4:7], s24 offen lds
  s_add_u32 m0, s25, 62464
  s_nop 0
  buffer_load_dwordx4 v15, s[4:7], s24 offen lds
  s_add_u32 m0, s25, 63488
  s_nop 0
  buffer_load_dwordx4 v16, s[4:7], s24 offen lds
  s_add_u32 m0, s25, 64512
  s_nop 0
  buffer_load_dwordx4 v17, s[4:7], s24 offen lds
  s_add_u32 m0, s25, 65536
  s_nop 0
  buffer_load_dwordx4 v18, s[4:7], s24 offen lds
  s_add_u32 s24, s24, 4096
  s_waitcnt vmcnt(10)
  s_barrier
  s_lshl_b32 s22, s17, 8
  s_add_u32 s22, s22, 35926016
  v_mov_b32 v5, 0
  s_cmp_lg_u32 s16, 0
  s_cbranch_scc1 k456_kernel_arr6
  v_mov_b32 v8, 1
  s_mov_b64 exec, 1
  buffer_atomic_add v8, v5, s[4:7], s22 offen sc1
  s_mov_b64 exec, -1
k456_kernel_arr6:
  s_add_u32 m0, s25, 81920
  s_nop 0
  buffer_load_dwordx4 v14, s[4:7], s24 offen lds
  s_add_u32 m0, s25, 82944
  s_nop 0
  buffer_load_dwordx4 v15, s[4:7], s24 offen lds
  s_add_u32 m0, s25, 83968
  s_nop 0
  buffer_load_dwordx4 v16, s[4:7], s24 offen lds
  s_add_u32 m0, s25, 84992
  s_nop 0
  buffer_load_dwordx4 v17, s[4:7], s24 offen lds
  s_add_u32 m0, s25, 86016
  s_nop 0
  buffer_load_dwordx4 v18, s[4:7], s24 offen lds
  s_add_u32 s24, s24, 4096
  s_cmp_lg_u32 s16, 0
  s_cbranch_scc1 k456_kernel_got8
  s_mov_b32 s29, 0
k456_kernel_poll7:
  buffer_load_dword v8, v5, s[4:7], s22 offen sc1
  s_add_u32 s29, s29, 1
  s_cmp_gt_u32 s29, 0x80000
  s_cbranch_scc1 k456_kernel_got8
  s_waitcnt vmcnt(0)
  v_readfirstlane_b32 s21, v8
  s_cmp_lt_u32 s21, 16
  s_cbranch_scc1 k456_kernel_poll7
k456_kernel_got8:
  s_barrier
  s_mul_i32 s23, s27, 110592
  s_and_b32 s21, s16, 1
  s_lshl_b32 s21, s21, 8
  s_add_u32 s23, s23, s21
  s_add_u32 s23, s23, 28561408
  buffer_load_dwordx4 a[0:3], v6, s[4:7], s23 offen offset:0 sc1
  buffer_load_dwordx4 a[4:7], v6, s[4:7], s23 offen offset:2048 sc1
  s_add_u32 s23, s23, 4096
  buffer_load_dwordx4 a[8:11], v6, s[4:7], s23 offen offset:0 sc1
  buffer_load_dwordx4 a[12:15], v6, s[4:7], s23 offen offset:2048 sc1
  s_add_u32 s23, s23, 4096
  buffer_load_dwordx4 a[16:19], v6, s[4:7], s23 offen offset:0 sc1
  buffer_load_dwordx4 a[20:23], v6, s[4:7], s23 offen offset:2048 sc1
  s_add_u32 s23, s23, 4096
  buffer_load_dwordx4 a[24:27], v6, s[4:7], s23 offen offset:0 sc1
  buffer_load_dwordx4 a[28:31], v6, s[4:7], s23 offen offset:2048 sc1
  s_add_u32 s23, s23, 4096
  s_lshl_b32 s21, s19, 2
  s_add_u32 s21, s21, s16
  s_mul_i32 s21, s21, 20480
  s_mul_i32 s22, s20, 160
  s_add_u32 s21, s21, s22
  v_mul_u32_u24 v8, 1280, v3
  v_lshl_add_u32 v8, v4, 3, v8
  v_add_u32 v8, s21, v8
  s_waitcnt vmcnt(4)
  s_barrier
  ds_read_b128 v[32:35], v11 offset:36864
  ds_read_b128 v[36:39], v11 offset:37888
  ds_read_b128 v[40:43], v11 offset:38912
  ds_read_b128 v[44:47], v11 offset:39936
  ds_read_b128 v[48:51], v11 offset:40960
  s_waitcnt lgkmcnt(4)
  v_mfma_f32_16x16x32_bf16 v[72:75], v[32:35], a[0:3], 0
  ds_read_b128 v[52:55], v11 offset:41984
  buffer_load_dwordx4 a[32:35], v6, s[4:7], s23 offen offset:0 sc1
  buffer_load_dwordx4 a[36:39], v6, s[4:7], s23 offen offset:2048 sc1
  s_waitcnt lgkmcnt(4)
  v_mfma_f32_16x16x32_bf16 v[76:79], v[36:39], a[0:3], 0
  ds_read_b128 v[56:59], v11 offset:43008
  s_add_u32 s23, s23, 4096
  buffer_load_dwordx4 a[40:43], v6, s[4:7], s23 offen offset:0 sc1
  s_waitcnt lgkmcnt(4)
  v_mfma_f32_16x16x32_bf16 v[80:83], v[40:43], a[0:3], 0
  ds_read_b128 v[60:63], v11 offset:44032
  buffer_load_dwordx4 a[44:47], v6, s[4:7], s23 offen offset:2048 sc1
  s_add_u32 s23, s23, 4096
  s_waitcnt lgkmcnt(4)
  v_mfma_f32_16x16x32_bf16 v[84:87], v[44:47], a[0:3], 0
  ds_read_b128 v[64:67], v11 offset:45056
  buffer_load_dwordx4 a[48:51], v6, s[4:7], s23 offen offset:0 sc1
  buffer_load_dwordx4 a[52:55], v6, s[4:7], s23 offen offset:2048 sc1
  s_waitcnt lgkmcnt(4)
  v_mfma_f32_16x16x32_bf16 v[88:91], v[48:51], a[0:3], 0
  ds_read_b128 v[68:71], v11 offset:46080
  s_add_u32 s23, s23, 4096
  buffer_load_dwordx4 a[56:59], v6, s[4:7], s23 offen offset:0 sc1
  s_waitcnt lgkmcnt(4)
  v_mfma_f32_16x16x32_bf16 v[72:75], v[52:55], a[4:7], v[72:75]
  ds_read_b128 v[32:35], v11 offset:47104
  buffer_load_dwordx4 a[60:63], v6, s[4:7], s23 offen offset:2048 sc1
  s_add_u32 s23, s23, 4096
  s_waitcnt lgkmcnt(4)
  v_mfma_f32_16x16x32_bf16 v[76:79], v[56:59], a[4:7], v[76:79]
  ds_read_b128 v[36:39], v11 offset:48128
  s_waitcnt lgkmcnt(4)
  v_mfma_f32_16x16x32_bf16 v[80:83], v[60:63], a[4:7], v[80:83]
  ds_read_b128 v[40:43], v11 offset:49152
  s_waitcnt lgkmcnt(4)
  v_mfma_f32_16x16x32_bf16 v[84:87], v[64:67], a[4:7], v[84:87]
  ds_read_b128 v[44:47], v11 offset:50176
  s_waitcnt lgkmcnt(4)
  v_mfma_f32_16x16x32_bf16 v[88:91], v[68:71], a[4:7], v[88:91]
  ds_read_b128 v[48:51], v11 offset:51200
  s_waitcnt lgkmcnt(4)
  v_mfma_f32_16x16x32_bf16 v[72:75], v[32:35], a[8:11], v[72:75]
  ds_read_b128 v[52:55], v11 offset:52224
  s_waitcnt lgkmcnt(4)
  v_mfma_f32_16x16x32_bf16 v[76:79], v[36:39], a[8:11], v[76:79]
  ds_read_b128 v[56:59], v11 offset:53248
  s_waitcnt lgkmcnt(4)
  v_mfma_f32_16x16x32_bf16 v[80:83], v[40:43], a[8:11], v[80:83]
  ds_read_b128 v[60:63], v11 offset:54272
  s_waitcnt lgkmcnt(4)
  v_mfma_f32_16x16x32_bf16 v[84:87], v[44:47], a[8:11], v[84:87]
  ds_read_b128 v[64:67], v11 offset:55296
  s_waitcnt lgkmcnt(4)
  v_mfma_f32_16x16x32_bf16 v[88:91], v[48:51], a[8:11], v[88:91]
  ds_read_b128 v[68:71], v11 offset:56320
  s_waitcnt vmcnt(8)
  s_waitcnt lgkmcnt(0)
  s_barrier
  v_mfma_f32_16x16x32_bf16 v[72:75], v[52:55], a[12:15], v[72:75]
  ds_read_b128 v[32:35], v11 offset:57344
  v_mfma_f32_16x16x32_bf16 v[76:79], v[56:59], a[12:15], v[76:79]
  ds_read_b128 v[36:39], v11 offset:58368
  v_mfma_f32_16x16x32_bf16 v[80:83], v[60:63], a[12:15], v[80:83]
  ds_read_b128 v[40:43], v11 offset:59392
  v_mfma_f32_16x16x32_bf16 v[84:87], v[64:67], a[12:15], v[84:87]
  ds_read_b128 v[44:47], v11 offset:60416
  v_mfma_f32_16x16x32_bf16 v[88:91], v[68:71], a[12:15], v[88:91]
  ds_read_b128 v[48:51], v11 offset:61440
  s_waitcnt lgkmcnt(4)
  v_mfma_f32_16x16x32_bf16 v[72:75], v[32:35], a[16:19], v[72:75]
  ds_read_b128 v[52:55], v11 offset:62464
  s_add_u32 m0, s25, 102400
  s_nop 0
  s_waitcnt lgkmcnt(4)
  v_mfma_f32_16x16x32_bf16 v[76:79], v[36:39], a[16:19], v[76:79]
  ds_read_b128 v[56:59], v11 offset:63488
  buffer_load_dwordx4 v14, s[4:7], s24 offen lds
  buffer_load_dwordx4 a[64:67], v6, s[4:7], s23 offen offset:0 sc1
  s_waitcnt lgkmcnt(4)
  v_mfma_f32_16x16x32_bf16 v[80:83], v[40:43], a[16:19], v[80:83]
  ds_read_b128 v[60:63], v11 offset:64512
  buffer_load_dwordx4 a[68:71], v6, s[4:7], s23 offen offset:2048 sc1
  s_add_u32 s23, s23, 4096
  s_waitcnt lgkmcnt(4)
  v_mfma_f32_16x16x32_bf16 v[84:87], v[44:47], a[16:19], v[84:87]
  ds_read_b128 v[64:67], v12 offset:0
  s_add_u32 m0, s25, 103424
  s_nop 0
  s_waitcnt lgkmcnt(4)
  v_mfma_f32_16x16x32_bf16 v[88:91], v[48:51], a[16:19], v[88:91]
  ds_read_b128 v[68:71], v12 offset:1024
  buffer_load_dwordx4 v15, s[4:7], s24 offen lds
  buffer_load_dwordx4 a[72:75], v6, s[4:7], s23 offen offset:0 sc1
  s_waitcnt lgkmcnt(4)
  v_mfma_f32_16x16x32_bf16 v[72:75], v[52:55], a[20:23], v[72:75]
  ds_read_b128 v[32:35], v12 offset:2048
  buffer_load_dwordx4 a[76:79], v6, s[4:7], s23 offen offset:2048 sc1
  s_add_u32 s23, s23, 4096
  s_waitcnt lgkmcnt(4)
  v_mfma_f32_16x16x32_bf16 v[76:79], v[56:59], a[20:23], v[76:79]
  ds_read_b128 v[36:39], v12 offset:3072
  s_add_u32 m0, s25, 104448
  s_nop 0
  s_waitcnt lgkmcnt(4)
  v_mfma_f32_16x16x32_bf16 v[80:83], v[60:63], a[20:23], v[80:83]
  ds_read_b128 v[40:43], v12 offset:4096
  buffer_load_dwordx4 v16, s[4:7], s24 offen lds
  s_add_u32 m0, s25, 105472
  s_waitcnt lgkmcnt(4)
  v_mfma_f32_16x16x32_bf16 v[84:87], v[64:67], a[20:23], v[84:87]
  ds_read_b128 v[44:47], v12 offset:5120
  s_nop 0
  buffer_load_dwordx4 v17, s[4:7], s24 offen lds
  s_waitcnt lgkmcnt(4)
  v_mfma_f32_16x16x32_bf16 v[88:91], v[68:71], a[20:23], v[88:91]
  ds_read_b128 v[48:51], v12 offset:6144
  s_add_u32 m0, s25, 106496
  s_nop 0
  s_waitcnt lgkmcnt(4)
  v_mfma_f32_16x16x32_bf16 v[72:75], v[32:35], a[24:27], v[72:75]
  ds_read_b128 v[52:55], v12 offset:7168
  buffer_load_dwordx4 v18, s[4:7], s24 offen lds
  s_add_u32 s24, s24, 4096
  s_waitcnt lgkmcnt(4)
  v_mfma_f32_16x16x32_bf16 v[76:79], v[36:39], a[24:27], v[76:79]
  ds_read_b128 v[56:59], v12 offset:8192
  s_waitcnt lgkmcnt(4)
  v_mfma_f32_16x16x32_bf16 v[80:83], v[40:43], a[24:27], v[80:83]
  ds_read_b128 v[60:63], v12 offset:9216
  s_waitcnt lgkmcnt(4)
  v_mfma_f32_16x16x32_bf16 v[84:87], v[44:47], a[24:27], v[84:87]
  ds_read_b128 v[64:67], v12 offset:10240
  s_waitcnt lgkmcnt(4)
  v_mfma_f32_16x16x32_bf16 v[88:91], v[48:51], a[24:27], v[88:91]
  ds_read_b128 v[68:71], v12 offset:11264
  s_waitcnt vmcnt(13)
  s_waitcnt lgkmcnt(0)
  s_barrier
  v_mfma_f32_16x16x32_bf16 v[72:75], v[52:55], a[28:31], v[72:75]
  ds_read_b128 v[32:35], v10 offset:0
  v_mfma_f32_16x16x32_bf16 v[76:79], v[56:59], a[28:31], v[76:79]
  ds_read_b128 v[36:39], v10 offset:1024
  v_mfma_f32_16x16x32_bf16 v[80:83], v[60:63], a[28:31], v[80:83]
  ds_read_b128 v[40:43], v10 offset:2048
  v_mfma_f32_16x16x32_bf16 v[84:87], v[64:67], a[28:31], v[84:87]
  ds_read_b128 v[44:47], v10 offset:3072
  v_mfma_f32_16x16x32_bf16 v[88:91], v[68:71], a[28:31], v[88:91]
  ds_read_b128 v[48:51], v10 offset:4096
  ds_read_b128 v[92:95], v7 offset:640
  ds_read_b128 v[96:99], v7 offset:704
  ds_read_b128 v[100:103], v7 offset:768
  ds_read_b128 v[104:107], v7 offset:832
  ds_read_b128 v[108:111], v7 offset:896
  v_lshlrev_b32 v112, 16, v22
  v_and_b32 v113, 0xffff0000, v22
  v_lshlrev_b32 v114, 16, v23
  v_and_b32 v115, 0xffff0000, v23
  v_lshlrev_b32 v116, 16, v24
  v_and_b32 v117, 0xffff0000, v24
  v_lshlrev_b32 v118, 16, v25
  v_and_b32 v119, 0xffff0000, v25
  v_lshlrev_b32 v120, 16, v26
  v_and_b32 v121, 0xffff0000, v26
  v_lshlrev_b32 v122, 16, v27
  v_and_b32 v123, 0xffff0000, v27
  v_lshlrev_b32 v124, 16, v28
  v_and_b32 v125, 0xffff0000, v28
  v_lshlrev_b32 v126, 16, v29
  v_and_b32 v127, 0xffff0000, v29
  v_lshlrev_b32 v128, 16, v30
  v_and_b32 v129, 0xffff0000, v30
  v_lshlrev_b32 v130, 16, v31
  v_and_b32 v131, 0xffff0000, v31
  s_waitcnt lgkmcnt(9)
  v_mfma_f32_16x16x32_bf16 v[72:75], v[32:35], a[32:35], v[72:75]
  ds_read_b128 v[52:55], v10 offset:5120
  s_add_u32 m0, s25, 122880
  s_nop 0
  s_waitcnt lgkmcnt(9)
  v_mfma_f32_16x16x32_bf16 v[76:79], v[36:39], a[32:35], v[76:79]
  ds_read_b128 v[56:59], v10 offset:6144
  buffer_load_dwordx4 v14, s[4:7], s24 offen lds
  buffer_load_dwordx4 a[0:3], v6, s[4:7], s23 offen offset:0 sc1
  s_waitcnt lgkmcnt(9)
  v_mfma_f32_16x16x32_bf16 v[80:83], v[40:43], a[32:35], v[80:83]
  ds_read_b128 v[60:63], v10 offset:7168
  buffer_load_dwordx4 a[4:7], v6, s[4:7], s23 offen offset:2048 sc1
  s_add_u32 s23, s23, 4096
  s_waitcnt lgkmcnt(9)
  v_mfma_f32_16x16x32_bf16 v[84:87], v[44:47], a[32:35], v[84:87]
  ds_read_b128 v[64:67], v10 offset:8192
  s_add_u32 m0, s25, 123904
  s_nop 0
  s_waitcnt lgkmcnt(9)
  v_mfma_f32_16x16x32_bf16 v[88:91], v[48:51], a[32:35], v[88:91]
  ds_read_b128 v[68:71], v10 offset:9216
  buffer_load_dwordx4 v15, s[4:7], s24 offen lds
  buffer_load_dwordx4 a[8:11], v6, s[4:7], s23 offen offset:0 sc1
  s_waitcnt lgkmcnt(4)
  v_mfma_f32_16x16x32_bf16 v[72:75], v[52:55], a[36:39], v[72:75]
  ds_read_b128 v[32:35], v10 offset:10240
  buffer_load_dwordx4 a[12:15], v6, s[4:7], s23 offen offset:2048 sc1
  s_add_u32 s23, s23, 4096
  s_waitcnt lgkmcnt(4)
  v_mfma_f32_16x16x32_bf16 v[76:79], v[56:59], a[36:39], v[76:79]
  ds_read_b128 v[36:39], v10 offset:11264
  s_add_u32 m0, s25, 124928
  s_nop 0
  s_waitcnt lgkmcnt(4)
  v_mfma_f32_16x16x32_bf16 v[80:83], v[60:63], a[36:39], v[80:83]
  ds_read_b128 v[40:43], v10 offset:12288
  buffer_load_dwordx4 v16, s[4:7], s24 offen lds
  s_add_u32 m0, s25, 125952
  s_waitcnt lgkmcnt(4)
  v_mfma_f32_16x16x32_bf16 v[84:87], v[64:67], a[36:39], v[84:87]
  ds_read_b128 v[44:47], v10 offset:13312
  s_nop 0
  buffer_load_dwordx4 v17, s[4:7], s24 offen lds
  s_waitcnt lgkmcnt(4)
  v_mfma_f32_16x16x32_bf16 v[88:91], v[68:71], a[36:39], v[88:91]
  ds_read_b128 v[48:51], v10 offset:14336
  s_add_u32 m0, s25, 126976
  s_nop 0
  s_waitcnt lgkmcnt(4)
  v_mfma_f32_16x16x32_bf16 v[72:75], v[32:35], a[40:43], v[72:75]
  ds_read_b128 v[52:55], v10 offset:15360
  buffer_load_dwordx4 v18, s[4:7], s24 offen lds
  s_add_u32 s24, s24, 4096
  s_waitcnt lgkmcnt(4)
  v_mfma_f32_16x16x32_bf16 v[76:79], v[36:39], a[40:43], v[76:79]
  ds_read_b128 v[56:59], v10 offset:16384
  s_waitcnt lgkmcnt(4)
  v_mfma_f32_16x16x32_bf16 v[80:83], v[40:43], a[40:43], v[80:83]
  ds_read_b128 v[60:63], v10 offset:17408
  s_waitcnt lgkmcnt(4)
  v_mfma_f32_16x16x32_bf16 v[84:87], v[44:47], a[40:43], v[84:87]
  ds_read_b128 v[64:67], v10 offset:18432
  s_waitcnt lgkmcnt(4)
  v_mfma_f32_16x16x32_bf16 v[88:91], v[48:51], a[40:43], v[88:91]
  ds_read_b128 v[68:71], v10 offset:19456
  s_waitcnt vmcnt(18)
  s_waitcnt lgkmcnt(0)
  s_barrier
  v_mfma_f32_16x16x32_bf16 v[72:75], v[52:55], a[44:47], v[72:75]
  ds_read_b128 v[32:35], v10 offset:20480
  v_mfma_f32_16x16x32_bf16 v[76:79], v[56:59], a[44:47], v[76:79]
  ds_read_b128 v[36:39], v10 offset:21504
  v_mfma_f32_16x16x32_bf16 v[80:83], v[60:63], a[44:47], v[80:83]
  ds_read_b128 v[40:43], v10 offset:22528
  v_mfma_f32_16x16x32_bf16 v[84:87], v[64:67], a[44:47], v[84:87]
  ds_read_b128 v[44:47], v10 offset:23552
  v_mfma_f32_16x16x32_bf16 v[88:91], v[68:71], a[44:47], v[88:91]
  ds_read_b128 v[48:51], v10 offset:24576
  s_waitcnt lgkmcnt(4)
  v_mfma_f32_16x16x32_bf16 v[72:75], v[32:35], a[48:51], v[72:75]
  ds_read_b128 v[52:55], v10 offset:25600
  s_add_u32 m0, s25, 0
  s_nop 0
  s_waitcnt lgkmcnt(4)
  v_mfma_f32_16x16x32_bf16 v[76:79], v[36:39], a[48:51], v[76:79]
  ds_read_b128 v[56:59], v10 offset:26624
  buffer_load_dwordx4 v14, s[4:7], s24 offen lds
  buffer_load_dwordx4 a[16:19], v6, s[4:7], s23 offen offset:0 sc1
  s_waitcnt lgkmcnt(4)
  v_mfma_f32_16x16x32_bf16 v[80:83], v[40:43], a[48:51], v[80:83]
  ds_read_b128 v[60:63], v10 offset:27648
  buffer_load_dwordx4 a[20:23], v6, s[4:7], s23 offen offset:2048 sc1
  s_add_u32 s23, s23, 4096
  s_waitcnt lgkmcnt(4)
  v_mfma_f32_16x16x32_bf16 v[84:87], v[44:47], a[48:51], v[84:87]
  ds_read_b128 v[64:67], v10 offset:28672
  s_add_u32 m0, s25, 1024
  s_nop 0
  s_waitcnt lgkmcnt(4)
  v_mfma_f32_16x16x32_bf16 v[88:91], v[48:51], a[48:51], v[88:91]
  ds_read_b128 v[68:71], v10 offset:29696
  buffer_load_dwordx4 v15, s[4:7], s24 offen lds
  buffer_load_dwordx4 a[24:27], v6, s[4:7], s23 offen offset:0 sc1
  s_waitcnt lgkmcnt(4)
  v_mfma_f32_16x16x32_bf16 v[72:75], v[52:55], a[52:55], v[72:75]
  ds_read_b128 v[32:35], v10 offset:30720
  buffer_load_dwordx4 a[28:31], v6, s[4:7], s23 offen offset:2048 sc1
  s_add_u32 s23, s23, 4096
  s_waitcnt lgkmcnt(4)
  v_mfma_f32_16x16x32_bf16 v[76:79], v[56:59], a[52:55], v[76:79]
  ds_read_b128 v[36:39], v10 offset:31744
  s_add_u32 m0, s25, 2048
  s_nop 0
  s_waitcnt lgkmcnt(4)
  v_mfma_f32_16x16x32_bf16 v[80:83], v[60:63], a[52:55], v[80:83]
  ds_read_b128 v[40:43], v10 offset:32768
  buffer_load_dwordx4 v16, s[4:7], s24 offen lds
  s_add_u32 m0, s25, 3072
  s_waitcnt lgkmcnt(4)
  v_mfma_f32_16x16x32_bf16 v[84:87], v[64:67], a[52:55], v[84:87]
  ds_read_b128 v[44:47], v10 offset:33792
  s_nop 0
  buffer_load_dwordx4 v17, s[4:7], s24 offen lds
  s_waitcnt lgkmcnt(4)
  v_mfma_f32_16x16x32_bf16 v[88:91], v[68:71], a[52:55], v[88:91]
  ds_read_b128 v[48:51], v10 offset:34816
  s_add_u32 m0, s25, 4096
  s_nop 0
  s_waitcnt lgkmcnt(4)
  v_mfma_f32_16x16x32_bf16 v[72:75], v[32:35], a[56:59], v[72:75]
  ds_read_b128 v[52:55], v10 offset:35840
  buffer_load_dwordx4 v18, s[4:7], s24 offen lds
  s_add_u32 s24, s24, 4096
  s_waitcnt lgkmcnt(4)
  v_mfma_f32_16x16x32_bf16 v[76:79], v[36:39], a[56:59], v[76:79]
  ds_read_b128 v[56:59], v10 offset:36864
  s_waitcnt lgkmcnt(4)
  v_mfma_f32_16x16x32_bf16 v[80:83], v[40:43], a[56:59], v[80:83]
  ds_read_b128 v[60:63], v10 offset:37888
  s_waitcnt lgkmcnt(4)
  v_mfma_f32_16x16x32_bf16 v[84:87], v[44:47], a[56:59], v[84:87]
  ds_read_b128 v[64:67], v10 offset:38912
  s_waitcnt lgkmcnt(4)
  v_mfma_f32_16x16x32_bf16 v[88:91], v[48:51], a[56:59], v[88:91]
  ds_read_b128 v[68:71], v10 offset:39936
  s_waitcnt vmcnt(21)
  s_waitcnt lgkmcnt(0)
  s_barrier
  v_mfma_f32_16x16x32_bf16 v[72:75], v[52:55], a[60:63], v[72:75]
  ds_read_b128 v[32:35], v10 offset:40960
  v_mfma_f32_16x16x32_bf16 v[76:79], v[56:59], a[60:63], v[76:79]
  ds_read_b128 v[36:39], v10 offset:41984
  v_mfma_f32_16x16x32_bf16 v[80:83], v[60:63], a[60:63], v[80:83]
  ds_read_b128 v[40:43], v10 offset:43008
  v_mfma_f32_16x16x32_bf16 v[84:87], v[64:67], a[60:63], v[84:87]
  ds_read_b128 v[44:47], v10 offset:44032
  v_mfma_f32_16x16x32_bf16 v[88:91], v[68:71], a[60:63], v[88:91]
  ds_read_b128 v[48:51], v10 offset:45056
  s_waitcnt lgkmcnt(4)
  v_mfma_f32_16x16x32_bf16 v[72:75], v[32:35], a[64:67], v[72:75]
  ds_read_b128 v[52:55], v10 offset:46080
  s_add_u32 m0, s25, 20480
  s_nop 0
  s_waitcnt lgkmcnt(4)
  v_mfma_f32_16x16x32_bf16 v[76:79], v[36:39], a[64:67], v[76:79]
  ds_read_b128 v[56:59], v10 offset:47104
  buffer_load_dwordx4 v14, s[4:7], s24 offen lds
  buffer_load_dwordx4 a[32:35], v6, s[4:7], s23 offen offset:0 sc1
  s_waitcnt lgkmcnt(4)
  v_mfma_f32_16x16x32_bf16 v[80:83], v[40:43], a[64:67], v[80:83]
  ds_read_b128 v[60:63], v10 offset:48128
  buffer_load_dwordx4 a[36:39], v6, s[4:7], s23 offen offset:2048 sc1
  s_add_u32 s23, s23, 4096
  s_waitcnt lgkmcnt(4)
  v_mfma_f32_16x16x32_bf16 v[84:87], v[44:47], a[64:67], v[84:87]
  ds_read_b128 v[64:67], v10 offset:49152
  s_add_u32 m0, s25, 21504
  s_nop 0
  s_waitcnt lgkmcnt(4)
  v_mfma_f32_16x16x32_bf16 v[88:91], v[48:51], a[64:67], v[88:91]
  ds_read_b128 v[68:71], v10 offset:50176
  buffer_load_dwordx4 v15, s[4:7], s24 offen lds
  buffer_load_dwordx4 a[40:43], v6, s[4:7], s23 offen offset:0 sc1
  s_waitcnt lgkmcnt(4)
  v_mfma_f32_16x16x32_bf16 v[72:75], v[52:55], a[68:71], v[72:75]
  ds_read_b128 v[32:35], v10 offset:51200
  buffer_load_dwordx4 a[44:47], v6, s[4:7], s23 offen offset:2048 sc1
  s_add_u32 s23, s23, 4096
  s_waitcnt lgkmcnt(4)
  v_mfma_f32_16x16x32_bf16 v[76:79], v[56:59], a[68:71], v[76:79]
  ds_read_b128 v[36:39], v10 offset:52224
  s_add_u32 m0, s25, 22528
  s_nop 0
  s_waitcnt lgkmcnt(4)
  v_mfma_f32_16x16x32_bf16 v[80:83], v[60:63], a[68:71], v[80:83]
  ds_read_b128 v[40:43], v10 offset:53248
  buffer_load_dwordx4 v16, s[4:7], s24 offen lds
  s_add_u32 m0, s25, 23552
  s_waitcnt lgkmcnt(4)
  v_mfma_f32_16x16x32_bf16 v[84:87], v[64:67], a[68:71], v[84:87]
  ds_read_b128 v[44:47], v10 offset:54272
  s_nop 0
  buffer_load_dwordx4 v17, s[4:7], s24 offen lds
  s_waitcnt lgkmcnt(4)
  v_mfma_f32_16x16x32_bf16 v[88:91], v[68:71], a[68:71], v[88:91]
  ds_read_b128 v[48:51], v10 offset:55296
  s_add_u32 m0, s25, 24576
  s_nop 0
  s_waitcnt lgkmcnt(4)
  v_mfma_f32_16x16x32_bf16 v[72:75], v[32:35], a[72:75], v[72:75]
  ds_read_b128 v[52:55], v10 offset:56320
  buffer_load_dwordx4 v18, s[4:7], s24 offen lds
  s_add_u32 s24, s24, 4096
  s_waitcnt lgkmcnt(4)
  v_mfma_f32_16x16x32_bf16 v[76:79], v[36:39], a[72:75], v[76:79]
  ds_read_b128 v[56:59], v10 offset:57344
  s_waitcnt lgkmcnt(4)
  v_mfma_f32_16x16x32_bf16 v[80:83], v[40:43], a[72:75], v[80:83]
  ds_read_b128 v[60:63], v10 offset:58368
  s_waitcnt lgkmcnt(4)
  v_mfma_f32_16x16x32_bf16 v[84:87], v[44:47], a[72:75], v[84:87]
  ds_read_b128 v[64:67], v10 offset:59392
  s_waitcnt lgkmcnt(4)
  v_mfma_f32_16x16x32_bf16 v[88:91], v[48:51], a[72:75], v[88:91]
  ds_read_b128 v[68:71], v10 offset:60416
  s_waitcnt vmcnt(21)
  s_waitcnt lgkmcnt(0)
  s_barrier
  v_mfma_f32_16x16x32_bf16 v[72:75], v[52:55], a[76:79], v[72:75]
  ds_read_b128 v[32:35], v10 offset:61440
  v_mfma_f32_16x16x32_bf16 v[76:79], v[56:59], a[76:79], v[76:79]
  ds_read_b128 v[36:39], v10 offset:62464
  v_mfma_f32_16x16x32_bf16 v[80:83], v[60:63], a[76:79], v[80:83]
  ds_read_b128 v[40:43], v10 offset:63488
  v_mfma_f32_16x16x32_bf16 v[84:87], v[64:67], a[76:79], v[84:87]
  ds_read_b128 v[44:47], v10 offset:64512
  v_mfma_f32_16x16x32_bf16 v[88:91], v[68:71], a[76:79], v[88:91]
  ds_read_b128 v[48:51], v11 offset:0
  s_waitcnt lgkmcnt(4)
  v_mfma_f32_16x16x32_bf16 v[72:75], v[32:35], a[0:3], v[72:75]
  ds_read_b128 v[52:55], v11 offset:1024
  s_add_u32 m0, s25, 40960
  s_nop 0
  s_waitcnt lgkmcnt(4)
  v_mfma_f32_16x16x32_bf16 v[76:79], v[36:39], a[0:3], v[76:79]
  ds_read_b128 v[56:59], v11 offset:2048
  buffer_load_dwordx4 v14, s[4:7], s24 offen lds
  buffer_load_dwordx4 a[48:51], v6, s[4:7], s23 offen offset:0 sc1
  s_waitcnt lgkmcnt(4)
  v_mfma_f32_16x16x32_bf16 v[80:83], v[40:43], a[0:3], v[80:83]
  ds_read_b128 v[60:63], v11 offset:3072
  buffer_load_dwordx4 a[52:55], v6, s[4:7], s23 offen offset:2048 sc1
  s_add_u32 s23, s23, 4096
  s_waitcnt lgkmcnt(4)
  v_mfma_f32_16x16x32_bf16 v[84:87], v[44:47], a[0:3], v[84:87]
  ds_read_b128 v[64:67], v11 offset:4096
  s_add_u32 m0, s25, 41984
  s_nop 0
  s_waitcnt lgkmcnt(4)
  v_mfma_f32_16x16x32_bf16 v[88:91], v[48:51], a[0:3], v[88:91]
  ds_read_b128 v[68:71], v11 offset:5120
  buffer_load_dwordx4 v15, s[4:7], s24 offen lds
  buffer_load_dwordx4 a[56:59], v6, s[4:7], s23 offen offset:0 sc1
  s_waitcnt lgkmcnt(4)
  v_mfma_f32_16x16x32_bf16 v[72:75], v[52:55], a[4:7], v[72:75]
  ds_read_b128 v[32:35], v11 offset:6144
  buffer_load_dwordx4 a[60:63], v6, s[4:7], s23 offen offset:2048 sc1
  s_add_u32 s23, s23, 4096
  s_waitcnt lgkmcnt(4)
  v_mfma_f32_16x16x32_bf16 v[76:79], v[56:59], a[4:7], v[76:79]
  ds_read_b128 v[36:39], v11 offset:7168
  s_add_u32 m0, s25, 43008
  s_nop 0
  s_waitcnt lgkmcnt(4)
  v_mfma_f32_16x16x32_bf16 v[80:83], v[60:63], a[4:7], v[80:83]
  ds_read_b128 v[40:43], v11 offset:8192
  buffer_load_dwordx4 v16, s[4:7], s24 offen lds
  s_add_u32 m0, s25, 44032
  s_waitcnt lgkmcnt(4)
  v_mfma_f32_16x16x32_bf16 v[84:87], v[64:67], a[4:7], v[84:87]
  ds_read_b128 v[44:47], v11 offset:9216
  s_nop 0
  buffer_load_dwordx4 v17, s[4:7], s24 offen lds
  s_waitcnt lgkmcnt(4)
  v_mfma_f32_16x16x32_bf16 v[88:91], v[68:71], a[4:7], v[88:91]
  ds_read_b128 v[48:51], v11 offset:10240
  s_add_u32 m0, s25, 45056
  s_nop 0
  s_waitcnt lgkmcnt(4)
  v_mfma_f32_16x16x32_bf16 v[72:75], v[32:35], a[8:11], v[72:75]
  ds_read_b128 v[52:55], v11 offset:11264
  buffer_load_dwordx4 v18, s[4:7], s24 offen lds
  s_add_u32 s24, s24, 4096
  s_waitcnt lgkmcnt(4)
  v_mfma_f32_16x16x32_bf16 v[76:79], v[36:39], a[8:11], v[76:79]
  ds_read_b128 v[56:59], v11 offset:12288
  s_waitcnt lgkmcnt(4)
  v_mfma_f32_16x16x32_bf16 v[80:83], v[40:43], a[8:11], v[80:83]
  ds_read_b128 v[60:63], v11 offset:13312
  s_waitcnt lgkmcnt(4)
  v_mfma_f32_16x16x32_bf16 v[84:87], v[44:47], a[8:11], v[84:87]
  ds_read_b128 v[64:67], v11 offset:14336
  s_waitcnt lgkmcnt(4)
  v_mfma_f32_16x16x32_bf16 v[88:91], v[48:51], a[8:11], v[88:91]
  ds_read_b128 v[68:71], v11 offset:15360
  s_waitcnt vmcnt(21)
  s_waitcnt lgkmcnt(0)
  s_barrier
  v_mfma_f32_16x16x32_bf16 v[72:75], v[52:55], a[12:15], v[72:75]
  ds_read_b128 v[32:35], v11 offset:16384
  v_mfma_f32_16x16x32_bf16 v[76:79], v[56:59], a[12:15], v[76:79]
  ds_read_b128 v[36:39], v11 offset:17408
  v_mfma_f32_16x16x32_bf16 v[80:83], v[60:63], a[12:15], v[80:83]
  ds_read_b128 v[40:43], v11 offset:18432
  v_mfma_f32_16x16x32_bf16 v[84:87], v[64:67], a[12:15], v[84:87]
  ds_read_b128 v[44:47], v11 offset:19456
  v_mfma_f32_16x16x32_bf16 v[88:91], v[68:71], a[12:15], v[88:91]
  ds_read_b128 v[48:51], v11 offset:20480
  s_waitcnt lgkmcnt(4)
  v_mfma_f32_16x16x32_bf16 v[72:75], v[32:35], a[16:19], v[72:75]
  ds_read_b128 v[52:55], v11 offset:21504
  s_add_u32 m0, s25, 61440
  s_nop 0
  s_waitcnt lgkmcnt(4)
  v_mfma_f32_16x16x32_bf16 v[76:79], v[36:39], a[16:19], v[76:79]
  ds_read_b128 v[56:59], v11 offset:22528
  buffer_load_dwordx4 v14, s[4:7], s24 offen lds
  buffer_load_dwordx4 a[64:67], v6, s[4:7], s23 offen offset:0 sc1
  s_waitcnt lgkmcnt(4)
  v_mfma_f32_16x16x32_bf16 v[80:83], v[40:43], a[16:19], v[80:83]
  ds_read_b128 v[60:63], v11 offset:23552
  buffer_load_dwordx4 a[68:71], v6, s[4:7], s23 offen offset:2048 sc1
  s_add_u32 s23, s23, 4096
  s_waitcnt lgkmcnt(4)
  v_mfma_f32_16x16x32_bf16 v[84:87], v[44:47], a[16:19], v[84:87]
  ds_read_b128 v[64:67], v11 offset:24576
  s_add_u32 m0, s25, 62464
  s_nop 0
  s_waitcnt lgkmcnt(4)
  v_mfma_f32_16x16x32_bf16 v[88:91], v[48:51], a[16:19], v[88:91]
  ds_read_b128 v[68:71], v11 offset:25600
  buffer_load_dwordx4 v15, s[4:7], s24 offen lds
  buffer_load_dwordx4 a[72:75], v6, s[4:7], s23 offen offset:0 sc1
  s_waitcnt lgkmcnt(4)
  v_mfma_f32_16x16x32_bf16 v[72:75], v[52:55], a[20:23], v[72:75]
  ds_read_b128 v[32:35], v11 offset:26624
  buffer_load_dwordx4 a[76:79], v6, s[4:7], s23 offen offset:2048 sc1
  s_add_u32 s23, s23, 4096
  s_waitcnt lgkmcnt(4)
  v_mfma_f32_16x16x32_bf16 v[76:79], v[56:59], a[20:23], v[76:79]
  ds_read_b128 v[36:39], v11 offset:27648
  s_add_u32 m0, s25, 63488
  s_nop 0
  s_waitcnt lgkmcnt(4)
  v_mfma_f32_16x16x32_bf16 v[80:83], v[60:63], a[20:23], v[80:83]
  ds_read_b128 v[40:43], v11 offset:28672
  buffer_load_dwordx4 v16, s[4:7], s24 offen lds
  s_add_u32 m0, s25, 64512
  s_waitcnt lgkmcnt(4)
  v_mfma_f32_16x16x32_bf16 v[84:87], v[64:67], a[20:23], v[84:87]
  ds_read_b128 v[44:47], v11 offset:29696
  s_nop 0
  buffer_load_dwordx4 v17, s[4:7], s24 offen lds
  s_waitcnt lgkmcnt(4)
  v_mfma_f32_16x16x32_bf16 v[88:91], v[68:71], a[20:23], v[88:91]
  ds_read_b128 v[48:51], v11 offset:30720
  s_add_u32 m0, s25, 65536
  s_nop 0
  s_waitcnt lgkmcnt(4)
  v_mfma_f32_16x16x32_bf16 v[72:75], v[32:35], a[24:27], v[72:75]
  ds_read_b128 v[52:55], v11 offset:31744
  buffer_load_dwordx4 v18, s[4:7], s24 offen lds
  s_add_u32 s24, s24, 4096
  s_waitcnt lgkmcnt(4)
  v_mfma_f32_16x16x32_bf16 v[76:79], v[36:39], a[24:27], v[76:79]
  ds_read_b128 v[56:59], v11 offset:32768
  s_waitcnt lgkmcnt(4)
  v_mfma_f32_16x16x32_bf16 v[80:83], v[40:43], a[24:27], v[80:83]
  ds_read_b128 v[60:63], v11 offset:33792
  s_waitcnt lgkmcnt(4)
  v_mfma_f32_16x16x32_bf16 v[84:87], v[44:47], a[24:27], v[84:87]
  ds_read_b128 v[64:67], v11 offset:34816
  s_waitcnt lgkmcnt(4)
  v_mfma_f32_16x16x32_bf16 v[88:91], v[48:51], a[24:27], v[88:91]
  ds_read_b128 v[68:71], v11 offset:35840
  s_waitcnt vmcnt(21)
  s_waitcnt lgkmcnt(0)
  s_barrier
  v_mfma_f32_16x16x32_bf16 v[72:75], v[52:55], a[28:31], v[72:75]
  ds_read_b128 v[32:35], v11 offset:36864
  v_mfma_f32_16x16x32_bf16 v[76:79], v[56:59], a[28:31], v[76:79]
  ds_read_b128 v[36:39], v11 offset:37888
  v_mfma_f32_16x16x32_bf16 v[80:83], v[60:63], a[28:31], v[80:83]
  ds_read_b128 v[40:43], v11 offset:38912
  v_mfma_f32_16x16x32_bf16 v[84:87], v[64:67], a[28:31], v[84:87]
  ds_read_b128 v[44:47], v11 offset:39936
  v_mfma_f32_16x16x32_bf16 v[88:91], v[68:71], a[28:31], v[88:91]
  ds_read_b128 v[48:51], v11 offset:40960
  s_waitcnt lgkmcnt(4)
  v_mfma_f32_16x16x32_bf16 v[72:75], v[32:35], a[32:35], v[72:75]
  ds_read_b128 v[52:55], v11 offset:41984
  s_cmp_lt_u32 s16, 2
  s_cselect_b32 s21, 0, 4096
  s_waitcnt lgkmcnt(4)
  v_mfma_f32_16x16x32_bf16 v[76:79], v[36:39], a[32:35], v[76:79]
  ds_read_b128 v[56:59], v11 offset:43008
  s_sub_u32 s24, s24, s21
  s_add_u32 m0, s25, 81920
  s_waitcnt lgkmcnt(4)
  v_mfma_f32_16x16x32_bf16 v[80:83], v[40:43], a[32:35], v[80:83]
  ds_read_b128 v[60:63], v11 offset:44032
  s_nop 0
  buffer_load_dwordx4 v14, s[4:7], s24 offen lds
  s_waitcnt lgkmcnt(4)
  v_mfma_f32_16x16x32_bf16 v[84:87], v[44:47], a[32:35], v[84:87]
  ds_read_b128 v[64:67], v11 offset:45056
  buffer_load_dwordx4 a[0:3], v6, s[4:7], s23 offen offset:0 sc1
  buffer_load_dwordx4 a[4:7], v6, s[4:7], s23 offen offset:2048 sc1
  s_waitcnt lgkmcnt(4)
  v_mfma_f32_16x16x32_bf16 v[88:91], v[48:51], a[32:35], v[88:91]
  ds_read_b128 v[68:71], v11 offset:46080
  s_add_u32 s23, s23, 4096
  s_add_u32 m0, s25, 82944
  s_waitcnt lgkmcnt(4)
  v_mfma_f32_16x16x32_bf16 v[72:75], v[52:55], a[36:39], v[72:75]
  ds_read_b128 v[32:35], v11 offset:47104
  s_nop 0
  buffer_load_dwordx4 v15, s[4:7], s24 offen lds
  s_waitcnt lgkmcnt(4)
  v_mfma_f32_16x16x32_bf16 v[76:79], v[56:59], a[36:39], v[76:79]
  ds_read_b128 v[36:39], v11 offset:48128
  buffer_load_dwordx4 a[8:11], v6, s[4:7], s23 offen offset:0 sc1
  buffer_load_dwordx4 a[12:15], v6, s[4:7], s23 offen offset:2048 sc1
  s_waitcnt lgkmcnt(4)
  v_mfma_f32_16x16x32_bf16 v[80:83], v[60:63], a[36:39], v[80:83]
  ds_read_b128 v[40:43], v11 offset:49152
  s_add_u32 s23, s23, 4096
  s_add_u32 m0, s25, 83968
  s_waitcnt lgkmcnt(4)
  v_mfma_f32_16x16x32_bf16 v[84:87], v[64:67], a[36:39], v[84:87]
  ds_read_b128 v[44:47], v11 offset:50176
  s_nop 0
  buffer_load_dwordx4 v16, s[4:7], s24 offen lds
  s_waitcnt lgkmcnt(4)
  v_mfma_f32_16x16x32_bf16 v[88:91], v[68:71], a[36:39], v[88:91]
  ds_read_b128 v[48:51], v11 offset:51200
  s_add_u32 m0, s25, 84992
  s_nop 0
  s_waitcnt lgkmcnt(4)
  v_mfma_f32_16x16x32_bf16 v[72:75], v[32:35], a[40:43], v[72:75]
  ds_read_b128 v[52:55], v11 offset:52224
  buffer_load_dwordx4 v17, s[4:7], s24 offen lds
  s_add_u32 m0, s25, 86016
  s_waitcnt lgkmcnt(4)
  v_mfma_f32_16x16x32_bf16 v[76:79], v[36:39], a[40:43], v[76:79]
  ds_read_b128 v[56:59], v11 offset:53248
  s_nop 0
  buffer_load_dwordx4 v18, s[4:7], s24 offen lds
  s_waitcnt lgkmcnt(4)
  v_mfma_f32_16x16x32_bf16 v[80:83], v[40:43], a[40:43], v[80:83]
  ds_read_b128 v[60:63], v11 offset:54272
  s_add_u32 s24, s24, 4096
  s_waitcnt lgkmcnt(4)
  v_mfma_f32_16x16x32_bf16 v[84:87], v[44:47], a[40:43], v[84:87]
  ds_read_b128 v[64:67], v11 offset:55296
  s_waitcnt lgkmcnt(4)
  v_mfma_f32_16x16x32_bf16 v[88:91], v[48:51], a[40:43], v[88:91]
  ds_read_b128 v[68:71], v11 offset:56320
  s_waitcnt vmcnt(21)
  s_waitcnt lgkmcnt(0)
  s_barrier
  v_mfma_f32_16x16x32_bf16 v[72:75], v[52:55], a[44:47], v[72:75]
  ds_read_b128 v[32:35], v11 offset:57344
  v_mfma_f32_16x16x32_bf16 v[76:79], v[56:59], a[44:47], v[76:79]
  ds_read_b128 v[36:39], v11 offset:58368
  v_mfma_f32_16x16x32_bf16 v[80:83], v[60:63], a[44:47], v[80:83]
  ds_read_b128 v[40:43], v11 offset:59392
  v_mfma_f32_16x16x32_bf16 v[84:87], v[64:67], a[44:47], v[84:87]
  ds_read_b128 v[44:47], v11 offset:60416
  v_mfma_f32_16x16x32_bf16 v[88:91], v[68:71], a[44:47], v[88:91]
  ds_read_b128 v[48:51], v11 offset:61440
  s_waitcnt lgkmcnt(4)
  v_mfma_f32_16x16x32_bf16 v[72:75], v[32:35], a[48:51], v[72:75]
  ds_read_b128 v[52:55], v11 offset:62464
  buffer_load_dwordx4 a[16:19], v6, s[4:7], s23 offen offset:0 sc1
  buffer_load_dwordx4 a[20:23], v6, s[4:7], s23 offen offset:2048 sc1
  s_waitcnt lgkmcnt(4)
  v_mfma_f32_16x16x32_bf16 v[76:79], v[36:39], a[48:51], v[76:79]
  ds_read_b128 v[56:59], v11 offset:63488
  s_add_u32 s23, s23, 4096
  buffer_load_dwordx4 a[24:27], v6, s[4:7], s23 offen offset:0 sc1
  s_waitcnt lgkmcnt(4)
  v_mfma_f32_16x16x32_bf16 v[80:83], v[40:43], a[48:51], v[80:83]
  ds_read_b128 v[60:63], v11 offset:64512
  buffer_load_dwordx4 a[28:31], v6, s[4:7], s23 offen offset:2048 sc1
  s_add_u32 s23, s23, 4096
  s_waitcnt lgkmcnt(4)
  v_mfma_f32_16x16x32_bf16 v[84:87], v[44:47], a[48:51], v[84:87]
  ds_read_b128 v[64:67], v12 offset:0
  s_waitcnt lgkmcnt(4)
  v_mfma_f32_16x16x32_bf16 v[88:91], v[48:51], a[48:51], v[88:91]
  ds_read_b128 v[68:71], v12 offset:1024
  s_waitcnt lgkmcnt(4)
  v_mfma_f32_16x16x32_bf16 v[72:75], v[52:55], a[52:55], v[72:75]
  ds_read_b128 v[32:35], v12 offset:2048
  s_waitcnt lgkmcnt(4)
  v_mfma_f32_16x16x32_bf16 v[76:79], v[56:59], a[52:55], v[76:79]
  ds_read_b128 v[36:39], v12 offset:3072
  s_waitcnt lgkmcnt(4)
  v_mfma_f32_16x16x32_bf16 v[80:83], v[60:63], a[52:55], v[80:83]
  ds_read_b128 v[40:43], v12 offset:4096
  s_waitcnt lgkmcnt(4)
  v_mfma_f32_16x16x32_bf16 v[84:87], v[64:67], a[52:55], v[84:87]
  ds_read_b128 v[44:47], v12 offset:5120
  s_waitcnt lgkmcnt(4)
  v_mfma_f32_16x16x32_bf16 v[88:91], v[68:71], a[52:55], v[88:91]
  ds_read_b128 v[48:51], v12 offset:6144
  s_waitcnt lgkmcnt(4)
  v_mfma_f32_16x16x32_bf16 v[72:75], v[32:35], a[56:59], v[72:75]
  ds_read_b128 v[52:55], v12 offset:7168
  s_waitcnt lgkmcnt(4)
  v_mfma_f32_16x16x32_bf16 v[76:79], v[36:39], a[56:59], v[76:79]
  ds_read_b128 v[56:59], v12 offset:8192
  s_waitcnt lgkmcnt(4)
  v_mfma_f32_16x16x32_bf16 v[80:83], v[40:43], a[56:59], v[80:83]
  ds_read_b128 v[60:63], v12 offset:9216
  s_waitcnt lgkmcnt(4)
  v_mfma_f32_16x16x32_bf16 v[84:87], v[44:47], a[56:59], v[84:87]
  ds_read_b128 v[64:67], v12 offset:10240
  s_waitcnt lgkmcnt(4)
  v_mfma_f32_16x16x32_bf16 v[88:91], v[48:51], a[56:59], v[88:91]
  ds_read_b128 v[68:71], v12 offset:11264
  s_waitcnt vmcnt(16)
  s_waitcnt lgkmcnt(0)
  s_barrier
  v_mfma_f32_16x16x32_bf16 v[72:75], v[52:55], a[60:63], v[72:75]
  ds_read_b128 v[32:35], v10 offset:0
  v_mfma_f32_16x16x32_bf16 v[76:79], v[56:59], a[60:63], v[76:79]
  ds_read_b128 v[36:39], v10 offset:1024
  v_mfma_f32_16x16x32_bf16 v[80:83], v[60:63], a[60:63], v[80:83]
  ds_read_b128 v[40:43], v10 offset:2048
  v_mfma_f32_16x16x32_bf16 v[84:87], v[64:67], a[60:63], v[84:87]
  ds_read_b128 v[44:47], v10 offset:3072
  v_mfma_f32_16x16x32_bf16 v[88:91], v[68:71], a[60:63], v[88:91]
  ds_read_b128 v[48:51], v10 offset:4096
  s_waitcnt lgkmcnt(4)
  v_mfma_f32_16x16x32_bf16 v[72:75], v[32:35], a[64:67], v[72:75]
  ds_read_b128 v[52:55], v10 offset:5120
  buffer_load_dwordx4 a[32:35], v6, s[4:7], s23 offen offset:0 sc1
  buffer_load_dwordx4 a[36:39], v6, s[4:7], s23 offen offset:2048 sc1
  s_waitcnt lgkmcnt(4)
  v_mfma_f32_16x16x32_bf16 v[76:79], v[36:39], a[64:67], v[76:79]
  ds_read_b128 v[56:59], v10 offset:6144
  s_add_u32 s23, s23, 4096
  buffer_load_dwordx4 a[40:43], v6, s[4:7], s23 offen offset:0 sc1
  s_waitcnt lgkmcnt(4)
  v_mfma_f32_16x16x32_bf16 v[80:83], v[40:43], a[64:67], v[80:83]
  ds_read_b128 v[60:63], v10 offset:7168
  buffer_load_dwordx4 a[44:47], v6, s[4:7], s23 offen offset:2048 sc1
  s_add_u32 s23, s23, 4096
  s_waitcnt lgkmcnt(4)
  v_mfma_f32_16x16x32_bf16 v[84:87], v[44:47], a[64:67], v[84:87]
  ds_read_b128 v[64:67], v10 offset:8192
  s_waitcnt lgkmcnt(4)
  v_mfma_f32_16x16x32_bf16 v[88:91], v[48:51], a[64:67], v[88:91]
  ds_read_b128 v[68:71], v10 offset:9216
  s_waitcnt lgkmcnt(4)
  v_mfma_f32_16x16x32_bf16 v[72:75], v[52:55], a[68:71], v[72:75]
  ds_read_b128 v[32:35], v10 offset:10240
  s_waitcnt lgkmcnt(4)
  v_mfma_f32_16x16x32_bf16 v[76:79], v[56:59], a[68:71], v[76:79]
  ds_read_b128 v[36:39], v10 offset:11264
  s_waitcnt lgkmcnt(4)
  v_mfma_f32_16x16x32_bf16 v[80:83], v[60:63], a[68:71], v[80:83]
  ds_read_b128 v[40:43], v10 offset:12288
  s_waitcnt lgkmcnt(4)
  v_mfma_f32_16x16x32_bf16 v[84:87], v[64:67], a[68:71], v[84:87]
  ds_read_b128 v[44:47], v10 offset:13312
  s_waitcnt lgkmcnt(4)
  v_mfma_f32_16x16x32_bf16 v[88:91], v[68:71], a[68:71], v[88:91]
  ds_read_b128 v[48:51], v10 offset:14336
  s_waitcnt lgkmcnt(4)
  v_mfma_f32_16x16x32_bf16 v[72:75], v[32:35], a[72:75], v[72:75]
  ds_read_b128 v[52:55], v10 offset:15360
  s_waitcnt lgkmcnt(4)
  v_mfma_f32_16x16x32_bf16 v[76:79], v[36:39], a[72:75], v[76:79]
  ds_read_b128 v[56:59], v10 offset:16384
  s_waitcnt lgkmcnt(4)
  v_mfma_f32_16x16x32_bf16 v[80:83], v[40:43], a[72:75], v[80:83]
  ds_read_b128 v[60:63], v10 offset:17408
  s_waitcnt lgkmcnt(4)
  v_mfma_f32_16x16x32_bf16 v[84:87], v[44:47], a[72:75], v[84:87]
  ds_read_b128 v[64:67], v10 offset:18432
  s_waitcnt lgkmcnt(4)
  v_mfma_f32_16x16x32_bf16 v[88:91], v[48:51], a[72:75], v[88:91]
  ds_read_b128 v[68:71], v10 offset:19456
  s_waitcnt vmcnt(11)
  s_waitcnt lgkmcnt(0)
  s_barrier
  v_mfma_f32_16x16x32_bf16 v[72:75], v[52:55], a[76:79], v[72:75]
  ds_read_b128 v[32:35], v10 offset:20480
  v_mfma_f32_16x16x32_bf16 v[76:79], v[56:59], a[76:79], v[76:79]
  ds_read_b128 v[36:39], v10 offset:21504
  v_mfma_f32_16x16x32_bf16 v[80:83], v[60:63], a[76:79], v[80:83]
  ds_read_b128 v[40:43], v10 offset:22528
  v_mfma_f32_16x16x32_bf16 v[84:87], v[64:67], a[76:79], v[84:87]
  ds_read_b128 v[44:47], v10 offset:23552
  v_mfma_f32_16x16x32_bf16 v[88:91], v[68:71], a[76:79], v[88:91]
  ds_read_b128 v[48:51], v10 offset:24576
  s_waitcnt lgkmcnt(4)
  v_mfma_f32_16x16x32_bf16 v[72:75], v[32:35], a[0:3], v[72:75]
  ds_read_b128 v[52:55], v10 offset:25600
  buffer_load_dwordx4 a[48:51], v6, s[4:7], s23 offen offset:0 sc1
  buffer_load_dwordx4 a[52:55], v6, s[4:7], s23 offen offset:2048 sc1
  s_waitcnt lgkmcnt(4)
  v_mfma_f32_16x16x32_bf16 v[76:79], v[36:39], a[0:3], v[76:79]
  ds_read_b128 v[56:59], v10 offset:26624
  s_add_u32 s23, s23, 4096
  s_waitcnt lgkmcnt(4)
  v_mfma_f32_16x16x32_bf16 v[80:83], v[40:43], a[0:3], v[80:83]
  ds_read_b128 v[60:63], v10 offset:27648
  s_waitcnt lgkmcnt(4)
  v_mfma_f32_16x16x32_bf16 v[84:87], v[44:47], a[0:3], v[84:87]
  ds_read_b128 v[64:67], v10 offset:28672
  s_waitcnt lgkmcnt(4)
  v_mfma_f32_16x16x32_bf16 v[88:91], v[48:51], a[0:3], v[88:91]
  ds_read_b128 v[68:71], v10 offset:29696
  s_waitcnt lgkmcnt(4)
  v_mfma_f32_16x16x32_bf16 v[72:75], v[52:55], a[4:7], v[72:75]
  ds_read_b128 v[32:35], v10 offset:30720
  s_waitcnt lgkmcnt(4)
  v_mfma_f32_16x16x32_bf16 v[76:79], v[56:59], a[4:7], v[76:79]
  ds_read_b128 v[36:39], v10 offset:31744
  s_waitcnt lgkmcnt(4)
  v_mfma_f32_16x16x32_bf16 v[80:83], v[60:63], a[4:7], v[80:83]
  ds_read_b128 v[40:43], v10 offset:32768
  s_waitcnt lgkmcnt(4)
  v_mfma_f32_16x16x32_bf16 v[84:87], v[64:67], a[4:7], v[84:87]
  ds_read_b128 v[44:47], v10 offset:33792
  s_waitcnt lgkmcnt(4)
  v_mfma_f32_16x16x32_bf16 v[88:91], v[68:71], a[4:7], v[88:91]
  ds_read_b128 v[48:51], v10 offset:34816
  s_waitcnt lgkmcnt(4)
  v_mfma_f32_16x16x32_bf16 v[72:75], v[32:35], a[8:11], v[72:75]
  ds_read_b128 v[52:55], v10 offset:35840
  s_waitcnt lgkmcnt(4)
  v_mfma_f32_16x16x32_bf16 v[76:79], v[36:39], a[8:11], v[76:79]
  ds_read_b128 v[56:59], v10 offset:36864
  s_waitcnt lgkmcnt(4)
  v_mfma_f32_16x16x32_bf16 v[80:83], v[40:43], a[8:11], v[80:83]
  ds_read_b128 v[60:63], v10 offset:37888
  s_waitcnt lgkmcnt(4)
  v_mfma_f32_16x16x32_bf16 v[84:87], v[44:47], a[8:11], v[84:87]
  ds_read_b128 v[64:67], v10 offset:38912
  s_waitcnt lgkmcnt(4)
  v_mfma_f32_16x16x32_bf16 v[88:91], v[48:51], a[8:11], v[88:91]
  ds_read_b128 v[68:71], v10 offset:39936
  s_waitcnt vmcnt(6)
  s_waitcnt lgkmcnt(0)
  s_barrier
  v_mfma_f32_16x16x32_bf16 v[72:75], v[52:55], a[12:15], v[72:75]
  ds_read_b128 v[32:35], v10 offset:40960
  v_mfma_f32_16x16x32_bf16 v[76:79], v[56:59], a[12:15], v[76:79]
  ds_read_b128 v[36:39], v10 offset:41984
  v_mfma_f32_16x16x32_bf16 v[80:83], v[60:63], a[12:15], v[80:83]
  ds_read_b128 v[40:43], v10 offset:43008
  v_mfma_f32_16x16x32_bf16 v[84:87], v[64:67], a[12:15], v[84:87]
  ds_read_b128 v[44:47], v10 offset:44032
  v_mfma_f32_16x16x32_bf16 v[88:91], v[68:71], a[12:15], v[88:91]
  ds_read_b128 v[48:51], v10 offset:45056
  s_waitcnt lgkmcnt(4)
  v_mfma_f32_16x16x32_bf16 v[72:75], v[32:35], a[16:19], v[72:75]
  ds_read_b128 v[52:55], v10 offset:46080
  s_waitcnt lgkmcnt(4)
  v_mfma_f32_16x16x32_bf16 v[76:79], v[36:39], a[16:19], v[76:79]
  ds_read_b128 v[56:59], v10 offset:47104
  s_waitcnt lgkmcnt(4)
  v_mfma_f32_16x16x32_bf16 v[80:83], v[40:43], a[16:19], v[80:83]
  ds_read_b128 v[60:63], v10 offset:48128
  s_waitcnt lgkmcnt(4)
  v_mfma_f32_16x16x32_bf16 v[84:87], v[44:47], a[16:19], v[84:87]
  ds_read_b128 v[64:67], v10 offset:49152
  s_waitcnt lgkmcnt(4)
  v_mfma_f32_16x16x32_bf16 v[88:91], v[48:51], a[16:19], v[88:91]
  ds_read_b128 v[68:71], v10 offset:50176
  s_waitcnt lgkmcnt(4)
  v_mfma_f32_16x16x32_bf16 v[72:75], v[52:55], a[20:23], v[72:75]
  ds_read_b128 v[32:35], v10 offset:51200
  s_waitcnt lgkmcnt(4)
  v_mfma_f32_16x16x32_bf16 v[76:79], v[56:59], a[20:23], v[76:79]
  ds_read_b128 v[36:39], v10 offset:52224
  s_waitcnt lgkmcnt(4)
  v_mfma_f32_16x16x32_bf16 v[80:83], v[60:63], a[20:23], v[80:83]
  ds_read_b128 v[40:43], v10 offset:53248
  s_waitcnt lgkmcnt(4)
  v_mfma_f32_16x16x32_bf16 v[84:87], v[64:67], a[20:23], v[84:87]
  ds_read_b128 v[44:47], v10 offset:54272
  s_waitcnt lgkmcnt(4)
  v_mfma_f32_16x16x32_bf16 v[88:91], v[68:71], a[20:23], v[88:91]
  ds_read_b128 v[48:51], v10 offset:55296
  s_waitcnt lgkmcnt(4)
  v_mfma_f32_16x16x32_bf16 v[72:75], v[32:35], a[24:27], v[72:75]
  ds_read_b128 v[52:55], v10 offset:56320
  s_waitcnt lgkmcnt(4)
  v_mfma_f32_16x16x32_bf16 v[76:79], v[36:39], a[24:27], v[76:79]
  ds_read_b128 v[56:59], v10 offset:57344
  s_waitcnt lgkmcnt(4)
  v_mfma_f32_16x16x32_bf16 v[80:83], v[40:43], a[24:27], v[80:83]
  ds_read_b128 v[60:63], v10 offset:58368
  s_waitcnt lgkmcnt(4)
  v_mfma_f32_16x16x32_bf16 v[84:87], v[44:47], a[24:27], v[84:87]
  ds_read_b128 v[64:67], v10 offset:59392
  s_waitcnt lgkmcnt(4)
  v_mfma_f32_16x16x32_bf16 v[88:91], v[48:51], a[24:27], v[88:91]
  ds_read_b128 v[68:71], v10 offset:60416
  s_waitcnt vmcnt(2)
  s_waitcnt lgkmcnt(0)
  s_barrier
  v_mfma_f32_16x16x32_bf16 v[72:75], v[52:55], a[28:31], v[72:75]
  ds_read_b128 v[32:35], v10 offset:61440
  v_mfma_f32_16x16x32_bf16 v[76:79], v[56:59], a[28:31], v[76:79]
  ds_read_b128 v[36:39], v10 offset:62464
  v_mfma_f32_16x16x32_bf16 v[80:83], v[60:63], a[28:31], v[80:83]
  ds_read_b128 v[40:43], v10 offset:63488
  v_mfma_f32_16x16x32_bf16 v[84:87], v[64:67], a[28:31], v[84:87]
  ds_read_b128 v[44:47], v10 offset:64512
  v_mfma_f32_16x16x32_bf16 v[88:91], v[68:71], a[28:31], v[88:91]
  ds_read_b128 v[48:51], v11 offset:0
  s_waitcnt lgkmcnt(4)
  v_mfma_f32_16x16x32_bf16 v[72:75], v[32:35], a[32:35], v[72:75]
  ds_read_b128 v[52:55], v11 offset:1024
  s_waitcnt lgkmcnt(4)
  v_mfma_f32_16x16x32_bf16 v[76:79], v[36:39], a[32:35], v[76:79]
  ds_read_b128 v[56:59], v11 offset:2048
  s_waitcnt lgkmcnt(4)
  v_mfma_f32_16x16x32_bf16 v[80:83], v[40:43], a[32:35], v[80:83]
  ds_read_b128 v[60:63], v11 offset:3072
  s_waitcnt lgkmcnt(4)
  v_mfma_f32_16x16x32_bf16 v[84:87], v[44:47], a[32:35], v[84:87]
  ds_read_b128 v[64:67], v11 offset:4096
  s_waitcnt lgkmcnt(4)
  v_mfma_f32_16x16x32_bf16 v[88:91], v[48:51], a[32:35], v[88:91]
  ds_read_b128 v[68:71], v11 offset:5120
  s_waitcnt lgkmcnt(4)
  v_mfma_f32_16x16x32_bf16 v[72:75], v[52:55], a[36:39], v[72:75]
  ds_read_b128 v[32:35], v11 offset:6144
  s_waitcnt lgkmcnt(4)
  v_mfma_f32_16x16x32_bf16 v[76:79], v[56:59], a[36:39], v[76:79]
  ds_read_b128 v[36:39], v11 offset:7168
  s_waitcnt lgkmcnt(4)
  v_mfma_f32_16x16x32_bf16 v[80:83], v[60:63], a[36:39], v[80:83]
  ds_read_b128 v[40:43], v11 offset:8192
  s_waitcnt lgkmcnt(4)
  v_mfma_f32_16x16x32_bf16 v[84:87], v[64:67], a[36:39], v[84:87]
  ds_read_b128 v[44:47], v11 offset:9216
  s_waitcnt lgkmcnt(4)
  v_mfma_f32_16x16x32_bf16 v[88:91], v[68:71], a[36:39], v[88:91]
  ds_read_b128 v[48:51], v11 offset:10240
  s_waitcnt lgkmcnt(4)
  v_mfma_f32_16x16x32_bf16 v[72:75], v[32:35], a[40:43], v[72:75]
  ds_read_b128 v[52:55], v11 offset:11264
  s_waitcnt lgkmcnt(4)
  v_mfma_f32_16x16x32_bf16 v[76:79], v[36:39], a[40:43], v[76:79]
  ds_read_b128 v[56:59], v11 offset:12288
  s_waitcnt lgkmcnt(4)
  v_mfma_f32_16x16x32_bf16 v[80:83], v[40:43], a[40:43], v[80:83]
  ds_read_b128 v[60:63], v11 offset:13312
  s_waitcnt lgkmcnt(4)
  v_mfma_f32_16x16x32_bf16 v[84:87], v[44:47], a[40:43], v[84:87]
  ds_read_b128 v[64:67], v11 offset:14336
  s_waitcnt lgkmcnt(4)
  v_mfma_f32_16x16x32_bf16 v[88:91], v[48:51], a[40:43], v[88:91]
  ds_read_b128 v[68:71], v11 offset:15360
  s_waitcnt vmcnt(0)
  s_waitcnt lgkmcnt(0)
  s_barrier
  v_mfma_f32_16x16x32_bf16 v[72:75], v[52:55], a[44:47], v[72:75]
  ds_read_b128 v[32:35], v11 offset:16384
  v_mfma_f32_16x16x32_bf16 v[76:79], v[56:59], a[44:47], v[76:79]
  ds_read_b128 v[36:39], v11 offset:17408
  v_mfma_f32_16x16x32_bf16 v[80:83], v[60:63], a[44:47], v[80:83]
  ds_read_b128 v[40:43], v11 offset:18432
  v_mfma_f32_16x16x32_bf16 v[84:87], v[64:67], a[44:47], v[84:87]
  ds_read_b128 v[44:47], v11 offset:19456
  v_mfma_f32_16x16x32_bf16 v[88:91], v[68:71], a[44:47], v[88:91]
  ds_read_b128 v[48:51], v11 offset:20480
  s_waitcnt lgkmcnt(4)
  v_mfma_f32_16x16x32_bf16 v[72:75], v[32:35], a[48:51], v[72:75]
  ds_read_b128 v[52:55], v11 offset:21504
  s_waitcnt lgkmcnt(4)
  v_mfma_f32_16x16x32_bf16 v[76:79], v[36:39], a[48:51], v[76:79]
  ds_read_b128 v[56:59], v11 offset:22528
  s_waitcnt lgkmcnt(4)
  v_mfma_f32_16x16x32_bf16 v[80:83], v[40:43], a[48:51], v[80:83]
  ds_read_b128 v[60:63], v11 offset:23552
  s_waitcnt lgkmcnt(4)
  v_mfma_f32_16x16x32_bf16 v[84:87], v[44:47], a[48:51], v[84:87]
  ds_read_b128 v[64:67], v11 offset:24576
  s_waitcnt lgkmcnt(4)
  v_mfma_f32_16x16x32_bf16 v[88:91], v[48:51], a[48:51], v[88:91]
  ds_read_b128 v[68:71], v11 offset:25600
  s_waitcnt lgkmcnt(4)
  v_mfma_f32_16x16x32_bf16 v[72:75], v[52:55], a[52:55], v[72:75]
  s_waitcnt lgkmcnt(3)
  v_mfma_f32_16x16x32_bf16 v[76:79], v[56:59], a[52:55], v[76:79]
  s_waitcnt lgkmcnt(2)
  v_mfma_f32_16x16x32_bf16 v[80:83], v[60:63], a[52:55], v[80:83]
  s_waitcnt lgkmcnt(1)
  v_mfma_f32_16x16x32_bf16 v[84:87], v[64:67], a[52:55], v[84:87]
  s_waitcnt lgkmcnt(0)
  v_mfma_f32_16x16x32_bf16 v[88:91], v[68:71], a[52:55], v[88:91]
  s_nop 6
  s_waitcnt lgkmcnt(0)
  v_fmac_f32 v112, v92, v72
  v_fmac_f32 v113, v93, v73
  v_fmac_f32 v114, v94, v74
  v_fmac_f32 v115, v95, v75
  v_fmac_f32 v116, v96, v76
  v_fmac_f32 v117, v97, v77
  v_fmac_f32 v118, v98, v78
  v_fmac_f32 v119, v99, v79
  v_fmac_f32 v120, v100, v80
  v_fmac_f32 v121, v101, v81
  v_fmac_f32 v122, v102, v82
  v_fmac_f32 v123, v103, v83
  v_fmac_f32 v124, v104, v84
  v_fmac_f32 v125, v105, v85
  v_fmac_f32 v126, v106, v86
  v_fmac_f32 v127, v107, v87
  v_fmac_f32 v128, v108, v88
  v_fmac_f32 v129, v109, v89
  v_fmac_f32 v130, v110, v90
  v_fmac_f32 v131, v111, v91
  v_cvt_pk_bf16_f32 v22, v112, v113
  v_cvt_pk_bf16_f32 v23, v114, v115
  buffer_store_dwordx2 v[22:23], v8, s[12:15], 0 offen offset:0
  v_cvt_pk_bf16_f32 v24, v116, v117
  v_cvt_pk_bf16_f32 v25, v118, v119
  buffer_store_dwordx2 v[24:25], v8, s[12:15], 0 offen offset:32
  v_cvt_pk_bf16_f32 v26, v120, v121
  v_cvt_pk_bf16_f32 v27, v122, v123
  buffer_store_dwordx2 v[26:27], v8, s[12:15], 0 offen offset:64
  v_cvt_pk_bf16_f32 v28, v124, v125
  v_cvt_pk_bf16_f32 v29, v126, v127
  buffer_store_dwordx2 v[28:29], v8, s[12:15], 0 offen offset:96
  v_cvt_pk_bf16_f32 v30, v128, v129
  v_cvt_pk_bf16_f32 v31, v130, v131
  buffer_store_dwordx2 v[30:31], v8, s[12:15], 0 offen offset:128
k456_kernel_end1:
  s_endpgm
code_end:
.section .rodata,"a"
.p2align 6
.amdhsa_kernel k1_kernel
  .amdhsa_next_free_vgpr 64
  .amdhsa_next_free_sgpr 37
  .amdhsa_accum_offset 64
  .amdhsa_group_segment_fixed_size 0
  .amdhsa_kernarg_size 96
  .amdhsa_user_sgpr_count 2
  .amdhsa_user_sgpr_kernarg_segment_ptr 1
  .amdhsa_system_sgpr_workgroup_id_x 1
.end_amdhsa_kernel
.p2align 6
.amdhsa_kernel k2_kernel
  .amdhsa_next_free_vgpr 189
  .amdhsa_next_free_sgpr 24
  .amdhsa_accum_offset 192
  .amdhsa_group_segment_fixed_size 0
  .amdhsa_kernarg_size 96
  .amdhsa_user_sgpr_count 2
  .amdhsa_user_sgpr_kernarg_segment_ptr 1
  .amdhsa_system_sgpr_workgroup_id_x 1
.end_amdhsa_kernel
.p2align 6
.amdhsa_kernel k3_kernel
  .amdhsa_next_free_vgpr 220
  .amdhsa_next_free_sgpr 58
  .amdhsa_accum_offset 220
  .amdhsa_group_segment_fixed_size 0
  .amdhsa_kernarg_size 96
  .amdhsa_user_sgpr_count 2
  .amdhsa_user_sgpr_kernarg_segment_ptr 1
  .amdhsa_system_sgpr_workgroup_id_x 1
.end_amdhsa_kernel
.p2align 6
.amdhsa_kernel k456_kernel
  .amdhsa_next_free_vgpr 360
  .amdhsa_next_free_sgpr 32
  .amdhsa_accum_offset 200
  .amdhsa_group_segment_fixed_size 0
  .amdhsa_kernarg_size 96
  .amdhsa_user_sgpr_count 2
  .amdhsa_user_sgpr_kernarg_segment_ptr 1
  .amdhsa_system_sgpr_workgroup_id_x 1
.end_amdhsa_kernel
```
